```python
import torch

def _softmax(x, axis=-1):
    return torch.softmax(x, dim=axis)

def _gelu(x):
    return torch.nn.functional.gelu(x, approximate='tanh')

def _silu(x):
    return torch.nn.functional.silu(x)

def _sigmoid(x):
    return torch.sigmoid(x)

def _layernorm(x, axis=-1, eps=1e-05):
    m = x.mean(dim=axis, keepdim=True)
    v = x.var(dim=axis, keepdim=True, unbiased=False)
    return (x - m) / torch.sqrt(v + eps)

def _scatter_add(tgt, idx, src, axis=0):
    return tgt.clone().index_add_(axis, idx, src)

def _segment_sum(src, seg, n):
    out = torch.zeros((n,) + src.shape[1:], dtype=src.dtype)
    return out.index_add_(0, seg, src)

def _pad(x, pw):
    flat = tuple((v for pair in reversed(pw) for v in pair))
    return torch.nn.functional.pad(x, flat)
kernel_name = 'parallel_sum__sliding_block__mixer_gmlp__prompt'

def setup_inputs():

    _w = lambda a: (lambda t: t.to(torch.bfloat16) if t.is_floating_point() else t)(torch.as_tensor(a))

    def _A_setup():
        B, S, D = (1, 2048, 576)
        return {'x': _w((lambda *s: torch.randn(*s, dtype=torch.bfloat16) * 0.05)(B, S, D)), 'wqkv': _w((lambda *s: torch.randn(*s, dtype=torch.bfloat16) * 0.1)(D, 3 * D)), 'wo': _w((lambda *s: torch.randn(*s, dtype=torch.bfloat16) * 0.05)(D, D))}
    _A_in = _A_setup()

    def _B_setup():
        B, S, D, F = (1, 2048, 576, 4608)
        Fh = F // 2
        return {'x': _w((lambda *s: torch.randn(*s, dtype=torch.bfloat16) * 0.05)(B, S, D)), 'w_in': _w((lambda *s: torch.randn(*s, dtype=torch.bfloat16) * 0.4)(D, 2 * Fh)), 'w_sp': _w(0.01 * (lambda *s: torch.randn(*s, dtype=torch.bfloat16) * 0.4)(S, S)), 'b_sp': _w(1.0 + 0.01 * (lambda *s: torch.randn(*s, dtype=torch.bfloat16) * 0.05)(S)), 'w_out': _w((lambda *s: torch.randn(*s, dtype=torch.bfloat16) * 0.05)(Fh, D))}
    _B_in = _B_setup()
    return {'A_x': _A_in['x'], 'A_wqkv': _A_in['wqkv'], 'A_wo': _A_in['wo'], 'B_x': _B_in['x'], 'B_w_in': _B_in['w_in'], 'B_w_sp': _B_in['w_sp'], 'B_b_sp': _B_in['b_sp'], 'B_w_out': _B_in['w_out']}

def reference(A_x, A_wqkv, A_wo, B_x, B_w_in, B_w_sp, B_b_sp, B_w_out):

    def _A_ref(x, wqkv, wo):
        B, S, D = x.shape
        H = 32
        Dh = D // H
        W = 256
        qkv = (lambda x, *d: x.permute(*d))((x @ wqkv).reshape(B, S, 3, H, Dh), 2, 0, 3, 1, 4)
        q, k, v = (qkv[0], qkv[1], qkv[2])
        scores = torch.einsum('bhqd,bhkd->bhqk', q, k) * Dh ** (-0.5)
        idx = torch.arange(S)
        mask = (idx[:, None] - idx[None, :] >= 0) & (idx[:, None] - idx[None, :] < W)
        scores = torch.where(mask[None, None], scores, -1000000000.0)
        p = _softmax(scores, axis=-1)
        o = torch.einsum('bhqk,bhkd->bhqd', p, v)
        return (lambda x, *d: x.permute(*d))(o, 0, 2, 1, 3).reshape(B, S, D) @ wo

    def _B_ref(x, w_in, w_sp, b_sp, w_out):
        B, S, D = x.shape
        F = w_in.shape[-1]
        Fh = F // 2
        z = _gelu(torch.einsum('bsd,df->bsf', x, w_in))
        z1 = z[..., :Fh].clone()
        z2 = _layernorm(z[..., Fh:], axis=-1)
        g = torch.einsum('ts,bsf->btf', w_sp, z2) + b_sp[None, :, None]
        return torch.einsum('bsf,fd->bsd', z1 * g, w_out)
    x = A_x
    xn = _layernorm(x, axis=-1)
    return x + _A_ref(xn, A_wqkv, A_wo) + _B_ref(xn, B_w_in, B_w_sp, B_b_sp, B_w_out)
```

```asm
; @launch kernel=k0_kernel grid=(533,1,1) block=(256,1,1) lds=0
; @launch kernel=k1_kernel grid=(256,1,1) block=(512,1,1) lds=147456
; @launch kernel=k3_kernel grid=(256,1,1) block=(512,1,1) lds=163840
; @launch kernel=k4_kernel grid=(256,1,1) block=(256,1,1) lds=61440
.amdgcn_target "amdgcn-amd-amdhsa--gfx950"
.text
.globl k0_kernel
.p2align 8
.type k0_kernel,@function
k0_kernel:
    s_cmp_ge_u32 s2, 533
    s_cbranch_scc1 k0_end
    s_cmp_ge_u32 s2, 16
    s_cbranch_scc1 k0_nopf
    s_getpc_b64 s[4:5]
k0_pc:
    v_lshlrev_b32 v70, 7, v0
    v_min_u32 v70, k4_end-k0_pc, v70
    v_mov_b32 v71, s5
    v_add_co_u32 v70, vcc, s4, v70
    s_nop 1
    v_addc_co_u32 v71, vcc, 0, v71, vcc
    global_load_dword v68, v[70:71], off
    v_lshlrev_b32 v70, 7, v0
    v_add_u32 v70, 32768, v70
    v_min_u32 v70, k4_end-k0_pc, v70
    v_mov_b32 v71, s5
    v_add_co_u32 v70, vcc, s4, v70
    s_nop 1
    v_addc_co_u32 v71, vcc, 0, v71, vcc
    global_load_dword v69, v[70:71], off
k0_nopf:
    s_load_dwordx2 s[4:5], s[0:1], 80
    s_load_dwordx2 s[6:7], s[0:1], 0
    v_lshrrev_b32 v1, 6, v0
    v_and_b32 v0, 63, v0
    s_lshl_b32 s3, s2, 2
    v_readfirstlane_b32 s36, v1
    s_add_u32 s3, s3, s36
    s_cmp_lt_u32 s2, 128
    s_cbranch_scc1 k0_ln
    s_sub_u32 s3, s3, 512
    s_load_dwordx2 s[28:29], s[0:1], 16
    s_load_dwordx2 s[30:31], s[0:1], 56
    v_mov_b32 v1, s3
    v_lshl_add_u32 v1, v1, 6, v0
    v_lshrrev_b32 v2, 5, v1
    v_mul_u32_u24 v2, 7282, v2
    v_lshrrev_b32 v2, 16, v2
    v_mul_u32_u24 v3, 288, v2
    v_sub_u32 v3, v1, v3
    v_lshrrev_b32 v4, 2, v2
    v_and_b32 v2, 3, v2
    v_lshl_add_u32 v2, v4, 3, v2
    v_mul_u32_u24 v2, 4608, v2
    v_lshl_add_u32 v2, v3, 2, v2
    v_lshlrev_b32 v1, 5, v1
    s_cmp_lt_u32 s3, 324
    s_waitcnt lgkmcnt(0)
    s_cselect_b32 s8, s28, s30
    s_cselect_b32 s9, s29, s31
    s_mov_b32 s10, 2654208
    s_cselect_b32 s10, 663552, s10
    s_cselect_b32 s32, 0, 663552
    s_mov_b32 s11, 0x00020000
    v_subrev_u32 v2, s32, v2
    s_movk_i32 s33, 18432
    buffer_load_dword v8, v2, s[8:11], 0 offen offset:0
    buffer_load_dword v9, v2, s[8:11], 0 offen offset:1152
    buffer_load_dword v10, v2, s[8:11], 0 offen offset:2304
    buffer_load_dword v11, v2, s[8:11], 0 offen offset:3456
    buffer_load_dword v12, v2, s[8:11], s33 offen offset:0
    buffer_load_dword v13, v2, s[8:11], s33 offen offset:1152
    buffer_load_dword v14, v2, s[8:11], s33 offen offset:2304
    buffer_load_dword v15, v2, s[8:11], s33 offen offset:3456
    s_add_u32 s12, s4, 0x3100000
    s_addc_u32 s13, s5, 0
    s_mov_b32 s14, 0x32a000
    s_mov_b32 s15, 0x00020000
    s_mov_b32 s34, 0x05040100
    s_mov_b32 s35, 0x07060302
    s_waitcnt vmcnt(6)
    v_perm_b32 v16, v9, v8, s34
    v_perm_b32 v20, v9, v8, s35
    s_waitcnt vmcnt(4)
    v_perm_b32 v17, v11, v10, s34
    v_perm_b32 v21, v11, v10, s35
    s_waitcnt vmcnt(2)
    v_perm_b32 v18, v13, v12, s34
    v_perm_b32 v22, v13, v12, s35
    s_waitcnt vmcnt(0)
    v_perm_b32 v19, v15, v14, s34
    v_perm_b32 v23, v15, v14, s35
    buffer_store_dwordx4 v[16:19], v1, s[12:15], 0 offen
    buffer_store_dwordx4 v[20:23], v1, s[12:15], 0 offen offset:16
    s_cmp_ge_u32 s3, 576
    s_cbranch_scc1 k0_noz
    s_add_u32 s16, s4, 0x1b00000
    s_addc_u32 s17, s5, 0
    s_mov_b32 s18, 0x90000
    s_mov_b32 s19, 0x00020000
    s_lshl_b32 s3, s3, 10
    v_lshlrev_b32 v1, 4, v0
    v_mov_b32 v4, 0
    v_mov_b32 v5, 0
    v_mov_b32 v6, 0
    v_mov_b32 v7, 0
    buffer_store_dwordx4 v[4:7], v1, s[16:19], s3 offen
k0_noz:
    s_endpgm
k0_ln:
    v_lshrrev_b32 v2, 4, v0
    v_and_b32 v3, 15, v0
    v_mul_u32_u24 v4, 1152, v2
    v_lshl_add_u32 v4, v3, 4, v4
    v_cmp_gt_u32 vcc, 8, v3
    v_mov_b32 v6, 0x10000000
    s_mul_i32 s20, s3, 4608
    v_cndmask_b32 v5, v6, v4, vcc
    s_waitcnt lgkmcnt(0)
    s_mov_b32 s8, s6
    s_mov_b32 s9, s7
    s_mov_b32 s10, 0x240000
    s_mov_b32 s11, 0x00020000
    buffer_load_dwordx4 v[8:11], v4, s[8:11], s20 offen offset:0
    buffer_load_dwordx4 v[12:15], v4, s[8:11], s20 offen offset:256
    buffer_load_dwordx4 v[16:19], v4, s[8:11], s20 offen offset:512
    buffer_load_dwordx4 v[20:23], v4, s[8:11], s20 offen offset:768
    buffer_load_dwordx4 v[24:27], v5, s[8:11], s20 offen offset:1024
    s_lshr_b32 s21, s3, 3
    s_mul_i32 s21, s21, 36864
    s_and_b32 s22, s3, 4
    s_lshl_b32 s22, s22, 6
    s_add_u32 s21, s21, s22
    s_and_b32 s22, s3, 1
    s_lshl_b32 s22, s22, 7
    s_add_u32 s21, s21, s22
    s_and_b32 s22, s3, 2
    s_lshl_b32 s22, s22, 5
    s_add_u32 s21, s21, s22
    v_lshlrev_b32 v4, 9, v3
    v_lshl_add_u32 v4, v2, 4, v4
    v_cndmask_b32 v5, v6, v4, vcc
    v_mov_b32 v6, 0
    v_mov_b32 v7, 0
    s_add_u32 s21, s21, 0
    s_add_u32 s12, s4, s21
    s_addc_u32 s13, s5, 0
    s_mov_b32 s14, 0x9000
    s_mov_b32 s15, 0x00020000
    s_waitcnt vmcnt(4)
    v_lshlrev_b32 v28, 16, v8
    v_and_b32 v29, 0xffff0000, v8
    v_add_f32 v6, v6, v28
    v_fmac_f32 v7, v28, v28
    v_add_f32 v6, v6, v29
    v_fmac_f32 v7, v29, v29
    v_lshlrev_b32 v30, 16, v9
    v_and_b32 v31, 0xffff0000, v9
    v_add_f32 v6, v6, v30
    v_fmac_f32 v7, v30, v30
    v_add_f32 v6, v6, v31
    v_fmac_f32 v7, v31, v31
    v_lshlrev_b32 v32, 16, v10
    v_and_b32 v33, 0xffff0000, v10
    v_add_f32 v6, v6, v32
    v_fmac_f32 v7, v32, v32
    v_add_f32 v6, v6, v33
    v_fmac_f32 v7, v33, v33
    v_lshlrev_b32 v34, 16, v11
    v_and_b32 v35, 0xffff0000, v11
    v_add_f32 v6, v6, v34
    v_fmac_f32 v7, v34, v34
    v_add_f32 v6, v6, v35
    v_fmac_f32 v7, v35, v35
    s_waitcnt vmcnt(3)
    v_lshlrev_b32 v36, 16, v12
    v_and_b32 v37, 0xffff0000, v12
    v_add_f32 v6, v6, v36
    v_fmac_f32 v7, v36, v36
    v_add_f32 v6, v6, v37
    v_fmac_f32 v7, v37, v37
    v_lshlrev_b32 v38, 16, v13
    v_and_b32 v39, 0xffff0000, v13
    v_add_f32 v6, v6, v38
    v_fmac_f32 v7, v38, v38
    v_add_f32 v6, v6, v39
    v_fmac_f32 v7, v39, v39
    v_lshlrev_b32 v40, 16, v14
    v_and_b32 v41, 0xffff0000, v14
    v_add_f32 v6, v6, v40
    v_fmac_f32 v7, v40, v40
    v_add_f32 v6, v6, v41
    v_fmac_f32 v7, v41, v41
    v_lshlrev_b32 v42, 16, v15
    v_and_b32 v43, 0xffff0000, v15
    v_add_f32 v6, v6, v42
    v_fmac_f32 v7, v42, v42
    v_add_f32 v6, v6, v43
    v_fmac_f32 v7, v43, v43
    s_waitcnt vmcnt(2)
    v_lshlrev_b32 v44, 16, v16
    v_and_b32 v45, 0xffff0000, v16
    v_add_f32 v6, v6, v44
    v_fmac_f32 v7, v44, v44
    v_add_f32 v6, v6, v45
    v_fmac_f32 v7, v45, v45
    v_lshlrev_b32 v46, 16, v17
    v_and_b32 v47, 0xffff0000, v17
    v_add_f32 v6, v6, v46
    v_fmac_f32 v7, v46, v46
    v_add_f32 v6, v6, v47
    v_fmac_f32 v7, v47, v47
    v_lshlrev_b32 v48, 16, v18
    v_and_b32 v49, 0xffff0000, v18
    v_add_f32 v6, v6, v48
    v_fmac_f32 v7, v48, v48
    v_add_f32 v6, v6, v49
    v_fmac_f32 v7, v49, v49
    v_lshlrev_b32 v50, 16, v19
    v_and_b32 v51, 0xffff0000, v19
    v_add_f32 v6, v6, v50
    v_fmac_f32 v7, v50, v50
    v_add_f32 v6, v6, v51
    v_fmac_f32 v7, v51, v51
    s_waitcnt vmcnt(1)
    v_lshlrev_b32 v52, 16, v20
    v_and_b32 v53, 0xffff0000, v20
    v_add_f32 v6, v6, v52
    v_fmac_f32 v7, v52, v52
    v_add_f32 v6, v6, v53
    v_fmac_f32 v7, v53, v53
    v_lshlrev_b32 v54, 16, v21
    v_and_b32 v55, 0xffff0000, v21
    v_add_f32 v6, v6, v54
    v_fmac_f32 v7, v54, v54
    v_add_f32 v6, v6, v55
    v_fmac_f32 v7, v55, v55
    v_lshlrev_b32 v56, 16, v22
    v_and_b32 v57, 0xffff0000, v22
    v_add_f32 v6, v6, v56
    v_fmac_f32 v7, v56, v56
    v_add_f32 v6, v6, v57
    v_fmac_f32 v7, v57, v57
    v_lshlrev_b32 v58, 16, v23
    v_and_b32 v59, 0xffff0000, v23
    v_add_f32 v6, v6, v58
    v_fmac_f32 v7, v58, v58
    v_add_f32 v6, v6, v59
    v_fmac_f32 v7, v59, v59
    s_waitcnt vmcnt(0)
    v_lshlrev_b32 v60, 16, v24
    v_and_b32 v61, 0xffff0000, v24
    v_add_f32 v6, v6, v60
    v_fmac_f32 v7, v60, v60
    v_add_f32 v6, v6, v61
    v_fmac_f32 v7, v61, v61
    v_lshlrev_b32 v62, 16, v25
    v_and_b32 v63, 0xffff0000, v25
    v_add_f32 v6, v6, v62
    v_fmac_f32 v7, v62, v62
    v_add_f32 v6, v6, v63
    v_fmac_f32 v7, v63, v63
    v_lshlrev_b32 v64, 16, v26
    v_and_b32 v65, 0xffff0000, v26
    v_add_f32 v6, v6, v64
    v_fmac_f32 v7, v64, v64
    v_add_f32 v6, v6, v65
    v_fmac_f32 v7, v65, v65
    v_lshlrev_b32 v66, 16, v27
    v_and_b32 v67, 0xffff0000, v27
    v_add_f32 v6, v6, v66
    v_fmac_f32 v7, v66, v66
    v_add_f32 v6, v6, v67
    v_fmac_f32 v7, v67, v67
    s_nop 1
    v_add_f32_dpp v6, v6, v6 row_ror:8 row_mask:0xf bank_mask:0xf
    v_add_f32_dpp v7, v7, v7 row_ror:8 row_mask:0xf bank_mask:0xf
    s_nop 1
    v_add_f32_dpp v6, v6, v6 row_ror:4 row_mask:0xf bank_mask:0xf
    v_add_f32_dpp v7, v7, v7 row_ror:4 row_mask:0xf bank_mask:0xf
    s_nop 1
    v_add_f32_dpp v6, v6, v6 row_ror:2 row_mask:0xf bank_mask:0xf
    v_add_f32_dpp v7, v7, v7 row_ror:2 row_mask:0xf bank_mask:0xf
    s_nop 1
    v_add_f32_dpp v6, v6, v6 row_ror:1 row_mask:0xf bank_mask:0xf
    v_add_f32_dpp v7, v7, v7 row_ror:1 row_mask:0xf bank_mask:0xf
    v_mul_f32 v6, 0x3ae38e39, v6
    v_mul_f32 v7, 0x3ae38e39, v7
    v_fma_f32 v7, -v6, v6, v7
    v_max_f32 v7, 0, v7
    v_add_f32 v7, 0x3727c5ac, v7
    v_rsq_f32 v7, v7
    s_nop 0
    v_mul_f32 v6, v6, v7
    v_fma_f32 v28, v28, v7, -v6
    v_fma_f32 v29, v29, v7, -v6
    v_cvt_pk_bf16_f32 v8, v28, v29
    v_fma_f32 v30, v30, v7, -v6
    v_fma_f32 v31, v31, v7, -v6
    v_cvt_pk_bf16_f32 v9, v30, v31
    v_fma_f32 v32, v32, v7, -v6
    v_fma_f32 v33, v33, v7, -v6
    v_cvt_pk_bf16_f32 v10, v32, v33
    v_fma_f32 v34, v34, v7, -v6
    v_fma_f32 v35, v35, v7, -v6
    v_cvt_pk_bf16_f32 v11, v34, v35
    s_movk_i32 s22, 0
    buffer_store_dwordx4 v[8:11], v4, s[12:15], s22 offen
    v_fma_f32 v36, v36, v7, -v6
    v_fma_f32 v37, v37, v7, -v6
    v_cvt_pk_bf16_f32 v12, v36, v37
    v_fma_f32 v38, v38, v7, -v6
    v_fma_f32 v39, v39, v7, -v6
    v_cvt_pk_bf16_f32 v13, v38, v39
    v_fma_f32 v40, v40, v7, -v6
    v_fma_f32 v41, v41, v7, -v6
    v_cvt_pk_bf16_f32 v14, v40, v41
    v_fma_f32 v42, v42, v7, -v6
    v_fma_f32 v43, v43, v7, -v6
    v_cvt_pk_bf16_f32 v15, v42, v43
    s_movk_i32 s22, 8192
    buffer_store_dwordx4 v[12:15], v4, s[12:15], s22 offen
    v_fma_f32 v44, v44, v7, -v6
    v_fma_f32 v45, v45, v7, -v6
    v_cvt_pk_bf16_f32 v16, v44, v45
    v_fma_f32 v46, v46, v7, -v6
    v_fma_f32 v47, v47, v7, -v6
    v_cvt_pk_bf16_f32 v17, v46, v47
    v_fma_f32 v48, v48, v7, -v6
    v_fma_f32 v49, v49, v7, -v6
    v_cvt_pk_bf16_f32 v18, v48, v49
    v_fma_f32 v50, v50, v7, -v6
    v_fma_f32 v51, v51, v7, -v6
    v_cvt_pk_bf16_f32 v19, v50, v51
    s_movk_i32 s22, 16384
    buffer_store_dwordx4 v[16:19], v4, s[12:15], s22 offen
    v_fma_f32 v52, v52, v7, -v6
    v_fma_f32 v53, v53, v7, -v6
    v_cvt_pk_bf16_f32 v20, v52, v53
    v_fma_f32 v54, v54, v7, -v6
    v_fma_f32 v55, v55, v7, -v6
    v_cvt_pk_bf16_f32 v21, v54, v55
    v_fma_f32 v56, v56, v7, -v6
    v_fma_f32 v57, v57, v7, -v6
    v_cvt_pk_bf16_f32 v22, v56, v57
    v_fma_f32 v58, v58, v7, -v6
    v_fma_f32 v59, v59, v7, -v6
    v_cvt_pk_bf16_f32 v23, v58, v59
    s_movk_i32 s22, 24576
    buffer_store_dwordx4 v[20:23], v4, s[12:15], s22 offen
    v_fma_f32 v60, v60, v7, -v6
    v_fma_f32 v61, v61, v7, -v6
    v_cvt_pk_bf16_f32 v24, v60, v61
    v_fma_f32 v62, v62, v7, -v6
    v_fma_f32 v63, v63, v7, -v6
    v_cvt_pk_bf16_f32 v25, v62, v63
    v_fma_f32 v64, v64, v7, -v6
    v_fma_f32 v65, v65, v7, -v6
    v_cvt_pk_bf16_f32 v26, v64, v65
    v_fma_f32 v66, v66, v7, -v6
    v_fma_f32 v67, v67, v7, -v6
    v_cvt_pk_bf16_f32 v27, v66, v67
    s_mov_b32 s22, 0x8000
    buffer_store_dwordx4 v[24:27], v5, s[12:15], s22 offen
k0_end:
    s_endpgm
.globl k1_kernel
.p2align 8
.type k1_kernel,@function
k1_kernel:
    s_cmp_ge_u32 s2, 256
    s_cbranch_scc1 k1_end
    s_load_dwordx2 s[4:5], s[0:1], 80
    s_load_dwordx2 s[6:7], s[0:1], 8
    s_load_dwordx2 s[28:29], s[0:1], 32
    s_load_dwordx2 s[58:59], s[0:1], 40
    v_lshrrev_b32 v1, 6, v0
    v_and_b32 v0, 63, v0
    s_and_b32 s39, s2, 31
    v_readfirstlane_b32 s36, v1
    s_lshr_b32 s38, s2, 5
    s_lshl_b32 s38, s38, 3
    s_add_u32 s38, s38, s36
    s_lshr_b32 s37, s36, 2
    s_and_b32 s46, s39, 1
    s_cmp_lt_u32 s39, 12
    s_cselect_b32 s46, s46, 0
    s_xor_b32 s37, s37, s46
    s_add_u32 s40, s39, 36
    s_lshl_b32 s46, s39, 1
    s_sub_u32 s41, s46, 32
    s_sub_u32 s42, s46, 31
    s_add_u32 s47, s39, 56
    s_add_u32 s48, s39, 20
    s_cmp_lt_u32 s39, 16
    s_cselect_b32 s41, s47, s41
    s_cselect_b32 s42, s48, s42
    s_add_u32 s46, s46, 128
    s_add_u32 s47, s46, 1
    s_lshr_b32 s48, s39, 2
    s_add_u32 s48, s48, 152
    s_cmp_lt_u32 s39, 12
    s_cselect_b32 s41, s46, s41
    s_cselect_b32 s42, s47, s42
    s_cselect_b32 s43, s48, 255
    s_mov_b32 s35, 0
    v_lshrrev_b32 v4, 3, v0
    v_and_b32 v14, 7, v0
    v_lshlrev_b32 v14, 4, v14
    v_and_b32 v3, 16, v0
    v_lshlrev_b32 v3, 2, v3
    v_xor_b32 v14, v14, v3
    v_lshlrev_b32 v15, 4, v0
    s_waitcnt lgkmcnt(0)
    s_mul_i32 s46, s38, 36864
    s_add_u32 s8, s4, s46
    s_addc_u32 s9, s5, 0
    s_mov_b32 s10, 0x9000
    s_mov_b32 s11, 0x00020000
    s_mov_b32 s20, s4
    s_mov_b32 s21, s5
    s_mov_b32 s22, 0x3100000
    s_mov_b32 s23, 0x00020000
    s_cmp_lt_u32 s40, 128
    s_cselect_b32 s24, s28, s6
    s_cselect_b32 s25, s29, s7
    s_mov_b32 s26, 1990656
    s_cselect_b32 s26, 5308416, s26
    s_mov_b32 s27, 0x00020000
    s_movk_i32 s30, 3456
    s_cselect_b32 s30, 9216, s30
    s_and_b32 s31, s40, 127
    s_lshl_b32 s31, s31, 7
    v_mad_u32_u24 v3, v4, s30, v14
    s_lshl_b32 s46, s36, 3
    s_mul_i32 s46, s46, s30
    s_add_u32 s31, s31, s46
    s_mul_i32 s46, s30, 64
    s_lshl_b32 s47, s36, 10
    s_add_u32 m0, s47, 0
    s_nop 0
    buffer_load_dwordx4 v3, s[24:27], s31 offen lds
    s_add_u32 m0, m0, 8192
    s_add_u32 s31, s31, s46
    s_nop 0
    buffer_load_dwordx4 v3, s[24:27], s31 offen lds
    s_add_u32 m0, m0, 8192
    s_add_u32 s31, s31, s46
    s_nop 0
    buffer_load_dwordx4 v3, s[24:27], s31 offen lds
    s_add_u32 m0, m0, 8192
    s_add_u32 s31, s31, s46
    s_nop 0
    buffer_load_dwordx4 v3, s[24:27], s31 offen lds
    s_add_u32 m0, m0, 8192
    s_add_u32 s31, s31, s46
    s_nop 0
    buffer_load_dwordx4 v3, s[24:27], s31 offen lds
    s_add_u32 m0, m0, 8192
    s_add_u32 s31, s31, s46
    s_nop 0
    buffer_load_dwordx4 v3, s[24:27], s31 offen lds
    s_add_u32 m0, m0, 8192
    s_add_u32 s31, s31, s46
    s_nop 0
    buffer_load_dwordx4 v3, s[24:27], s31 offen lds
    s_add_u32 m0, m0, 8192
    s_add_u32 s31, s31, s46
    s_nop 0
    buffer_load_dwordx4 v3, s[24:27], s31 offen lds
    s_add_u32 m0, m0, 8192
    s_add_u32 s31, s31, s46
    s_nop 0
    buffer_load_dwordx4 v3, s[24:27], s31 offen lds
    s_cmp_eq_u32 s37, 0
    s_cbranch_scc0 k1_yld
    s_movk_i32 s48, 0
    buffer_load_dwordx4 v[16:19], v15, s[8:11], s48 offen offset:0
    buffer_load_dwordx4 v[20:23], v15, s[8:11], s48 offen offset:1024
    buffer_load_dwordx4 v[24:27], v15, s[8:11], s48 offen offset:2048
    buffer_load_dwordx4 v[28:31], v15, s[8:11], s48 offen offset:3072
    s_movk_i32 s48, 4096
    buffer_load_dwordx4 v[32:35], v15, s[8:11], s48 offen offset:0
    buffer_load_dwordx4 v[36:39], v15, s[8:11], s48 offen offset:1024
    buffer_load_dwordx4 v[40:43], v15, s[8:11], s48 offen offset:2048
    buffer_load_dwordx4 v[44:47], v15, s[8:11], s48 offen offset:3072
    s_movk_i32 s48, 8192
    buffer_load_dwordx4 v[48:51], v15, s[8:11], s48 offen offset:0
    buffer_load_dwordx4 v[52:55], v15, s[8:11], s48 offen offset:1024
    buffer_load_dwordx4 v[56:59], v15, s[8:11], s48 offen offset:2048
    buffer_load_dwordx4 v[60:63], v15, s[8:11], s48 offen offset:3072
    s_movk_i32 s48, 12288
    buffer_load_dwordx4 v[64:67], v15, s[8:11], s48 offen offset:0
    buffer_load_dwordx4 v[68:71], v15, s[8:11], s48 offen offset:1024
    buffer_load_dwordx4 v[72:75], v15, s[8:11], s48 offen offset:2048
    buffer_load_dwordx4 v[76:79], v15, s[8:11], s48 offen offset:3072
k1_yld:
    s_mov_b32 s60, s58
    s_mov_b32 s61, s59
    s_mov_b32 s62, 0x800000
    s_mov_b32 s63, 0x00020000
    v_bfe_u32 v11, v0, 2, 2
    v_and_b32 v255, 3, v0
    v_lshl_add_u32 v11, v11, 3, v255
    v_and_b32 v255, 48, v0
    v_lshl_add_u32 v11, v11, 12, v255
    s_lshr_b32 s46, s2, 5
    s_lshl_b32 s46, s46, 4
    s_and_b32 s47, s39, 15
    s_add_u32 s46, s46, s47
    s_lshl_b32 s88, s46, 16
    s_lshl_b32 s47, s36, 13
    s_add_u32 s88, s88, s47
    s_add_u32 s88, s88, 41943040
    s_lshr_b32 s55, s46, 1
    s_lshl_b32 s55, s55, 17
    s_and_b32 s46, s46, 1
    s_lshl_b32 s46, s46, 14
    s_add_u32 s55, s55, s46
    s_lshl_b32 s46, s36, 9
    s_add_u32 s55, s55, s46
    v_lshrrev_b32 v252, 5, v0
    v_bfe_u32 v253, v0, 2, 2
    v_lshl_add_u32 v1, v252, 3, v253
    v_lshlrev_b32 v1, 7, v1
    v_bfe_u32 v254, v0, 4, 1
    v_lshl_add_u32 v1, v254, 5, v1
    v_and_b32 v255, 3, v0
    v_lshl_add_u32 v1, v255, 3, v1
    v_lshrrev_b32 v253, 1, v253
    v_lshl_add_u32 v1, v253, 6, v1
    v_xor_b32 v2, 64, v1
    v_and_b32 v253, 7, v0
    v_lshl_add_u32 v253, v254, 3, v253
    v_bfe_u32 v255, v0, 3, 1
    v_mul_u32_u24 v5, 73728, v255
    v_lshl_add_u32 v5, v252, 8, v5
    v_lshl_add_u32 v5, v253, 4, v5
    v_and_b32 v6, 15, v0
    v_lshlrev_b32 v6, 4, v6
    v_lshl_add_u32 v6, v252, 8, v6
    v_mul_u32_u24 v7, 9216, v252
    v_and_b32 v8, 31, v0
    v_lshl_add_u32 v7, v8, 4, v7
    v_mul_u32_u24 v8, 9216, v252
    v_lshl_add_u32 v8, v254, 6, v8
    v_lshl_add_u32 v8, v255, 4, v8
    v_and_b32 v12, 4, v0
    v_lshl_add_u32 v8, v12, 3, v8
    v_and_b32 v12, 3, v0
    v_lshl_add_u32 v8, v12, 2, v8
    v_mul_u32_u24 v12, 36864, v255
    v_sub_u32 v12, v5, v12
    s_lshr_b32 s56, s38, 1
    s_mul_i32 s56, s56, 18432
    s_and_b32 s46, s38, 1
    s_mul_i32 s46, s46, 4608
    s_add_u32 s56, s56, s46
    s_mov_b32 s44, 36864
    s_mov_b32 s45, 73728
    s_mov_b32 s50, 0xc0135761
    s_mov_b32 s51, 0xbdd2d3e8
    v_mov_b32 v253, s50
    s_add_u32 s56, s56, 28311552
    s_add_u32 s57, s56, 4096
    s_cmp_eq_u32 s37, 0
    s_cbranch_scc0 k1_ygo
    s_waitcnt vmcnt(16)
    s_barrier
    s_setprio 3
    s_branch k1_M0X
k1_ygo:
    s_lshr_b32 s46, s2, 5
    s_and_b32 s46, s46, 7
    s_lshl_b32 s46, s46, 2
    s_and_b32 s47, s36, 3
    s_add_u32 s46, s46, s47
    s_mul_i32 s89, s46, 18
    v_and_b32 v10, 1, v0
    v_lshlrev_b32 v10, 6, v10
    s_cmp_eq_u32 s43, 255
    s_cselect_b32 s49, s42, s43
    s_cmp_lt_u32 s41, 128
    s_cselect_b32 s24, s28, s6
    s_cselect_b32 s25, s29, s7
    s_mov_b32 s26, 1990656
    s_cselect_b32 s26, 5308416, s26
    s_mov_b32 s27, 0x00020000
    s_movk_i32 s30, 3456
    s_cselect_b32 s30, 9216, s30
    s_and_b32 s31, s41, 127
    s_lshl_b32 s31, s31, 7
    v_mad_u32_u24 v3, v4, s30, v14
    v_lshrrev_b32 v3, 1, v0
    v_add_u32 v3, 0, v3
    v_min_u32 v3, 17, v3
    v_add_u32 v3, s89, v3
    v_mad_u32_u24 v3, v3, s30, v10
    buffer_load_dword v9, v3, s[24:27], s31 offen
    s_cmp_lt_u32 s42, 128
    s_cselect_b32 s24, s28, s6
    s_cselect_b32 s25, s29, s7
    s_mov_b32 s26, 1990656
    s_cselect_b32 s26, 5308416, s26
    s_mov_b32 s27, 0x00020000
    s_movk_i32 s30, 3456
    s_cselect_b32 s30, 9216, s30
    s_and_b32 s31, s42, 127
    s_lshl_b32 s31, s31, 7
    v_mad_u32_u24 v3, v4, s30, v14
    v_lshrrev_b32 v3, 1, v0
    v_add_u32 v3, 0, v3
    v_min_u32 v3, 17, v3
    v_add_u32 v3, s89, v3
    v_mad_u32_u24 v3, v3, s30, v10
    buffer_load_dword v9, v3, s[24:27], s31 offen
    s_cmp_lt_u32 s49, 128
    s_cselect_b32 s24, s28, s6
    s_cselect_b32 s25, s29, s7
    s_mov_b32 s26, 1990656
    s_cselect_b32 s26, 5308416, s26
    s_mov_b32 s27, 0x00020000
    s_movk_i32 s30, 3456
    s_cselect_b32 s30, 9216, s30
    s_and_b32 s31, s49, 127
    s_lshl_b32 s31, s31, 7
    v_mad_u32_u24 v3, v4, s30, v14
    v_lshrrev_b32 v3, 1, v0
    v_add_u32 v3, 0, v3
    v_min_u32 v3, 17, v3
    v_add_u32 v3, s89, v3
    v_mad_u32_u24 v3, v3, s30, v10
    buffer_load_dword v9, v3, s[24:27], s31 offen
    s_cmp_lt_u32 s41, 128
    s_cselect_b32 s24, s28, s6
    s_cselect_b32 s25, s29, s7
    s_mov_b32 s26, 1990656
    s_cselect_b32 s26, 5308416, s26
    s_mov_b32 s27, 0x00020000
    s_movk_i32 s30, 3456
    s_cselect_b32 s30, 9216, s30
    s_and_b32 s31, s41, 127
    s_lshl_b32 s31, s31, 7
    v_mad_u32_u24 v3, v4, s30, v14
    s_and_b32 s49, s36, 3
    s_lshl_b32 s46, s49, 3
    s_mul_i32 s46, s46, s30
    s_add_u32 s31, s31, s46
    s_lshl_b32 s30, s30, 5
    s_lshl_b32 s47, s49, 10
    s_add_u32 m0, s47, s45
    s_waitcnt vmcnt(3)
    s_barrier
    s_barrier
    s_setprio 2
    s_movk_i32 s48, 0
    buffer_load_dwordx4 v[16:19], v15, s[8:11], s48 offen offset:0
    buffer_load_dwordx4 v[20:23], v15, s[8:11], s48 offen offset:1024
    buffer_load_dwordx4 v[24:27], v15, s[8:11], s48 offen offset:2048
    buffer_load_dwordx4 v[28:31], v15, s[8:11], s48 offen offset:3072
    s_movk_i32 s48, 4096
    buffer_load_dwordx4 v[32:35], v15, s[8:11], s48 offen offset:0
    buffer_load_dwordx4 v[36:39], v15, s[8:11], s48 offen offset:1024
    buffer_load_dwordx4 v[40:43], v15, s[8:11], s48 offen offset:2048
    buffer_load_dwordx4 v[44:47], v15, s[8:11], s48 offen offset:3072
    s_movk_i32 s48, 8192
    buffer_load_dwordx4 v[48:51], v15, s[8:11], s48 offen offset:0
    buffer_load_dwordx4 v[52:55], v15, s[8:11], s48 offen offset:1024
    buffer_load_dwordx4 v[56:59], v15, s[8:11], s48 offen offset:2048
    buffer_load_dwordx4 v[60:63], v15, s[8:11], s48 offen offset:3072
    s_movk_i32 s48, 12288
    buffer_load_dwordx4 v[64:67], v15, s[8:11], s48 offen offset:0
    buffer_load_dwordx4 v[68:71], v15, s[8:11], s48 offen offset:1024
    buffer_load_dwordx4 v[72:75], v15, s[8:11], s48 offen offset:2048
    buffer_load_dwordx4 v[76:79], v15, s[8:11], s48 offen offset:3072
    s_branch k1_M0Y
k1_top:
    s_cmp_eq_u32 s37, 0
    s_cbranch_scc1 k1_px
    s_setprio 2
    s_branch k1_py
k1_px:
    s_setprio 3
    s_cmp_eq_u32 s41, 255
    s_cbranch_scc1 k1_py
    s_cmp_lt_u32 s41, 128
    s_cselect_b32 s24, s28, s6
    s_cselect_b32 s25, s29, s7
    s_mov_b32 s26, 1990656
    s_cselect_b32 s26, 5308416, s26
    s_mov_b32 s27, 0x00020000
    s_movk_i32 s30, 3456
    s_cselect_b32 s30, 9216, s30
    s_and_b32 s31, s41, 127
    s_lshl_b32 s31, s31, 7
    v_mad_u32_u24 v3, v4, s30, v14
    s_and_b32 s49, s36, 3
    s_lshl_b32 s46, s49, 3
    s_mul_i32 s46, s46, s30
    s_add_u32 s31, s31, s46
    s_lshl_b32 s30, s30, 5
    s_lshl_b32 s47, s49, 10
    s_add_u32 m0, s47, s45
    s_cmp_lt_u32 s40, 36
    s_cbranch_scc1 k1_MSD
    s_cmp_lt_u32 s40, 128
    s_cbranch_scc1 k1_MND
    s_cmp_lt_u32 s40, 146
    s_cbranch_scc1 k1_MSD
    s_branch k1_MND
k1_py:
    s_cmp_lt_u32 s40, 36
    s_cbranch_scc1 k1_MS
    s_cmp_lt_u32 s40, 128
    s_cbranch_scc1 k1_MN
    s_cmp_lt_u32 s40, 146
    s_cbranch_scc1 k1_MS
    s_cmp_lt_u32 s40, 152
    s_cbranch_scc1 k1_MN
    s_bitcmp1_b32 s39, 1
    s_cbranch_scc0 k1_mini0
    v_mov_b32 v1, v2
k1_mini0:
    buffer_load_dwordx4 v[176:179], v7, s[20:23], s56 offen offset:0 sc1
    buffer_load_dwordx4 v[180:183], v7, s[20:23], s56 offen offset:512 sc1
    buffer_load_dwordx4 v[184:187], v7, s[20:23], s56 offen offset:1024 sc1
    buffer_load_dwordx4 v[188:191], v7, s[20:23], s56 offen offset:1536 sc1
    buffer_load_dwordx4 v[236:239], v7, s[20:23], s56 offen offset:2048 sc1
    buffer_load_dwordx4 v[240:243], v7, s[20:23], s56 offen offset:2560 sc1
    buffer_load_dwordx4 v[244:247], v7, s[20:23], s56 offen offset:3072 sc1
    buffer_load_dwordx4 v[248:251], v7, s[20:23], s56 offen offset:3584 sc1
    buffer_load_dwordx4 v[216:219], v7, s[20:23], s57 offen offset:0 sc1
    ds_read_b64_tr_b16 v[192:193], v1 offset:0
    ds_read_b64_tr_b16 v[194:195], v1 offset:512
    ds_read_b64_tr_b16 v[196:197], v1 offset:2048
    ds_read_b64_tr_b16 v[198:199], v1 offset:2560
    ds_read_b64_tr_b16 v[200:201], v1 offset:4096
    ds_read_b64_tr_b16 v[202:203], v1 offset:4608
    ds_read_b64_tr_b16 v[204:205], v1 offset:6144
    ds_read_b64_tr_b16 v[206:207], v1 offset:6656
    ds_read_b64_tr_b16 v[208:209], v1 offset:8192
    ds_read_b64_tr_b16 v[210:211], v1 offset:8704
    ds_read_b64_tr_b16 v[212:213], v1 offset:10240
    ds_read_b64_tr_b16 v[214:215], v1 offset:10752
    s_waitcnt lgkmcnt(10)
    v_mfma_f32_32x32x16_bf16 v[160:175], v[16:19], v[192:195], 0
    ds_read_b64_tr_b16 v[192:193], v1 offset:12288
    ds_read_b64_tr_b16 v[194:195], v1 offset:12800
    s_waitcnt lgkmcnt(10)
    v_mfma_f32_32x32x16_bf16 v[160:175], v[20:23], v[196:199], v[160:175]
    ds_read_b64_tr_b16 v[196:197], v1 offset:14336
    ds_read_b64_tr_b16 v[198:199], v1 offset:14848
    s_waitcnt lgkmcnt(10)
    v_mfma_f32_32x32x16_bf16 v[160:175], v[24:27], v[200:203], v[160:175]
    ds_read_b64_tr_b16 v[200:201], v1 offset:16384
    ds_read_b64_tr_b16 v[202:203], v1 offset:16896
    s_waitcnt lgkmcnt(10)
    v_mfma_f32_32x32x16_bf16 v[160:175], v[28:31], v[204:207], v[160:175]
    ds_read_b64_tr_b16 v[204:205], v1 offset:18432
    ds_read_b64_tr_b16 v[206:207], v1 offset:18944
    s_waitcnt lgkmcnt(10)
    v_mfma_f32_32x32x16_bf16 v[160:175], v[32:35], v[208:211], v[160:175]
    ds_read_b64_tr_b16 v[208:209], v1 offset:20480
    ds_read_b64_tr_b16 v[210:211], v1 offset:20992
    s_waitcnt lgkmcnt(10)
    v_mfma_f32_32x32x16_bf16 v[160:175], v[36:39], v[212:215], v[160:175]
    ds_read_b64_tr_b16 v[212:213], v1 offset:22528
    ds_read_b64_tr_b16 v[214:215], v1 offset:23040
    s_waitcnt lgkmcnt(10)
    v_mfma_f32_32x32x16_bf16 v[160:175], v[40:43], v[192:195], v[160:175]
    ds_read_b64_tr_b16 v[192:193], v1 offset:24576
    ds_read_b64_tr_b16 v[194:195], v1 offset:25088
    s_waitcnt lgkmcnt(10)
    v_mfma_f32_32x32x16_bf16 v[160:175], v[44:47], v[196:199], v[160:175]
    ds_read_b64_tr_b16 v[196:197], v1 offset:26624
    ds_read_b64_tr_b16 v[198:199], v1 offset:27136
    s_waitcnt lgkmcnt(10)
    v_mfma_f32_32x32x16_bf16 v[160:175], v[48:51], v[200:203], v[160:175]
    ds_read_b64_tr_b16 v[200:201], v1 offset:28672
    ds_read_b64_tr_b16 v[202:203], v1 offset:29184
    s_waitcnt lgkmcnt(10)
    v_mfma_f32_32x32x16_bf16 v[160:175], v[52:55], v[204:207], v[160:175]
    ds_read_b64_tr_b16 v[204:205], v1 offset:30720
    ds_read_b64_tr_b16 v[206:207], v1 offset:31232
    s_waitcnt lgkmcnt(10)
    v_mfma_f32_32x32x16_bf16 v[160:175], v[56:59], v[208:211], v[160:175]
    ds_read_b64_tr_b16 v[208:209], v1 offset:32768
    ds_read_b64_tr_b16 v[210:211], v1 offset:33280
    s_waitcnt lgkmcnt(10)
    v_mfma_f32_32x32x16_bf16 v[160:175], v[60:63], v[212:215], v[160:175]
    ds_read_b64_tr_b16 v[212:213], v1 offset:34816
    ds_read_b64_tr_b16 v[214:215], v1 offset:35328
    s_waitcnt lgkmcnt(10)
    v_mfma_f32_32x32x16_bf16 v[160:175], v[64:67], v[192:195], v[160:175]
    v_add_u32 v1, 0x9000, v1
    ds_read_b64_tr_b16 v[192:193], v1 offset:0
    ds_read_b64_tr_b16 v[194:195], v1 offset:512
    s_waitcnt lgkmcnt(10)
    v_mfma_f32_32x32x16_bf16 v[160:175], v[68:71], v[196:199], v[160:175]
    ds_read_b64_tr_b16 v[196:197], v1 offset:2048
    ds_read_b64_tr_b16 v[198:199], v1 offset:2560
    s_waitcnt lgkmcnt(10)
    v_mfma_f32_32x32x16_bf16 v[160:175], v[72:75], v[200:203], v[160:175]
    ds_read_b64_tr_b16 v[200:201], v1 offset:4096
    ds_read_b64_tr_b16 v[202:203], v1 offset:4608
    s_waitcnt lgkmcnt(10)
    v_mfma_f32_32x32x16_bf16 v[160:175], v[76:79], v[204:207], v[160:175]
    ds_read_b64_tr_b16 v[204:205], v1 offset:6144
    ds_read_b64_tr_b16 v[206:207], v1 offset:6656
    s_waitcnt lgkmcnt(10)
    v_mfma_f32_32x32x16_bf16 v[160:175], v[80:83], v[208:211], v[160:175]
    ds_read_b64_tr_b16 v[208:209], v1 offset:8192
    ds_read_b64_tr_b16 v[210:211], v1 offset:8704
    s_waitcnt lgkmcnt(10)
    v_mfma_f32_32x32x16_bf16 v[160:175], v[84:87], v[212:215], v[160:175]
    ds_read_b64_tr_b16 v[212:213], v1 offset:10240
    ds_read_b64_tr_b16 v[214:215], v1 offset:10752
    s_waitcnt lgkmcnt(10)
    v_mfma_f32_32x32x16_bf16 v[160:175], v[88:91], v[192:195], v[160:175]
    ds_read_b64_tr_b16 v[192:193], v1 offset:12288
    ds_read_b64_tr_b16 v[194:195], v1 offset:12800
    s_waitcnt lgkmcnt(10)
    v_mfma_f32_32x32x16_bf16 v[160:175], v[92:95], v[196:199], v[160:175]
    ds_read_b64_tr_b16 v[196:197], v1 offset:14336
    ds_read_b64_tr_b16 v[198:199], v1 offset:14848
    s_waitcnt lgkmcnt(10)
    v_mfma_f32_32x32x16_bf16 v[160:175], v[96:99], v[200:203], v[160:175]
    ds_read_b64_tr_b16 v[200:201], v1 offset:16384
    ds_read_b64_tr_b16 v[202:203], v1 offset:16896
    s_waitcnt lgkmcnt(10)
    v_mfma_f32_32x32x16_bf16 v[160:175], v[100:103], v[204:207], v[160:175]
    ds_read_b64_tr_b16 v[204:205], v1 offset:18432
    ds_read_b64_tr_b16 v[206:207], v1 offset:18944
    s_waitcnt lgkmcnt(10)
    v_mfma_f32_32x32x16_bf16 v[160:175], v[104:107], v[208:211], v[160:175]
    ds_read_b64_tr_b16 v[208:209], v1 offset:20480
    ds_read_b64_tr_b16 v[210:211], v1 offset:20992
    s_waitcnt lgkmcnt(10)
    v_mfma_f32_32x32x16_bf16 v[160:175], v[108:111], v[212:215], v[160:175]
    ds_read_b64_tr_b16 v[212:213], v1 offset:22528
    ds_read_b64_tr_b16 v[214:215], v1 offset:23040
    s_waitcnt lgkmcnt(10)
    v_mfma_f32_32x32x16_bf16 v[160:175], v[112:115], v[192:195], v[160:175]
    ds_read_b64_tr_b16 v[192:193], v1 offset:24576
    ds_read_b64_tr_b16 v[194:195], v1 offset:25088
    s_waitcnt lgkmcnt(10)
    v_mfma_f32_32x32x16_bf16 v[160:175], v[116:119], v[196:199], v[160:175]
    ds_read_b64_tr_b16 v[196:197], v1 offset:26624
    ds_read_b64_tr_b16 v[198:199], v1 offset:27136
    s_waitcnt lgkmcnt(10)
    v_mfma_f32_32x32x16_bf16 v[160:175], v[120:123], v[200:203], v[160:175]
    ds_read_b64_tr_b16 v[200:201], v1 offset:28672
    ds_read_b64_tr_b16 v[202:203], v1 offset:29184
    s_waitcnt lgkmcnt(10)
    v_mfma_f32_32x32x16_bf16 v[160:175], v[124:127], v[204:207], v[160:175]
    ds_read_b64_tr_b16 v[204:205], v1 offset:30720
    ds_read_b64_tr_b16 v[206:207], v1 offset:31232
    s_waitcnt lgkmcnt(10)
    v_mfma_f32_32x32x16_bf16 v[160:175], v[128:131], v[208:211], v[160:175]
    ds_read_b64_tr_b16 v[208:209], v1 offset:32768
    ds_read_b64_tr_b16 v[210:211], v1 offset:33280
    s_waitcnt lgkmcnt(10)
    v_mfma_f32_32x32x16_bf16 v[160:175], v[132:135], v[212:215], v[160:175]
    ds_read_b64_tr_b16 v[212:213], v1 offset:34816
    ds_read_b64_tr_b16 v[214:215], v1 offset:35328
    s_waitcnt lgkmcnt(10)
    v_mfma_f32_32x32x16_bf16 v[160:175], v[136:139], v[192:195], v[160:175]
    s_waitcnt lgkmcnt(8)
    v_mfma_f32_32x32x16_bf16 v[160:175], v[140:143], v[196:199], v[160:175]
    s_waitcnt lgkmcnt(6)
    v_mfma_f32_32x32x16_bf16 v[160:175], v[144:147], v[200:203], v[160:175]
    s_waitcnt lgkmcnt(4)
    v_mfma_f32_32x32x16_bf16 v[160:175], v[148:151], v[204:207], v[160:175]
    s_waitcnt lgkmcnt(2)
    v_mfma_f32_32x32x16_bf16 v[160:175], v[152:155], v[208:211], v[160:175]
    s_waitcnt lgkmcnt(0)
    v_mfma_f32_32x32x16_bf16 v[160:175], v[156:159], v[212:215], v[160:175]
    s_branch k1_afterM
.p2align 6
k1_M0X:
    ds_read_b64_tr_b16 v[192:193], v1 offset:0
    ds_read_b64_tr_b16 v[194:195], v1 offset:512
    ds_read_b64_tr_b16 v[196:197], v2 offset:0
    ds_read_b64_tr_b16 v[198:199], v2 offset:512
    ds_read_b64_tr_b16 v[200:201], v1 offset:2048
    ds_read_b64_tr_b16 v[202:203], v1 offset:2560
    ds_read_b64_tr_b16 v[204:205], v2 offset:2048
    ds_read_b64_tr_b16 v[206:207], v2 offset:2560
    ds_read_b64_tr_b16 v[208:209], v1 offset:4096
    ds_read_b64_tr_b16 v[210:211], v1 offset:4608
    ds_read_b64_tr_b16 v[212:213], v2 offset:4096
    ds_read_b64_tr_b16 v[214:215], v2 offset:4608
    ds_read_b64_tr_b16 v[216:217], v1 offset:6144
    ds_read_b64_tr_b16 v[218:219], v1 offset:6656
    s_waitcnt vmcnt(15) lgkmcnt(12)
    v_mfma_f32_32x32x16_bf16 v[160:175], v[16:19], v[192:195], 0
    ds_read_b64_tr_b16 v[192:193], v2 offset:6144
    ds_read_b64_tr_b16 v[194:195], v2 offset:6656
    s_waitcnt lgkmcnt(12)
    v_mfma_f32_32x32x16_bf16 v[176:191], v[16:19], v[196:199], 0
    ds_read_b64_tr_b16 v[196:197], v1 offset:8192
    ds_read_b64_tr_b16 v[198:199], v1 offset:8704
    s_movk_i32 s48, 16384
    buffer_load_dwordx4 v[80:83], v15, s[8:11], s48 offen offset:0
    s_waitcnt vmcnt(15) lgkmcnt(12)
    v_mfma_f32_32x32x16_bf16 v[160:175], v[20:23], v[200:203], v[160:175]
    ds_read_b64_tr_b16 v[200:201], v2 offset:8192
    ds_read_b64_tr_b16 v[202:203], v2 offset:8704
    s_waitcnt lgkmcnt(12)
    v_mfma_f32_32x32x16_bf16 v[176:191], v[20:23], v[204:207], v[176:191]
    ds_read_b64_tr_b16 v[204:205], v1 offset:10240
    ds_read_b64_tr_b16 v[206:207], v1 offset:10752
    buffer_load_dwordx4 v[84:87], v15, s[8:11], s48 offen offset:1024
    s_waitcnt vmcnt(15) lgkmcnt(12)
    v_mfma_f32_32x32x16_bf16 v[160:175], v[24:27], v[208:211], v[160:175]
    ds_read_b64_tr_b16 v[208:209], v2 offset:10240
    ds_read_b64_tr_b16 v[210:211], v2 offset:10752
    s_waitcnt lgkmcnt(12)
    v_mfma_f32_32x32x16_bf16 v[176:191], v[24:27], v[212:215], v[176:191]
    ds_read_b64_tr_b16 v[212:213], v1 offset:12288
    ds_read_b64_tr_b16 v[214:215], v1 offset:12800
    buffer_load_dwordx4 v[88:91], v15, s[8:11], s48 offen offset:2048
    s_waitcnt vmcnt(15) lgkmcnt(12)
    v_mfma_f32_32x32x16_bf16 v[160:175], v[28:31], v[216:219], v[160:175]
    ds_read_b64_tr_b16 v[216:217], v2 offset:12288
    ds_read_b64_tr_b16 v[218:219], v2 offset:12800
    s_waitcnt lgkmcnt(12)
    v_mfma_f32_32x32x16_bf16 v[176:191], v[28:31], v[192:195], v[176:191]
    ds_read_b64_tr_b16 v[192:193], v1 offset:14336
    ds_read_b64_tr_b16 v[194:195], v1 offset:14848
    buffer_load_dwordx4 v[92:95], v15, s[8:11], s48 offen offset:3072
    s_waitcnt vmcnt(15) lgkmcnt(12)
    v_mfma_f32_32x32x16_bf16 v[160:175], v[32:35], v[196:199], v[160:175]
    ds_read_b64_tr_b16 v[196:197], v2 offset:14336
    ds_read_b64_tr_b16 v[198:199], v2 offset:14848
    s_waitcnt lgkmcnt(12)
    v_mfma_f32_32x32x16_bf16 v[176:191], v[32:35], v[200:203], v[176:191]
    ds_read_b64_tr_b16 v[200:201], v1 offset:16384
    ds_read_b64_tr_b16 v[202:203], v1 offset:16896
    s_movk_i32 s48, 20480
    buffer_load_dwordx4 v[96:99], v15, s[8:11], s48 offen offset:0
    s_waitcnt vmcnt(15) lgkmcnt(12)
    v_mfma_f32_32x32x16_bf16 v[160:175], v[36:39], v[204:207], v[160:175]
    ds_read_b64_tr_b16 v[204:205], v2 offset:16384
    ds_read_b64_tr_b16 v[206:207], v2 offset:16896
    s_waitcnt lgkmcnt(12)
    v_mfma_f32_32x32x16_bf16 v[176:191], v[36:39], v[208:211], v[176:191]
    ds_read_b64_tr_b16 v[208:209], v1 offset:18432
    ds_read_b64_tr_b16 v[210:211], v1 offset:18944
    buffer_load_dwordx4 v[100:103], v15, s[8:11], s48 offen offset:1024
    s_waitcnt vmcnt(15) lgkmcnt(12)
    v_mfma_f32_32x32x16_bf16 v[160:175], v[40:43], v[212:215], v[160:175]
    ds_read_b64_tr_b16 v[212:213], v2 offset:18432
    ds_read_b64_tr_b16 v[214:215], v2 offset:18944
    s_waitcnt lgkmcnt(12)
    v_mfma_f32_32x32x16_bf16 v[176:191], v[40:43], v[216:219], v[176:191]
    ds_read_b64_tr_b16 v[216:217], v1 offset:20480
    ds_read_b64_tr_b16 v[218:219], v1 offset:20992
    buffer_load_dwordx4 v[104:107], v15, s[8:11], s48 offen offset:2048
    s_waitcnt vmcnt(15) lgkmcnt(12)
    v_mfma_f32_32x32x16_bf16 v[160:175], v[44:47], v[192:195], v[160:175]
    ds_read_b64_tr_b16 v[192:193], v2 offset:20480
    ds_read_b64_tr_b16 v[194:195], v2 offset:20992
    s_waitcnt lgkmcnt(12)
    v_mfma_f32_32x32x16_bf16 v[176:191], v[44:47], v[196:199], v[176:191]
    ds_read_b64_tr_b16 v[196:197], v1 offset:22528
    ds_read_b64_tr_b16 v[198:199], v1 offset:23040
    buffer_load_dwordx4 v[108:111], v15, s[8:11], s48 offen offset:3072
    s_waitcnt vmcnt(15) lgkmcnt(12)
    v_mfma_f32_32x32x16_bf16 v[160:175], v[48:51], v[200:203], v[160:175]
    ds_read_b64_tr_b16 v[200:201], v2 offset:22528
    ds_read_b64_tr_b16 v[202:203], v2 offset:23040
    s_waitcnt lgkmcnt(12)
    v_mfma_f32_32x32x16_bf16 v[176:191], v[48:51], v[204:207], v[176:191]
    ds_read_b64_tr_b16 v[204:205], v1 offset:24576
    ds_read_b64_tr_b16 v[206:207], v1 offset:25088
    s_movk_i32 s48, 24576
    buffer_load_dwordx4 v[112:115], v15, s[8:11], s48 offen offset:0
    s_waitcnt vmcnt(15) lgkmcnt(12)
    v_mfma_f32_32x32x16_bf16 v[160:175], v[52:55], v[208:211], v[160:175]
    ds_read_b64_tr_b16 v[208:209], v2 offset:24576
    ds_read_b64_tr_b16 v[210:211], v2 offset:25088
    s_waitcnt lgkmcnt(12)
    v_mfma_f32_32x32x16_bf16 v[176:191], v[52:55], v[212:215], v[176:191]
    ds_read_b64_tr_b16 v[212:213], v1 offset:26624
    ds_read_b64_tr_b16 v[214:215], v1 offset:27136
    buffer_load_dwordx4 v[116:119], v15, s[8:11], s48 offen offset:1024
    s_waitcnt vmcnt(15) lgkmcnt(12)
    v_mfma_f32_32x32x16_bf16 v[160:175], v[56:59], v[216:219], v[160:175]
    ds_read_b64_tr_b16 v[216:217], v2 offset:26624
    ds_read_b64_tr_b16 v[218:219], v2 offset:27136
    s_waitcnt lgkmcnt(12)
    v_mfma_f32_32x32x16_bf16 v[176:191], v[56:59], v[192:195], v[176:191]
    ds_read_b64_tr_b16 v[192:193], v1 offset:28672
    ds_read_b64_tr_b16 v[194:195], v1 offset:29184
    buffer_load_dwordx4 v[120:123], v15, s[8:11], s48 offen offset:2048
    s_waitcnt vmcnt(15) lgkmcnt(12)
    v_mfma_f32_32x32x16_bf16 v[160:175], v[60:63], v[196:199], v[160:175]
    ds_read_b64_tr_b16 v[196:197], v2 offset:28672
    ds_read_b64_tr_b16 v[198:199], v2 offset:29184
    s_waitcnt lgkmcnt(12)
    v_mfma_f32_32x32x16_bf16 v[176:191], v[60:63], v[200:203], v[176:191]
    ds_read_b64_tr_b16 v[200:201], v1 offset:30720
    ds_read_b64_tr_b16 v[202:203], v1 offset:31232
    buffer_load_dwordx4 v[124:127], v15, s[8:11], s48 offen offset:3072
    s_waitcnt vmcnt(15) lgkmcnt(12)
    v_mfma_f32_32x32x16_bf16 v[160:175], v[64:67], v[204:207], v[160:175]
    ds_read_b64_tr_b16 v[204:205], v2 offset:30720
    ds_read_b64_tr_b16 v[206:207], v2 offset:31232
    s_waitcnt lgkmcnt(12)
    v_mfma_f32_32x32x16_bf16 v[176:191], v[64:67], v[208:211], v[176:191]
    ds_read_b64_tr_b16 v[208:209], v1 offset:32768
    ds_read_b64_tr_b16 v[210:211], v1 offset:33280
    s_movk_i32 s48, 28672
    buffer_load_dwordx4 v[128:131], v15, s[8:11], s48 offen offset:0
    s_waitcnt vmcnt(15) lgkmcnt(12)
    v_mfma_f32_32x32x16_bf16 v[160:175], v[68:71], v[212:215], v[160:175]
    ds_read_b64_tr_b16 v[212:213], v2 offset:32768
    ds_read_b64_tr_b16 v[214:215], v2 offset:33280
    s_waitcnt lgkmcnt(12)
    v_mfma_f32_32x32x16_bf16 v[176:191], v[68:71], v[216:219], v[176:191]
    ds_read_b64_tr_b16 v[216:217], v1 offset:34816
    ds_read_b64_tr_b16 v[218:219], v1 offset:35328
    buffer_load_dwordx4 v[132:135], v15, s[8:11], s48 offen offset:1024
    s_waitcnt vmcnt(15) lgkmcnt(12)
    v_mfma_f32_32x32x16_bf16 v[160:175], v[72:75], v[192:195], v[160:175]
    ds_read_b64_tr_b16 v[192:193], v2 offset:34816
    ds_read_b64_tr_b16 v[194:195], v2 offset:35328
    s_waitcnt lgkmcnt(12)
    v_mfma_f32_32x32x16_bf16 v[176:191], v[72:75], v[196:199], v[176:191]
    v_add_u32 v1, 0x9000, v1
    v_add_u32 v2, 0x9000, v2
    ds_read_b64_tr_b16 v[196:197], v1 offset:0
    ds_read_b64_tr_b16 v[198:199], v1 offset:512
    buffer_load_dwordx4 v[136:139], v15, s[8:11], s48 offen offset:2048
    s_waitcnt vmcnt(15) lgkmcnt(12)
    v_mfma_f32_32x32x16_bf16 v[160:175], v[76:79], v[200:203], v[160:175]
    ds_read_b64_tr_b16 v[200:201], v2 offset:0
    ds_read_b64_tr_b16 v[202:203], v2 offset:512
    s_waitcnt lgkmcnt(12)
    v_mfma_f32_32x32x16_bf16 v[176:191], v[76:79], v[204:207], v[176:191]
    ds_read_b64_tr_b16 v[204:205], v1 offset:2048
    ds_read_b64_tr_b16 v[206:207], v1 offset:2560
    buffer_load_dwordx4 v[140:143], v15, s[8:11], s48 offen offset:3072
    s_waitcnt vmcnt(15) lgkmcnt(12)
    v_mfma_f32_32x32x16_bf16 v[160:175], v[80:83], v[208:211], v[160:175]
    ds_read_b64_tr_b16 v[208:209], v2 offset:2048
    ds_read_b64_tr_b16 v[210:211], v2 offset:2560
    s_waitcnt lgkmcnt(12)
    v_mfma_f32_32x32x16_bf16 v[176:191], v[80:83], v[212:215], v[176:191]
    ds_read_b64_tr_b16 v[212:213], v1 offset:4096
    ds_read_b64_tr_b16 v[214:215], v1 offset:4608
    s_mov_b32 s48, 32768
    buffer_load_dwordx4 v[144:147], v15, s[8:11], s48 offen offset:0
    s_waitcnt vmcnt(15) lgkmcnt(12)
    v_mfma_f32_32x32x16_bf16 v[160:175], v[84:87], v[216:219], v[160:175]
    ds_read_b64_tr_b16 v[216:217], v2 offset:4096
    ds_read_b64_tr_b16 v[218:219], v2 offset:4608
    s_waitcnt lgkmcnt(12)
    v_mfma_f32_32x32x16_bf16 v[176:191], v[84:87], v[192:195], v[176:191]
    ds_read_b64_tr_b16 v[192:193], v1 offset:6144
    ds_read_b64_tr_b16 v[194:195], v1 offset:6656
    buffer_load_dwordx4 v[148:151], v15, s[8:11], s48 offen offset:1024
    s_waitcnt vmcnt(15) lgkmcnt(12)
    v_mfma_f32_32x32x16_bf16 v[160:175], v[88:91], v[196:199], v[160:175]
    ds_read_b64_tr_b16 v[196:197], v2 offset:6144
    ds_read_b64_tr_b16 v[198:199], v2 offset:6656
    s_waitcnt lgkmcnt(12)
    v_mfma_f32_32x32x16_bf16 v[176:191], v[88:91], v[200:203], v[176:191]
    ds_read_b64_tr_b16 v[200:201], v1 offset:8192
    ds_read_b64_tr_b16 v[202:203], v1 offset:8704
    buffer_load_dwordx4 v[152:155], v15, s[8:11], s48 offen offset:2048
    s_waitcnt vmcnt(15) lgkmcnt(12)
    v_mfma_f32_32x32x16_bf16 v[160:175], v[92:95], v[204:207], v[160:175]
    ds_read_b64_tr_b16 v[204:205], v2 offset:8192
    ds_read_b64_tr_b16 v[206:207], v2 offset:8704
    s_waitcnt lgkmcnt(12)
    v_mfma_f32_32x32x16_bf16 v[176:191], v[92:95], v[208:211], v[176:191]
    ds_read_b64_tr_b16 v[208:209], v1 offset:10240
    ds_read_b64_tr_b16 v[210:211], v1 offset:10752
    buffer_load_dwordx4 v[156:159], v15, s[8:11], s48 offen offset:3072
    s_barrier
    s_waitcnt vmcnt(15) lgkmcnt(12)
    v_mfma_f32_32x32x16_bf16 v[160:175], v[96:99], v[212:215], v[160:175]
    ds_read_b64_tr_b16 v[212:213], v2 offset:10240
    ds_read_b64_tr_b16 v[214:215], v2 offset:10752
    s_waitcnt lgkmcnt(12)
    v_mfma_f32_32x32x16_bf16 v[176:191], v[96:99], v[216:219], v[176:191]
    ds_read_b64_tr_b16 v[216:217], v1 offset:12288
    ds_read_b64_tr_b16 v[218:219], v1 offset:12800
    s_waitcnt vmcnt(14) lgkmcnt(12)
    v_mfma_f32_32x32x16_bf16 v[160:175], v[100:103], v[192:195], v[160:175]
    ds_read_b64_tr_b16 v[192:193], v2 offset:12288
    ds_read_b64_tr_b16 v[194:195], v2 offset:12800
    s_waitcnt lgkmcnt(12)
    v_mfma_f32_32x32x16_bf16 v[176:191], v[100:103], v[196:199], v[176:191]
    ds_read_b64_tr_b16 v[196:197], v1 offset:14336
    ds_read_b64_tr_b16 v[198:199], v1 offset:14848
    s_waitcnt vmcnt(13) lgkmcnt(12)
    v_mfma_f32_32x32x16_bf16 v[160:175], v[104:107], v[200:203], v[160:175]
    ds_read_b64_tr_b16 v[200:201], v2 offset:14336
    ds_read_b64_tr_b16 v[202:203], v2 offset:14848
    s_waitcnt lgkmcnt(12)
    v_mfma_f32_32x32x16_bf16 v[176:191], v[104:107], v[204:207], v[176:191]
    ds_read_b64_tr_b16 v[204:205], v1 offset:16384
    ds_read_b64_tr_b16 v[206:207], v1 offset:16896
    s_waitcnt vmcnt(12) lgkmcnt(12)
    v_mfma_f32_32x32x16_bf16 v[160:175], v[108:111], v[208:211], v[160:175]
    ds_read_b64_tr_b16 v[208:209], v2 offset:16384
    ds_read_b64_tr_b16 v[210:211], v2 offset:16896
    s_waitcnt lgkmcnt(12)
    v_mfma_f32_32x32x16_bf16 v[176:191], v[108:111], v[212:215], v[176:191]
    ds_read_b64_tr_b16 v[212:213], v1 offset:18432
    ds_read_b64_tr_b16 v[214:215], v1 offset:18944
    s_waitcnt vmcnt(11) lgkmcnt(12)
    v_mfma_f32_32x32x16_bf16 v[160:175], v[112:115], v[216:219], v[160:175]
    ds_read_b64_tr_b16 v[216:217], v2 offset:18432
    ds_read_b64_tr_b16 v[218:219], v2 offset:18944
    s_waitcnt lgkmcnt(12)
    v_mfma_f32_32x32x16_bf16 v[176:191], v[112:115], v[192:195], v[176:191]
    ds_read_b64_tr_b16 v[192:193], v1 offset:20480
    ds_read_b64_tr_b16 v[194:195], v1 offset:20992
    s_waitcnt vmcnt(10) lgkmcnt(12)
    v_mfma_f32_32x32x16_bf16 v[160:175], v[116:119], v[196:199], v[160:175]
    ds_read_b64_tr_b16 v[196:197], v2 offset:20480
    ds_read_b64_tr_b16 v[198:199], v2 offset:20992
    s_waitcnt lgkmcnt(12)
    v_mfma_f32_32x32x16_bf16 v[176:191], v[116:119], v[200:203], v[176:191]
    ds_read_b64_tr_b16 v[200:201], v1 offset:22528
    ds_read_b64_tr_b16 v[202:203], v1 offset:23040
    s_waitcnt vmcnt(9) lgkmcnt(12)
    v_mfma_f32_32x32x16_bf16 v[160:175], v[120:123], v[204:207], v[160:175]
    ds_read_b64_tr_b16 v[204:205], v2 offset:22528
    ds_read_b64_tr_b16 v[206:207], v2 offset:23040
    s_waitcnt lgkmcnt(12)
    v_mfma_f32_32x32x16_bf16 v[176:191], v[120:123], v[208:211], v[176:191]
    ds_read_b64_tr_b16 v[208:209], v1 offset:24576
    ds_read_b64_tr_b16 v[210:211], v1 offset:25088
    s_waitcnt vmcnt(8) lgkmcnt(12)
    v_mfma_f32_32x32x16_bf16 v[160:175], v[124:127], v[212:215], v[160:175]
    ds_read_b64_tr_b16 v[212:213], v2 offset:24576
    ds_read_b64_tr_b16 v[214:215], v2 offset:25088
    s_waitcnt lgkmcnt(12)
    v_mfma_f32_32x32x16_bf16 v[176:191], v[124:127], v[216:219], v[176:191]
    ds_read_b64_tr_b16 v[216:217], v1 offset:26624
    ds_read_b64_tr_b16 v[218:219], v1 offset:27136
    s_waitcnt vmcnt(7) lgkmcnt(12)
    v_mfma_f32_32x32x16_bf16 v[160:175], v[128:131], v[192:195], v[160:175]
    ds_read_b64_tr_b16 v[192:193], v2 offset:26624
    ds_read_b64_tr_b16 v[194:195], v2 offset:27136
    s_waitcnt lgkmcnt(12)
    v_mfma_f32_32x32x16_bf16 v[176:191], v[128:131], v[196:199], v[176:191]
    ds_read_b64_tr_b16 v[196:197], v1 offset:28672
    ds_read_b64_tr_b16 v[198:199], v1 offset:29184
    s_waitcnt vmcnt(6) lgkmcnt(12)
    v_mfma_f32_32x32x16_bf16 v[160:175], v[132:135], v[200:203], v[160:175]
    ds_read_b64_tr_b16 v[200:201], v2 offset:28672
    ds_read_b64_tr_b16 v[202:203], v2 offset:29184
    s_waitcnt lgkmcnt(12)
    v_mfma_f32_32x32x16_bf16 v[176:191], v[132:135], v[204:207], v[176:191]
    ds_read_b64_tr_b16 v[204:205], v1 offset:30720
    ds_read_b64_tr_b16 v[206:207], v1 offset:31232
    s_waitcnt vmcnt(5) lgkmcnt(12)
    v_mfma_f32_32x32x16_bf16 v[160:175], v[136:139], v[208:211], v[160:175]
    ds_read_b64_tr_b16 v[208:209], v2 offset:30720
    ds_read_b64_tr_b16 v[210:211], v2 offset:31232
    s_waitcnt lgkmcnt(12)
    v_mfma_f32_32x32x16_bf16 v[176:191], v[136:139], v[212:215], v[176:191]
    ds_read_b64_tr_b16 v[212:213], v1 offset:32768
    ds_read_b64_tr_b16 v[214:215], v1 offset:33280
    s_waitcnt vmcnt(4) lgkmcnt(12)
    v_mfma_f32_32x32x16_bf16 v[160:175], v[140:143], v[216:219], v[160:175]
    ds_read_b64_tr_b16 v[216:217], v2 offset:32768
    ds_read_b64_tr_b16 v[218:219], v2 offset:33280
    s_waitcnt lgkmcnt(12)
    v_mfma_f32_32x32x16_bf16 v[176:191], v[140:143], v[192:195], v[176:191]
    ds_read_b64_tr_b16 v[192:193], v1 offset:34816
    ds_read_b64_tr_b16 v[194:195], v1 offset:35328
    s_waitcnt vmcnt(3) lgkmcnt(12)
    v_mfma_f32_32x32x16_bf16 v[160:175], v[144:147], v[196:199], v[160:175]
    ds_read_b64_tr_b16 v[196:197], v2 offset:34816
    ds_read_b64_tr_b16 v[198:199], v2 offset:35328
    s_waitcnt lgkmcnt(12)
    v_mfma_f32_32x32x16_bf16 v[176:191], v[144:147], v[200:203], v[176:191]
    s_waitcnt vmcnt(2) lgkmcnt(10)
    v_mfma_f32_32x32x16_bf16 v[160:175], v[148:151], v[204:207], v[160:175]
    s_waitcnt lgkmcnt(8)
    v_mfma_f32_32x32x16_bf16 v[176:191], v[148:151], v[208:211], v[176:191]
    s_waitcnt vmcnt(1) lgkmcnt(6)
    v_mfma_f32_32x32x16_bf16 v[160:175], v[152:155], v[212:215], v[160:175]
    s_waitcnt lgkmcnt(4)
    v_mfma_f32_32x32x16_bf16 v[176:191], v[152:155], v[216:219], v[176:191]
    s_waitcnt vmcnt(0) lgkmcnt(2)
    v_mfma_f32_32x32x16_bf16 v[160:175], v[156:159], v[192:195], v[160:175]
    s_waitcnt lgkmcnt(0)
    v_mfma_f32_32x32x16_bf16 v[176:191], v[156:159], v[196:199], v[176:191]
    s_branch k1_afterM
.p2align 6
k1_M0Y:
    ds_read_b64_tr_b16 v[192:193], v1 offset:0
    ds_read_b64_tr_b16 v[194:195], v1 offset:512
    ds_read_b64_tr_b16 v[196:197], v2 offset:0
    ds_read_b64_tr_b16 v[198:199], v2 offset:512
    ds_read_b64_tr_b16 v[200:201], v1 offset:2048
    ds_read_b64_tr_b16 v[202:203], v1 offset:2560
    ds_read_b64_tr_b16 v[204:205], v2 offset:2048
    ds_read_b64_tr_b16 v[206:207], v2 offset:2560
    ds_read_b64_tr_b16 v[208:209], v1 offset:4096
    ds_read_b64_tr_b16 v[210:211], v1 offset:4608
    ds_read_b64_tr_b16 v[212:213], v2 offset:4096
    ds_read_b64_tr_b16 v[214:215], v2 offset:4608
    ds_read_b64_tr_b16 v[216:217], v1 offset:6144
    ds_read_b64_tr_b16 v[218:219], v1 offset:6656
    s_waitcnt vmcnt(15) lgkmcnt(12)
    v_mfma_f32_32x32x16_bf16 v[160:175], v[16:19], v[192:195], 0
    ds_read_b64_tr_b16 v[192:193], v2 offset:6144
    ds_read_b64_tr_b16 v[194:195], v2 offset:6656
    s_waitcnt lgkmcnt(12)
    v_mfma_f32_32x32x16_bf16 v[176:191], v[16:19], v[196:199], 0
    ds_read_b64_tr_b16 v[196:197], v1 offset:8192
    ds_read_b64_tr_b16 v[198:199], v1 offset:8704
    s_movk_i32 s48, 16384
    buffer_load_dwordx4 v[80:83], v15, s[8:11], s48 offen offset:0
    s_waitcnt vmcnt(15) lgkmcnt(12)
    v_mfma_f32_32x32x16_bf16 v[160:175], v[20:23], v[200:203], v[160:175]
    ds_read_b64_tr_b16 v[200:201], v2 offset:8192
    ds_read_b64_tr_b16 v[202:203], v2 offset:8704
    s_waitcnt lgkmcnt(12)
    v_mfma_f32_32x32x16_bf16 v[176:191], v[20:23], v[204:207], v[176:191]
    ds_read_b64_tr_b16 v[204:205], v1 offset:10240
    ds_read_b64_tr_b16 v[206:207], v1 offset:10752
    buffer_load_dwordx4 v[84:87], v15, s[8:11], s48 offen offset:1024
    s_waitcnt vmcnt(15) lgkmcnt(12)
    v_mfma_f32_32x32x16_bf16 v[160:175], v[24:27], v[208:211], v[160:175]
    ds_read_b64_tr_b16 v[208:209], v2 offset:10240
    ds_read_b64_tr_b16 v[210:211], v2 offset:10752
    s_waitcnt lgkmcnt(12)
    v_mfma_f32_32x32x16_bf16 v[176:191], v[24:27], v[212:215], v[176:191]
    ds_read_b64_tr_b16 v[212:213], v1 offset:12288
    ds_read_b64_tr_b16 v[214:215], v1 offset:12800
    buffer_load_dwordx4 v[88:91], v15, s[8:11], s48 offen offset:2048
    s_waitcnt vmcnt(15) lgkmcnt(12)
    v_mfma_f32_32x32x16_bf16 v[160:175], v[28:31], v[216:219], v[160:175]
    ds_read_b64_tr_b16 v[216:217], v2 offset:12288
    ds_read_b64_tr_b16 v[218:219], v2 offset:12800
    s_waitcnt lgkmcnt(12)
    v_mfma_f32_32x32x16_bf16 v[176:191], v[28:31], v[192:195], v[176:191]
    ds_read_b64_tr_b16 v[192:193], v1 offset:14336
    ds_read_b64_tr_b16 v[194:195], v1 offset:14848
    buffer_load_dwordx4 v[92:95], v15, s[8:11], s48 offen offset:3072
    s_waitcnt vmcnt(15) lgkmcnt(12)
    v_mfma_f32_32x32x16_bf16 v[160:175], v[32:35], v[196:199], v[160:175]
    ds_read_b64_tr_b16 v[196:197], v2 offset:14336
    ds_read_b64_tr_b16 v[198:199], v2 offset:14848
    s_waitcnt lgkmcnt(12)
    v_mfma_f32_32x32x16_bf16 v[176:191], v[32:35], v[200:203], v[176:191]
    ds_read_b64_tr_b16 v[200:201], v1 offset:16384
    ds_read_b64_tr_b16 v[202:203], v1 offset:16896
    s_movk_i32 s48, 20480
    buffer_load_dwordx4 v[96:99], v15, s[8:11], s48 offen offset:0
    s_waitcnt vmcnt(15) lgkmcnt(12)
    v_mfma_f32_32x32x16_bf16 v[160:175], v[36:39], v[204:207], v[160:175]
    ds_read_b64_tr_b16 v[204:205], v2 offset:16384
    ds_read_b64_tr_b16 v[206:207], v2 offset:16896
    s_waitcnt lgkmcnt(12)
    v_mfma_f32_32x32x16_bf16 v[176:191], v[36:39], v[208:211], v[176:191]
    ds_read_b64_tr_b16 v[208:209], v1 offset:18432
    ds_read_b64_tr_b16 v[210:211], v1 offset:18944
    buffer_load_dwordx4 v[100:103], v15, s[8:11], s48 offen offset:1024
    s_waitcnt vmcnt(15) lgkmcnt(12)
    v_mfma_f32_32x32x16_bf16 v[160:175], v[40:43], v[212:215], v[160:175]
    ds_read_b64_tr_b16 v[212:213], v2 offset:18432
    ds_read_b64_tr_b16 v[214:215], v2 offset:18944
    s_waitcnt lgkmcnt(12)
    v_mfma_f32_32x32x16_bf16 v[176:191], v[40:43], v[216:219], v[176:191]
    ds_read_b64_tr_b16 v[216:217], v1 offset:20480
    ds_read_b64_tr_b16 v[218:219], v1 offset:20992
    buffer_load_dwordx4 v[104:107], v15, s[8:11], s48 offen offset:2048
    s_waitcnt vmcnt(15) lgkmcnt(12)
    v_mfma_f32_32x32x16_bf16 v[160:175], v[44:47], v[192:195], v[160:175]
    ds_read_b64_tr_b16 v[192:193], v2 offset:20480
    ds_read_b64_tr_b16 v[194:195], v2 offset:20992
    s_waitcnt lgkmcnt(12)
    v_mfma_f32_32x32x16_bf16 v[176:191], v[44:47], v[196:199], v[176:191]
    ds_read_b64_tr_b16 v[196:197], v1 offset:22528
    ds_read_b64_tr_b16 v[198:199], v1 offset:23040
    buffer_load_dwordx4 v[108:111], v15, s[8:11], s48 offen offset:3072
    s_waitcnt vmcnt(15) lgkmcnt(12)
    v_mfma_f32_32x32x16_bf16 v[160:175], v[48:51], v[200:203], v[160:175]
    ds_read_b64_tr_b16 v[200:201], v2 offset:22528
    ds_read_b64_tr_b16 v[202:203], v2 offset:23040
    s_waitcnt lgkmcnt(12)
    v_mfma_f32_32x32x16_bf16 v[176:191], v[48:51], v[204:207], v[176:191]
    ds_read_b64_tr_b16 v[204:205], v1 offset:24576
    ds_read_b64_tr_b16 v[206:207], v1 offset:25088
    s_movk_i32 s48, 24576
    buffer_load_dwordx4 v[112:115], v15, s[8:11], s48 offen offset:0
    s_waitcnt vmcnt(15) lgkmcnt(12)
    v_mfma_f32_32x32x16_bf16 v[160:175], v[52:55], v[208:211], v[160:175]
    ds_read_b64_tr_b16 v[208:209], v2 offset:24576
    ds_read_b64_tr_b16 v[210:211], v2 offset:25088
    s_waitcnt lgkmcnt(12)
    v_mfma_f32_32x32x16_bf16 v[176:191], v[52:55], v[212:215], v[176:191]
    ds_read_b64_tr_b16 v[212:213], v1 offset:26624
    ds_read_b64_tr_b16 v[214:215], v1 offset:27136
    buffer_load_dwordx4 v[116:119], v15, s[8:11], s48 offen offset:1024
    s_waitcnt vmcnt(15) lgkmcnt(12)
    v_mfma_f32_32x32x16_bf16 v[160:175], v[56:59], v[216:219], v[160:175]
    ds_read_b64_tr_b16 v[216:217], v2 offset:26624
    ds_read_b64_tr_b16 v[218:219], v2 offset:27136
    s_waitcnt lgkmcnt(12)
    v_mfma_f32_32x32x16_bf16 v[176:191], v[56:59], v[192:195], v[176:191]
    ds_read_b64_tr_b16 v[192:193], v1 offset:28672
    ds_read_b64_tr_b16 v[194:195], v1 offset:29184
    buffer_load_dwordx4 v[120:123], v15, s[8:11], s48 offen offset:2048
    s_waitcnt vmcnt(15) lgkmcnt(12)
    v_mfma_f32_32x32x16_bf16 v[160:175], v[60:63], v[196:199], v[160:175]
    ds_read_b64_tr_b16 v[196:197], v2 offset:28672
    ds_read_b64_tr_b16 v[198:199], v2 offset:29184
    s_waitcnt lgkmcnt(12)
    v_mfma_f32_32x32x16_bf16 v[176:191], v[60:63], v[200:203], v[176:191]
    ds_read_b64_tr_b16 v[200:201], v1 offset:30720
    ds_read_b64_tr_b16 v[202:203], v1 offset:31232
    buffer_load_dwordx4 v[124:127], v15, s[8:11], s48 offen offset:3072
    s_waitcnt vmcnt(15) lgkmcnt(12)
    v_mfma_f32_32x32x16_bf16 v[160:175], v[64:67], v[204:207], v[160:175]
    ds_read_b64_tr_b16 v[204:205], v2 offset:30720
    ds_read_b64_tr_b16 v[206:207], v2 offset:31232
    s_waitcnt lgkmcnt(12)
    v_mfma_f32_32x32x16_bf16 v[176:191], v[64:67], v[208:211], v[176:191]
    ds_read_b64_tr_b16 v[208:209], v1 offset:32768
    ds_read_b64_tr_b16 v[210:211], v1 offset:33280
    s_movk_i32 s48, 28672
    buffer_load_dwordx4 v[128:131], v15, s[8:11], s48 offen offset:0
    s_waitcnt vmcnt(15) lgkmcnt(12)
    v_mfma_f32_32x32x16_bf16 v[160:175], v[68:71], v[212:215], v[160:175]
    ds_read_b64_tr_b16 v[212:213], v2 offset:32768
    ds_read_b64_tr_b16 v[214:215], v2 offset:33280
    s_waitcnt lgkmcnt(12)
    v_mfma_f32_32x32x16_bf16 v[176:191], v[68:71], v[216:219], v[176:191]
    ds_read_b64_tr_b16 v[216:217], v1 offset:34816
    ds_read_b64_tr_b16 v[218:219], v1 offset:35328
    buffer_load_dwordx4 v[132:135], v15, s[8:11], s48 offen offset:1024
    s_waitcnt vmcnt(15) lgkmcnt(12)
    v_mfma_f32_32x32x16_bf16 v[160:175], v[72:75], v[192:195], v[160:175]
    ds_read_b64_tr_b16 v[192:193], v2 offset:34816
    ds_read_b64_tr_b16 v[194:195], v2 offset:35328
    s_waitcnt lgkmcnt(12)
    v_mfma_f32_32x32x16_bf16 v[176:191], v[72:75], v[196:199], v[176:191]
    v_add_u32 v1, 0x9000, v1
    v_add_u32 v2, 0x9000, v2
    ds_read_b64_tr_b16 v[196:197], v1 offset:0
    ds_read_b64_tr_b16 v[198:199], v1 offset:512
    buffer_load_dwordx4 v[136:139], v15, s[8:11], s48 offen offset:2048
    s_waitcnt vmcnt(15) lgkmcnt(12)
    v_mfma_f32_32x32x16_bf16 v[160:175], v[76:79], v[200:203], v[160:175]
    ds_read_b64_tr_b16 v[200:201], v2 offset:0
    ds_read_b64_tr_b16 v[202:203], v2 offset:512
    s_waitcnt lgkmcnt(12)
    v_mfma_f32_32x32x16_bf16 v[176:191], v[76:79], v[204:207], v[176:191]
    ds_read_b64_tr_b16 v[204:205], v1 offset:2048
    ds_read_b64_tr_b16 v[206:207], v1 offset:2560
    buffer_load_dwordx4 v[140:143], v15, s[8:11], s48 offen offset:3072
    s_waitcnt vmcnt(15) lgkmcnt(12)
    v_mfma_f32_32x32x16_bf16 v[160:175], v[80:83], v[208:211], v[160:175]
    ds_read_b64_tr_b16 v[208:209], v2 offset:2048
    ds_read_b64_tr_b16 v[210:211], v2 offset:2560
    s_waitcnt lgkmcnt(12)
    v_mfma_f32_32x32x16_bf16 v[176:191], v[80:83], v[212:215], v[176:191]
    ds_read_b64_tr_b16 v[212:213], v1 offset:4096
    ds_read_b64_tr_b16 v[214:215], v1 offset:4608
    s_mov_b32 s48, 32768
    buffer_load_dwordx4 v[144:147], v15, s[8:11], s48 offen offset:0
    s_waitcnt vmcnt(15) lgkmcnt(12)
    v_mfma_f32_32x32x16_bf16 v[160:175], v[84:87], v[216:219], v[160:175]
    ds_read_b64_tr_b16 v[216:217], v2 offset:4096
    ds_read_b64_tr_b16 v[218:219], v2 offset:4608
    s_waitcnt lgkmcnt(12)
    v_mfma_f32_32x32x16_bf16 v[176:191], v[84:87], v[192:195], v[176:191]
    ds_read_b64_tr_b16 v[192:193], v1 offset:6144
    ds_read_b64_tr_b16 v[194:195], v1 offset:6656
    buffer_load_dwordx4 v[148:151], v15, s[8:11], s48 offen offset:1024
    s_waitcnt vmcnt(15) lgkmcnt(12)
    v_mfma_f32_32x32x16_bf16 v[160:175], v[88:91], v[196:199], v[160:175]
    ds_read_b64_tr_b16 v[196:197], v2 offset:6144
    ds_read_b64_tr_b16 v[198:199], v2 offset:6656
    s_waitcnt lgkmcnt(12)
    v_mfma_f32_32x32x16_bf16 v[176:191], v[88:91], v[200:203], v[176:191]
    ds_read_b64_tr_b16 v[200:201], v1 offset:8192
    ds_read_b64_tr_b16 v[202:203], v1 offset:8704
    buffer_load_dwordx4 v[152:155], v15, s[8:11], s48 offen offset:2048
    s_waitcnt vmcnt(15) lgkmcnt(12)
    v_mfma_f32_32x32x16_bf16 v[160:175], v[92:95], v[204:207], v[160:175]
    ds_read_b64_tr_b16 v[204:205], v2 offset:8192
    ds_read_b64_tr_b16 v[206:207], v2 offset:8704
    s_waitcnt lgkmcnt(12)
    v_mfma_f32_32x32x16_bf16 v[176:191], v[92:95], v[208:211], v[176:191]
    ds_read_b64_tr_b16 v[208:209], v1 offset:10240
    ds_read_b64_tr_b16 v[210:211], v1 offset:10752
    buffer_load_dwordx4 v[156:159], v15, s[8:11], s48 offen offset:3072
    s_waitcnt vmcnt(15) lgkmcnt(12)
    v_mfma_f32_32x32x16_bf16 v[160:175], v[96:99], v[212:215], v[160:175]
    ds_read_b64_tr_b16 v[212:213], v2 offset:10240
    ds_read_b64_tr_b16 v[214:215], v2 offset:10752
    buffer_load_dwordx4 v3, s[24:27], s31 offen lds
    s_add_u32 m0, m0, 4096
    s_add_u32 s31, s31, s30
    s_waitcnt lgkmcnt(12)
    v_mfma_f32_32x32x16_bf16 v[176:191], v[96:99], v[216:219], v[176:191]
    ds_read_b64_tr_b16 v[216:217], v1 offset:12288
    ds_read_b64_tr_b16 v[218:219], v1 offset:12800
    buffer_load_dwordx4 v3, s[24:27], s31 offen lds
    s_add_u32 m0, m0, 4096
    s_add_u32 s31, s31, s30
    s_waitcnt vmcnt(16) lgkmcnt(12)
    v_mfma_f32_32x32x16_bf16 v[160:175], v[100:103], v[192:195], v[160:175]
    ds_read_b64_tr_b16 v[192:193], v2 offset:12288
    ds_read_b64_tr_b16 v[194:195], v2 offset:12800
    buffer_load_dwordx4 v3, s[24:27], s31 offen lds
    s_add_u32 m0, m0, 4096
    s_add_u32 s31, s31, s30
    s_waitcnt lgkmcnt(12)
    v_mfma_f32_32x32x16_bf16 v[176:191], v[100:103], v[196:199], v[176:191]
    ds_read_b64_tr_b16 v[196:197], v1 offset:14336
    ds_read_b64_tr_b16 v[198:199], v1 offset:14848
    buffer_load_dwordx4 v3, s[24:27], s31 offen lds
    s_add_u32 m0, m0, 4096
    s_add_u32 s31, s31, s30
    s_waitcnt vmcnt(17) lgkmcnt(12)
    v_mfma_f32_32x32x16_bf16 v[160:175], v[104:107], v[200:203], v[160:175]
    ds_read_b64_tr_b16 v[200:201], v2 offset:14336
    ds_read_b64_tr_b16 v[202:203], v2 offset:14848
    buffer_load_dwordx4 v3, s[24:27], s31 offen lds
    s_add_u32 m0, m0, 4096
    s_add_u32 s31, s31, s30
    s_waitcnt lgkmcnt(12)
    v_mfma_f32_32x32x16_bf16 v[176:191], v[104:107], v[204:207], v[176:191]
    ds_read_b64_tr_b16 v[204:205], v1 offset:16384
    ds_read_b64_tr_b16 v[206:207], v1 offset:16896
    buffer_load_dwordx4 v3, s[24:27], s31 offen lds
    s_add_u32 m0, m0, 4096
    s_add_u32 s31, s31, s30
    s_waitcnt vmcnt(18) lgkmcnt(12)
    v_mfma_f32_32x32x16_bf16 v[160:175], v[108:111], v[208:211], v[160:175]
    ds_read_b64_tr_b16 v[208:209], v2 offset:16384
    ds_read_b64_tr_b16 v[210:211], v2 offset:16896
    buffer_load_dwordx4 v3, s[24:27], s31 offen lds
    s_add_u32 m0, m0, 4096
    s_add_u32 s31, s31, s30
    s_waitcnt lgkmcnt(12)
    v_mfma_f32_32x32x16_bf16 v[176:191], v[108:111], v[212:215], v[176:191]
    ds_read_b64_tr_b16 v[212:213], v1 offset:18432
    ds_read_b64_tr_b16 v[214:215], v1 offset:18944
    buffer_load_dwordx4 v3, s[24:27], s31 offen lds
    s_add_u32 m0, m0, 4096
    s_add_u32 s31, s31, s30
    s_waitcnt vmcnt(19) lgkmcnt(12)
    v_mfma_f32_32x32x16_bf16 v[160:175], v[112:115], v[216:219], v[160:175]
    ds_read_b64_tr_b16 v[216:217], v2 offset:18432
    ds_read_b64_tr_b16 v[218:219], v2 offset:18944
    buffer_load_dwordx4 v3, s[24:27], s31 offen lds
    s_add_u32 m0, m0, 4096
    s_add_u32 s31, s31, s30
    s_waitcnt lgkmcnt(12)
    v_mfma_f32_32x32x16_bf16 v[176:191], v[112:115], v[192:195], v[176:191]
    ds_read_b64_tr_b16 v[192:193], v1 offset:20480
    ds_read_b64_tr_b16 v[194:195], v1 offset:20992
    buffer_load_dwordx4 v3, s[24:27], s31 offen lds
    s_add_u32 m0, m0, 4096
    s_add_u32 s31, s31, s30
    s_waitcnt vmcnt(20) lgkmcnt(12)
    v_mfma_f32_32x32x16_bf16 v[160:175], v[116:119], v[196:199], v[160:175]
    ds_read_b64_tr_b16 v[196:197], v2 offset:20480
    ds_read_b64_tr_b16 v[198:199], v2 offset:20992
    buffer_load_dwordx4 v3, s[24:27], s31 offen lds
    s_add_u32 m0, m0, 4096
    s_add_u32 s31, s31, s30
    s_waitcnt lgkmcnt(12)
    v_mfma_f32_32x32x16_bf16 v[176:191], v[116:119], v[200:203], v[176:191]
    ds_read_b64_tr_b16 v[200:201], v1 offset:22528
    ds_read_b64_tr_b16 v[202:203], v1 offset:23040
    buffer_load_dwordx4 v3, s[24:27], s31 offen lds
    s_add_u32 m0, m0, 4096
    s_add_u32 s31, s31, s30
    s_waitcnt vmcnt(21) lgkmcnt(12)
    v_mfma_f32_32x32x16_bf16 v[160:175], v[120:123], v[204:207], v[160:175]
    ds_read_b64_tr_b16 v[204:205], v2 offset:22528
    ds_read_b64_tr_b16 v[206:207], v2 offset:23040
    buffer_load_dwordx4 v3, s[24:27], s31 offen lds
    s_add_u32 m0, m0, 4096
    s_add_u32 s31, s31, s30
    s_waitcnt lgkmcnt(12)
    v_mfma_f32_32x32x16_bf16 v[176:191], v[120:123], v[208:211], v[176:191]
    ds_read_b64_tr_b16 v[208:209], v1 offset:24576
    ds_read_b64_tr_b16 v[210:211], v1 offset:25088
    buffer_load_dwordx4 v3, s[24:27], s31 offen lds
    s_add_u32 m0, m0, 4096
    s_add_u32 s31, s31, s30
    s_waitcnt vmcnt(22) lgkmcnt(12)
    v_mfma_f32_32x32x16_bf16 v[160:175], v[124:127], v[212:215], v[160:175]
    ds_read_b64_tr_b16 v[212:213], v2 offset:24576
    ds_read_b64_tr_b16 v[214:215], v2 offset:25088
    buffer_load_dwordx4 v3, s[24:27], s31 offen lds
    s_add_u32 m0, m0, 4096
    s_add_u32 s31, s31, s30
    s_waitcnt lgkmcnt(12)
    v_mfma_f32_32x32x16_bf16 v[176:191], v[124:127], v[216:219], v[176:191]
    ds_read_b64_tr_b16 v[216:217], v1 offset:26624
    ds_read_b64_tr_b16 v[218:219], v1 offset:27136
    buffer_load_dwordx4 v3, s[24:27], s31 offen lds
    s_add_u32 m0, m0, 4096
    s_add_u32 s31, s31, s30
    s_waitcnt vmcnt(23) lgkmcnt(12)
    v_mfma_f32_32x32x16_bf16 v[160:175], v[128:131], v[192:195], v[160:175]
    ds_read_b64_tr_b16 v[192:193], v2 offset:26624
    ds_read_b64_tr_b16 v[194:195], v2 offset:27136
    buffer_load_dwordx4 v3, s[24:27], s31 offen lds
    s_add_u32 m0, m0, 4096
    s_add_u32 s31, s31, s30
    s_waitcnt lgkmcnt(12)
    v_mfma_f32_32x32x16_bf16 v[176:191], v[128:131], v[196:199], v[176:191]
    ds_read_b64_tr_b16 v[196:197], v1 offset:28672
    ds_read_b64_tr_b16 v[198:199], v1 offset:29184
    buffer_load_dwordx4 v3, s[24:27], s31 offen lds
    s_add_u32 m0, m0, 4096
    s_add_u32 s31, s31, s30
    s_waitcnt vmcnt(24) lgkmcnt(12)
    v_mfma_f32_32x32x16_bf16 v[160:175], v[132:135], v[200:203], v[160:175]
    ds_read_b64_tr_b16 v[200:201], v2 offset:28672
    ds_read_b64_tr_b16 v[202:203], v2 offset:29184
    s_waitcnt lgkmcnt(12)
    v_mfma_f32_32x32x16_bf16 v[176:191], v[132:135], v[204:207], v[176:191]
    ds_read_b64_tr_b16 v[204:205], v1 offset:30720
    ds_read_b64_tr_b16 v[206:207], v1 offset:31232
    s_waitcnt vmcnt(23) lgkmcnt(12)
    v_mfma_f32_32x32x16_bf16 v[160:175], v[136:139], v[208:211], v[160:175]
    ds_read_b64_tr_b16 v[208:209], v2 offset:30720
    ds_read_b64_tr_b16 v[210:211], v2 offset:31232
    s_waitcnt lgkmcnt(12)
    v_mfma_f32_32x32x16_bf16 v[176:191], v[136:139], v[212:215], v[176:191]
    ds_read_b64_tr_b16 v[212:213], v1 offset:32768
    ds_read_b64_tr_b16 v[214:215], v1 offset:33280
    s_waitcnt vmcnt(22) lgkmcnt(12)
    v_mfma_f32_32x32x16_bf16 v[160:175], v[140:143], v[216:219], v[160:175]
    ds_read_b64_tr_b16 v[216:217], v2 offset:32768
    ds_read_b64_tr_b16 v[218:219], v2 offset:33280
    s_waitcnt lgkmcnt(12)
    v_mfma_f32_32x32x16_bf16 v[176:191], v[140:143], v[192:195], v[176:191]
    ds_read_b64_tr_b16 v[192:193], v1 offset:34816
    ds_read_b64_tr_b16 v[194:195], v1 offset:35328
    s_waitcnt vmcnt(21) lgkmcnt(12)
    v_mfma_f32_32x32x16_bf16 v[160:175], v[144:147], v[196:199], v[160:175]
    ds_read_b64_tr_b16 v[196:197], v2 offset:34816
    ds_read_b64_tr_b16 v[198:199], v2 offset:35328
    s_waitcnt lgkmcnt(12)
    v_mfma_f32_32x32x16_bf16 v[176:191], v[144:147], v[200:203], v[176:191]
    s_waitcnt vmcnt(20) lgkmcnt(10)
    v_mfma_f32_32x32x16_bf16 v[160:175], v[148:151], v[204:207], v[160:175]
    s_waitcnt lgkmcnt(8)
    v_mfma_f32_32x32x16_bf16 v[176:191], v[148:151], v[208:211], v[176:191]
    s_waitcnt vmcnt(19) lgkmcnt(6)
    v_mfma_f32_32x32x16_bf16 v[160:175], v[152:155], v[212:215], v[160:175]
    s_waitcnt lgkmcnt(4)
    v_mfma_f32_32x32x16_bf16 v[176:191], v[152:155], v[216:219], v[176:191]
    s_waitcnt vmcnt(18) lgkmcnt(2)
    v_mfma_f32_32x32x16_bf16 v[160:175], v[156:159], v[192:195], v[160:175]
    s_waitcnt lgkmcnt(0)
    v_mfma_f32_32x32x16_bf16 v[176:191], v[156:159], v[196:199], v[176:191]
    s_branch k1_afterM
.p2align 6
k1_MN:
    ds_read_b64_tr_b16 v[192:193], v1 offset:0
    ds_read_b64_tr_b16 v[194:195], v1 offset:512
    ds_read_b64_tr_b16 v[196:197], v2 offset:0
    ds_read_b64_tr_b16 v[198:199], v2 offset:512
    ds_read_b64_tr_b16 v[200:201], v1 offset:2048
    ds_read_b64_tr_b16 v[202:203], v1 offset:2560
    ds_read_b64_tr_b16 v[204:205], v2 offset:2048
    ds_read_b64_tr_b16 v[206:207], v2 offset:2560
    ds_read_b64_tr_b16 v[208:209], v1 offset:4096
    ds_read_b64_tr_b16 v[210:211], v1 offset:4608
    ds_read_b64_tr_b16 v[212:213], v2 offset:4096
    ds_read_b64_tr_b16 v[214:215], v2 offset:4608
    ds_read_b64_tr_b16 v[216:217], v1 offset:6144
    ds_read_b64_tr_b16 v[218:219], v1 offset:6656
    s_waitcnt lgkmcnt(12)
    v_mfma_f32_32x32x16_bf16 v[160:175], v[16:19], v[192:195], 0
    ds_read_b64_tr_b16 v[192:193], v2 offset:6144
    ds_read_b64_tr_b16 v[194:195], v2 offset:6656
    s_waitcnt lgkmcnt(12)
    v_mfma_f32_32x32x16_bf16 v[176:191], v[16:19], v[196:199], 0
    ds_read_b64_tr_b16 v[196:197], v1 offset:8192
    ds_read_b64_tr_b16 v[198:199], v1 offset:8704
    s_waitcnt lgkmcnt(12)
    v_mfma_f32_32x32x16_bf16 v[160:175], v[20:23], v[200:203], v[160:175]
    ds_read_b64_tr_b16 v[200:201], v2 offset:8192
    ds_read_b64_tr_b16 v[202:203], v2 offset:8704
    s_waitcnt lgkmcnt(12)
    v_mfma_f32_32x32x16_bf16 v[176:191], v[20:23], v[204:207], v[176:191]
    ds_read_b64_tr_b16 v[204:205], v1 offset:10240
    ds_read_b64_tr_b16 v[206:207], v1 offset:10752
    s_waitcnt lgkmcnt(12)
    v_mfma_f32_32x32x16_bf16 v[160:175], v[24:27], v[208:211], v[160:175]
    ds_read_b64_tr_b16 v[208:209], v2 offset:10240
    ds_read_b64_tr_b16 v[210:211], v2 offset:10752
    s_waitcnt lgkmcnt(12)
    v_mfma_f32_32x32x16_bf16 v[176:191], v[24:27], v[212:215], v[176:191]
    ds_read_b64_tr_b16 v[212:213], v1 offset:12288
    ds_read_b64_tr_b16 v[214:215], v1 offset:12800
    s_waitcnt lgkmcnt(12)
    v_mfma_f32_32x32x16_bf16 v[160:175], v[28:31], v[216:219], v[160:175]
    ds_read_b64_tr_b16 v[216:217], v2 offset:12288
    ds_read_b64_tr_b16 v[218:219], v2 offset:12800
    s_waitcnt lgkmcnt(12)
    v_mfma_f32_32x32x16_bf16 v[176:191], v[28:31], v[192:195], v[176:191]
    ds_read_b64_tr_b16 v[192:193], v1 offset:14336
    ds_read_b64_tr_b16 v[194:195], v1 offset:14848
    s_waitcnt lgkmcnt(12)
    v_mfma_f32_32x32x16_bf16 v[160:175], v[32:35], v[196:199], v[160:175]
    ds_read_b64_tr_b16 v[196:197], v2 offset:14336
    ds_read_b64_tr_b16 v[198:199], v2 offset:14848
    s_waitcnt lgkmcnt(12)
    v_mfma_f32_32x32x16_bf16 v[176:191], v[32:35], v[200:203], v[176:191]
    ds_read_b64_tr_b16 v[200:201], v1 offset:16384
    ds_read_b64_tr_b16 v[202:203], v1 offset:16896
    s_waitcnt lgkmcnt(12)
    v_mfma_f32_32x32x16_bf16 v[160:175], v[36:39], v[204:207], v[160:175]
    ds_read_b64_tr_b16 v[204:205], v2 offset:16384
    ds_read_b64_tr_b16 v[206:207], v2 offset:16896
    s_waitcnt lgkmcnt(12)
    v_mfma_f32_32x32x16_bf16 v[176:191], v[36:39], v[208:211], v[176:191]
    ds_read_b64_tr_b16 v[208:209], v1 offset:18432
    ds_read_b64_tr_b16 v[210:211], v1 offset:18944
    s_waitcnt lgkmcnt(12)
    v_mfma_f32_32x32x16_bf16 v[160:175], v[40:43], v[212:215], v[160:175]
    ds_read_b64_tr_b16 v[212:213], v2 offset:18432
    ds_read_b64_tr_b16 v[214:215], v2 offset:18944
    s_waitcnt lgkmcnt(12)
    v_mfma_f32_32x32x16_bf16 v[176:191], v[40:43], v[216:219], v[176:191]
    ds_read_b64_tr_b16 v[216:217], v1 offset:20480
    ds_read_b64_tr_b16 v[218:219], v1 offset:20992
    s_waitcnt lgkmcnt(12)
    v_mfma_f32_32x32x16_bf16 v[160:175], v[44:47], v[192:195], v[160:175]
    ds_read_b64_tr_b16 v[192:193], v2 offset:20480
    ds_read_b64_tr_b16 v[194:195], v2 offset:20992
    s_waitcnt lgkmcnt(12)
    v_mfma_f32_32x32x16_bf16 v[176:191], v[44:47], v[196:199], v[176:191]
    ds_read_b64_tr_b16 v[196:197], v1 offset:22528
    ds_read_b64_tr_b16 v[198:199], v1 offset:23040
    s_waitcnt lgkmcnt(12)
    v_mfma_f32_32x32x16_bf16 v[160:175], v[48:51], v[200:203], v[160:175]
    ds_read_b64_tr_b16 v[200:201], v2 offset:22528
    ds_read_b64_tr_b16 v[202:203], v2 offset:23040
    s_waitcnt lgkmcnt(12)
    v_mfma_f32_32x32x16_bf16 v[176:191], v[48:51], v[204:207], v[176:191]
    ds_read_b64_tr_b16 v[204:205], v1 offset:24576
    ds_read_b64_tr_b16 v[206:207], v1 offset:25088
    s_waitcnt lgkmcnt(12)
    v_mfma_f32_32x32x16_bf16 v[160:175], v[52:55], v[208:211], v[160:175]
    ds_read_b64_tr_b16 v[208:209], v2 offset:24576
    ds_read_b64_tr_b16 v[210:211], v2 offset:25088
    s_waitcnt lgkmcnt(12)
    v_mfma_f32_32x32x16_bf16 v[176:191], v[52:55], v[212:215], v[176:191]
    ds_read_b64_tr_b16 v[212:213], v1 offset:26624
    ds_read_b64_tr_b16 v[214:215], v1 offset:27136
    s_waitcnt lgkmcnt(12)
    v_mfma_f32_32x32x16_bf16 v[160:175], v[56:59], v[216:219], v[160:175]
    ds_read_b64_tr_b16 v[216:217], v2 offset:26624
    ds_read_b64_tr_b16 v[218:219], v2 offset:27136
    s_waitcnt lgkmcnt(12)
    v_mfma_f32_32x32x16_bf16 v[176:191], v[56:59], v[192:195], v[176:191]
    ds_read_b64_tr_b16 v[192:193], v1 offset:28672
    ds_read_b64_tr_b16 v[194:195], v1 offset:29184
    s_waitcnt lgkmcnt(12)
    v_mfma_f32_32x32x16_bf16 v[160:175], v[60:63], v[196:199], v[160:175]
    ds_read_b64_tr_b16 v[196:197], v2 offset:28672
    ds_read_b64_tr_b16 v[198:199], v2 offset:29184
    s_waitcnt lgkmcnt(12)
    v_mfma_f32_32x32x16_bf16 v[176:191], v[60:63], v[200:203], v[176:191]
    ds_read_b64_tr_b16 v[200:201], v1 offset:30720
    ds_read_b64_tr_b16 v[202:203], v1 offset:31232
    s_waitcnt lgkmcnt(12)
    v_mfma_f32_32x32x16_bf16 v[160:175], v[64:67], v[204:207], v[160:175]
    ds_read_b64_tr_b16 v[204:205], v2 offset:30720
    ds_read_b64_tr_b16 v[206:207], v2 offset:31232
    s_waitcnt lgkmcnt(12)
    v_mfma_f32_32x32x16_bf16 v[176:191], v[64:67], v[208:211], v[176:191]
    ds_read_b64_tr_b16 v[208:209], v1 offset:32768
    ds_read_b64_tr_b16 v[210:211], v1 offset:33280
    s_waitcnt lgkmcnt(12)
    v_mfma_f32_32x32x16_bf16 v[160:175], v[68:71], v[212:215], v[160:175]
    ds_read_b64_tr_b16 v[212:213], v2 offset:32768
    ds_read_b64_tr_b16 v[214:215], v2 offset:33280
    s_waitcnt lgkmcnt(12)
    v_mfma_f32_32x32x16_bf16 v[176:191], v[68:71], v[216:219], v[176:191]
    ds_read_b64_tr_b16 v[216:217], v1 offset:34816
    ds_read_b64_tr_b16 v[218:219], v1 offset:35328
    s_waitcnt lgkmcnt(12)
    v_mfma_f32_32x32x16_bf16 v[160:175], v[72:75], v[192:195], v[160:175]
    ds_read_b64_tr_b16 v[192:193], v2 offset:34816
    ds_read_b64_tr_b16 v[194:195], v2 offset:35328
    s_waitcnt lgkmcnt(12)
    v_mfma_f32_32x32x16_bf16 v[176:191], v[72:75], v[196:199], v[176:191]
    v_add_u32 v1, 0x9000, v1
    v_add_u32 v2, 0x9000, v2
    ds_read_b64_tr_b16 v[196:197], v1 offset:0
    ds_read_b64_tr_b16 v[198:199], v1 offset:512
    s_waitcnt lgkmcnt(12)
    v_mfma_f32_32x32x16_bf16 v[160:175], v[76:79], v[200:203], v[160:175]
    ds_read_b64_tr_b16 v[200:201], v2 offset:0
    ds_read_b64_tr_b16 v[202:203], v2 offset:512
    s_waitcnt lgkmcnt(12)
    v_mfma_f32_32x32x16_bf16 v[176:191], v[76:79], v[204:207], v[176:191]
    ds_read_b64_tr_b16 v[204:205], v1 offset:2048
    ds_read_b64_tr_b16 v[206:207], v1 offset:2560
    s_waitcnt lgkmcnt(12)
    v_mfma_f32_32x32x16_bf16 v[160:175], v[80:83], v[208:211], v[160:175]
    ds_read_b64_tr_b16 v[208:209], v2 offset:2048
    ds_read_b64_tr_b16 v[210:211], v2 offset:2560
    s_waitcnt lgkmcnt(12)
    v_mfma_f32_32x32x16_bf16 v[176:191], v[80:83], v[212:215], v[176:191]
    ds_read_b64_tr_b16 v[212:213], v1 offset:4096
    ds_read_b64_tr_b16 v[214:215], v1 offset:4608
    s_waitcnt lgkmcnt(12)
    v_mfma_f32_32x32x16_bf16 v[160:175], v[84:87], v[216:219], v[160:175]
    ds_read_b64_tr_b16 v[216:217], v2 offset:4096
    ds_read_b64_tr_b16 v[218:219], v2 offset:4608
    s_waitcnt lgkmcnt(12)
    v_mfma_f32_32x32x16_bf16 v[176:191], v[84:87], v[192:195], v[176:191]
    ds_read_b64_tr_b16 v[192:193], v1 offset:6144
    ds_read_b64_tr_b16 v[194:195], v1 offset:6656
    s_waitcnt lgkmcnt(12)
    v_mfma_f32_32x32x16_bf16 v[160:175], v[88:91], v[196:199], v[160:175]
    ds_read_b64_tr_b16 v[196:197], v2 offset:6144
    ds_read_b64_tr_b16 v[198:199], v2 offset:6656
    s_waitcnt lgkmcnt(12)
    v_mfma_f32_32x32x16_bf16 v[176:191], v[88:91], v[200:203], v[176:191]
    ds_read_b64_tr_b16 v[200:201], v1 offset:8192
    ds_read_b64_tr_b16 v[202:203], v1 offset:8704
    s_waitcnt lgkmcnt(12)
    v_mfma_f32_32x32x16_bf16 v[160:175], v[92:95], v[204:207], v[160:175]
    ds_read_b64_tr_b16 v[204:205], v2 offset:8192
    ds_read_b64_tr_b16 v[206:207], v2 offset:8704
    s_waitcnt lgkmcnt(12)
    v_mfma_f32_32x32x16_bf16 v[176:191], v[92:95], v[208:211], v[176:191]
    ds_read_b64_tr_b16 v[208:209], v1 offset:10240
    ds_read_b64_tr_b16 v[210:211], v1 offset:10752
    s_waitcnt lgkmcnt(12)
    v_mfma_f32_32x32x16_bf16 v[160:175], v[96:99], v[212:215], v[160:175]
    ds_read_b64_tr_b16 v[212:213], v2 offset:10240
    ds_read_b64_tr_b16 v[214:215], v2 offset:10752
    s_waitcnt lgkmcnt(12)
    v_mfma_f32_32x32x16_bf16 v[176:191], v[96:99], v[216:219], v[176:191]
    ds_read_b64_tr_b16 v[216:217], v1 offset:12288
    ds_read_b64_tr_b16 v[218:219], v1 offset:12800
    s_waitcnt lgkmcnt(12)
    v_mfma_f32_32x32x16_bf16 v[160:175], v[100:103], v[192:195], v[160:175]
    ds_read_b64_tr_b16 v[192:193], v2 offset:12288
    ds_read_b64_tr_b16 v[194:195], v2 offset:12800
    s_waitcnt lgkmcnt(12)
    v_mfma_f32_32x32x16_bf16 v[176:191], v[100:103], v[196:199], v[176:191]
    ds_read_b64_tr_b16 v[196:197], v1 offset:14336
    ds_read_b64_tr_b16 v[198:199], v1 offset:14848
    s_waitcnt lgkmcnt(12)
    v_mfma_f32_32x32x16_bf16 v[160:175], v[104:107], v[200:203], v[160:175]
    ds_read_b64_tr_b16 v[200:201], v2 offset:14336
    ds_read_b64_tr_b16 v[202:203], v2 offset:14848
    s_waitcnt lgkmcnt(12)
    v_mfma_f32_32x32x16_bf16 v[176:191], v[104:107], v[204:207], v[176:191]
    ds_read_b64_tr_b16 v[204:205], v1 offset:16384
    ds_read_b64_tr_b16 v[206:207], v1 offset:16896
    s_waitcnt lgkmcnt(12)
    v_mfma_f32_32x32x16_bf16 v[160:175], v[108:111], v[208:211], v[160:175]
    ds_read_b64_tr_b16 v[208:209], v2 offset:16384
    ds_read_b64_tr_b16 v[210:211], v2 offset:16896
    s_waitcnt lgkmcnt(12)
    v_mfma_f32_32x32x16_bf16 v[176:191], v[108:111], v[212:215], v[176:191]
    ds_read_b64_tr_b16 v[212:213], v1 offset:18432
    ds_read_b64_tr_b16 v[214:215], v1 offset:18944
    s_waitcnt lgkmcnt(12)
    v_mfma_f32_32x32x16_bf16 v[160:175], v[112:115], v[216:219], v[160:175]
    ds_read_b64_tr_b16 v[216:217], v2 offset:18432
    ds_read_b64_tr_b16 v[218:219], v2 offset:18944
    s_waitcnt lgkmcnt(12)
    v_mfma_f32_32x32x16_bf16 v[176:191], v[112:115], v[192:195], v[176:191]
    ds_read_b64_tr_b16 v[192:193], v1 offset:20480
    ds_read_b64_tr_b16 v[194:195], v1 offset:20992
    s_waitcnt lgkmcnt(12)
    v_mfma_f32_32x32x16_bf16 v[160:175], v[116:119], v[196:199], v[160:175]
    ds_read_b64_tr_b16 v[196:197], v2 offset:20480
    ds_read_b64_tr_b16 v[198:199], v2 offset:20992
    s_waitcnt lgkmcnt(12)
    v_mfma_f32_32x32x16_bf16 v[176:191], v[116:119], v[200:203], v[176:191]
    ds_read_b64_tr_b16 v[200:201], v1 offset:22528
    ds_read_b64_tr_b16 v[202:203], v1 offset:23040
    s_waitcnt lgkmcnt(12)
    v_mfma_f32_32x32x16_bf16 v[160:175], v[120:123], v[204:207], v[160:175]
    ds_read_b64_tr_b16 v[204:205], v2 offset:22528
    ds_read_b64_tr_b16 v[206:207], v2 offset:23040
    s_waitcnt lgkmcnt(12)
    v_mfma_f32_32x32x16_bf16 v[176:191], v[120:123], v[208:211], v[176:191]
    ds_read_b64_tr_b16 v[208:209], v1 offset:24576
    ds_read_b64_tr_b16 v[210:211], v1 offset:25088
    s_waitcnt lgkmcnt(12)
    v_mfma_f32_32x32x16_bf16 v[160:175], v[124:127], v[212:215], v[160:175]
    ds_read_b64_tr_b16 v[212:213], v2 offset:24576
    ds_read_b64_tr_b16 v[214:215], v2 offset:25088
    s_waitcnt lgkmcnt(12)
    v_mfma_f32_32x32x16_bf16 v[176:191], v[124:127], v[216:219], v[176:191]
    ds_read_b64_tr_b16 v[216:217], v1 offset:26624
    ds_read_b64_tr_b16 v[218:219], v1 offset:27136
    s_waitcnt lgkmcnt(12)
    v_mfma_f32_32x32x16_bf16 v[160:175], v[128:131], v[192:195], v[160:175]
    ds_read_b64_tr_b16 v[192:193], v2 offset:26624
    ds_read_b64_tr_b16 v[194:195], v2 offset:27136
    s_waitcnt lgkmcnt(12)
    v_mfma_f32_32x32x16_bf16 v[176:191], v[128:131], v[196:199], v[176:191]
    ds_read_b64_tr_b16 v[196:197], v1 offset:28672
    ds_read_b64_tr_b16 v[198:199], v1 offset:29184
    s_waitcnt lgkmcnt(12)
    v_mfma_f32_32x32x16_bf16 v[160:175], v[132:135], v[200:203], v[160:175]
    ds_read_b64_tr_b16 v[200:201], v2 offset:28672
    ds_read_b64_tr_b16 v[202:203], v2 offset:29184
    s_waitcnt lgkmcnt(12)
    v_mfma_f32_32x32x16_bf16 v[176:191], v[132:135], v[204:207], v[176:191]
    ds_read_b64_tr_b16 v[204:205], v1 offset:30720
    ds_read_b64_tr_b16 v[206:207], v1 offset:31232
    s_waitcnt lgkmcnt(12)
    v_mfma_f32_32x32x16_bf16 v[160:175], v[136:139], v[208:211], v[160:175]
    ds_read_b64_tr_b16 v[208:209], v2 offset:30720
    ds_read_b64_tr_b16 v[210:211], v2 offset:31232
    s_waitcnt lgkmcnt(12)
    v_mfma_f32_32x32x16_bf16 v[176:191], v[136:139], v[212:215], v[176:191]
    ds_read_b64_tr_b16 v[212:213], v1 offset:32768
    ds_read_b64_tr_b16 v[214:215], v1 offset:33280
    s_waitcnt lgkmcnt(12)
    v_mfma_f32_32x32x16_bf16 v[160:175], v[140:143], v[216:219], v[160:175]
    ds_read_b64_tr_b16 v[216:217], v2 offset:32768
    ds_read_b64_tr_b16 v[218:219], v2 offset:33280
    s_waitcnt lgkmcnt(12)
    v_mfma_f32_32x32x16_bf16 v[176:191], v[140:143], v[192:195], v[176:191]
    ds_read_b64_tr_b16 v[192:193], v1 offset:34816
    ds_read_b64_tr_b16 v[194:195], v1 offset:35328
    s_waitcnt lgkmcnt(12)
    v_mfma_f32_32x32x16_bf16 v[160:175], v[144:147], v[196:199], v[160:175]
    ds_read_b64_tr_b16 v[196:197], v2 offset:34816
    ds_read_b64_tr_b16 v[198:199], v2 offset:35328
    s_waitcnt lgkmcnt(12)
    v_mfma_f32_32x32x16_bf16 v[176:191], v[144:147], v[200:203], v[176:191]
    s_waitcnt lgkmcnt(10)
    v_mfma_f32_32x32x16_bf16 v[160:175], v[148:151], v[204:207], v[160:175]
    s_waitcnt lgkmcnt(8)
    v_mfma_f32_32x32x16_bf16 v[176:191], v[148:151], v[208:211], v[176:191]
    s_waitcnt lgkmcnt(6)
    v_mfma_f32_32x32x16_bf16 v[160:175], v[152:155], v[212:215], v[160:175]
    s_waitcnt lgkmcnt(4)
    v_mfma_f32_32x32x16_bf16 v[176:191], v[152:155], v[216:219], v[176:191]
    s_waitcnt lgkmcnt(2)
    v_mfma_f32_32x32x16_bf16 v[160:175], v[156:159], v[192:195], v[160:175]
    s_waitcnt lgkmcnt(0)
    v_mfma_f32_32x32x16_bf16 v[176:191], v[156:159], v[196:199], v[176:191]
    s_branch k1_afterM
.p2align 6
k1_MND:
    ds_read_b64_tr_b16 v[192:193], v1 offset:0
    ds_read_b64_tr_b16 v[194:195], v1 offset:512
    ds_read_b64_tr_b16 v[196:197], v2 offset:0
    ds_read_b64_tr_b16 v[198:199], v2 offset:512
    ds_read_b64_tr_b16 v[200:201], v1 offset:2048
    ds_read_b64_tr_b16 v[202:203], v1 offset:2560
    ds_read_b64_tr_b16 v[204:205], v2 offset:2048
    ds_read_b64_tr_b16 v[206:207], v2 offset:2560
    ds_read_b64_tr_b16 v[208:209], v1 offset:4096
    ds_read_b64_tr_b16 v[210:211], v1 offset:4608
    ds_read_b64_tr_b16 v[212:213], v2 offset:4096
    ds_read_b64_tr_b16 v[214:215], v2 offset:4608
    ds_read_b64_tr_b16 v[216:217], v1 offset:6144
    ds_read_b64_tr_b16 v[218:219], v1 offset:6656
    s_waitcnt lgkmcnt(12)
    v_mfma_f32_32x32x16_bf16 v[160:175], v[16:19], v[192:195], 0
    ds_read_b64_tr_b16 v[192:193], v2 offset:6144
    ds_read_b64_tr_b16 v[194:195], v2 offset:6656
    buffer_load_dwordx4 v3, s[24:27], s31 offen lds
    s_waitcnt lgkmcnt(12)
    v_mfma_f32_32x32x16_bf16 v[176:191], v[16:19], v[196:199], 0
    ds_read_b64_tr_b16 v[196:197], v1 offset:8192
    ds_read_b64_tr_b16 v[198:199], v1 offset:8704
    s_add_u32 m0, m0, 4096
    s_add_u32 s31, s31, s30
    s_waitcnt lgkmcnt(12)
    v_mfma_f32_32x32x16_bf16 v[160:175], v[20:23], v[200:203], v[160:175]
    ds_read_b64_tr_b16 v[200:201], v2 offset:8192
    ds_read_b64_tr_b16 v[202:203], v2 offset:8704
    s_waitcnt lgkmcnt(12)
    v_mfma_f32_32x32x16_bf16 v[176:191], v[20:23], v[204:207], v[176:191]
    ds_read_b64_tr_b16 v[204:205], v1 offset:10240
    ds_read_b64_tr_b16 v[206:207], v1 offset:10752
    buffer_load_dwordx4 v3, s[24:27], s31 offen lds
    s_waitcnt lgkmcnt(12)
    v_mfma_f32_32x32x16_bf16 v[160:175], v[24:27], v[208:211], v[160:175]
    ds_read_b64_tr_b16 v[208:209], v2 offset:10240
    ds_read_b64_tr_b16 v[210:211], v2 offset:10752
    s_add_u32 m0, m0, 4096
    s_add_u32 s31, s31, s30
    s_waitcnt lgkmcnt(12)
    v_mfma_f32_32x32x16_bf16 v[176:191], v[24:27], v[212:215], v[176:191]
    ds_read_b64_tr_b16 v[212:213], v1 offset:12288
    ds_read_b64_tr_b16 v[214:215], v1 offset:12800
    s_waitcnt lgkmcnt(12)
    v_mfma_f32_32x32x16_bf16 v[160:175], v[28:31], v[216:219], v[160:175]
    ds_read_b64_tr_b16 v[216:217], v2 offset:12288
    ds_read_b64_tr_b16 v[218:219], v2 offset:12800
    buffer_load_dwordx4 v3, s[24:27], s31 offen lds
    s_waitcnt lgkmcnt(12)
    v_mfma_f32_32x32x16_bf16 v[176:191], v[28:31], v[192:195], v[176:191]
    ds_read_b64_tr_b16 v[192:193], v1 offset:14336
    ds_read_b64_tr_b16 v[194:195], v1 offset:14848
    s_add_u32 m0, m0, 4096
    s_add_u32 s31, s31, s30
    s_waitcnt lgkmcnt(12)
    v_mfma_f32_32x32x16_bf16 v[160:175], v[32:35], v[196:199], v[160:175]
    ds_read_b64_tr_b16 v[196:197], v2 offset:14336
    ds_read_b64_tr_b16 v[198:199], v2 offset:14848
    s_waitcnt lgkmcnt(12)
    v_mfma_f32_32x32x16_bf16 v[176:191], v[32:35], v[200:203], v[176:191]
    ds_read_b64_tr_b16 v[200:201], v1 offset:16384
    ds_read_b64_tr_b16 v[202:203], v1 offset:16896
    buffer_load_dwordx4 v3, s[24:27], s31 offen lds
    s_waitcnt lgkmcnt(12)
    v_mfma_f32_32x32x16_bf16 v[160:175], v[36:39], v[204:207], v[160:175]
    ds_read_b64_tr_b16 v[204:205], v2 offset:16384
    ds_read_b64_tr_b16 v[206:207], v2 offset:16896
    s_add_u32 m0, m0, 4096
    s_add_u32 s31, s31, s30
    s_waitcnt lgkmcnt(12)
    v_mfma_f32_32x32x16_bf16 v[176:191], v[36:39], v[208:211], v[176:191]
    ds_read_b64_tr_b16 v[208:209], v1 offset:18432
    ds_read_b64_tr_b16 v[210:211], v1 offset:18944
    s_waitcnt lgkmcnt(12)
    v_mfma_f32_32x32x16_bf16 v[160:175], v[40:43], v[212:215], v[160:175]
    ds_read_b64_tr_b16 v[212:213], v2 offset:18432
    ds_read_b64_tr_b16 v[214:215], v2 offset:18944
    buffer_load_dwordx4 v3, s[24:27], s31 offen lds
    s_waitcnt lgkmcnt(12)
    v_mfma_f32_32x32x16_bf16 v[176:191], v[40:43], v[216:219], v[176:191]
    ds_read_b64_tr_b16 v[216:217], v1 offset:20480
    ds_read_b64_tr_b16 v[218:219], v1 offset:20992
    s_add_u32 m0, m0, 4096
    s_add_u32 s31, s31, s30
    s_waitcnt lgkmcnt(12)
    v_mfma_f32_32x32x16_bf16 v[160:175], v[44:47], v[192:195], v[160:175]
    ds_read_b64_tr_b16 v[192:193], v2 offset:20480
    ds_read_b64_tr_b16 v[194:195], v2 offset:20992
    s_waitcnt lgkmcnt(12)
    v_mfma_f32_32x32x16_bf16 v[176:191], v[44:47], v[196:199], v[176:191]
    ds_read_b64_tr_b16 v[196:197], v1 offset:22528
    ds_read_b64_tr_b16 v[198:199], v1 offset:23040
    buffer_load_dwordx4 v3, s[24:27], s31 offen lds
    s_waitcnt lgkmcnt(12)
    v_mfma_f32_32x32x16_bf16 v[160:175], v[48:51], v[200:203], v[160:175]
    ds_read_b64_tr_b16 v[200:201], v2 offset:22528
    ds_read_b64_tr_b16 v[202:203], v2 offset:23040
    s_add_u32 m0, m0, 4096
    s_add_u32 s31, s31, s30
    s_waitcnt lgkmcnt(12)
    v_mfma_f32_32x32x16_bf16 v[176:191], v[48:51], v[204:207], v[176:191]
    ds_read_b64_tr_b16 v[204:205], v1 offset:24576
    ds_read_b64_tr_b16 v[206:207], v1 offset:25088
    s_waitcnt lgkmcnt(12)
    v_mfma_f32_32x32x16_bf16 v[160:175], v[52:55], v[208:211], v[160:175]
    ds_read_b64_tr_b16 v[208:209], v2 offset:24576
    ds_read_b64_tr_b16 v[210:211], v2 offset:25088
    buffer_load_dwordx4 v3, s[24:27], s31 offen lds
    s_waitcnt lgkmcnt(12)
    v_mfma_f32_32x32x16_bf16 v[176:191], v[52:55], v[212:215], v[176:191]
    ds_read_b64_tr_b16 v[212:213], v1 offset:26624
    ds_read_b64_tr_b16 v[214:215], v1 offset:27136
    s_add_u32 m0, m0, 4096
    s_add_u32 s31, s31, s30
    s_waitcnt lgkmcnt(12)
    v_mfma_f32_32x32x16_bf16 v[160:175], v[56:59], v[216:219], v[160:175]
    ds_read_b64_tr_b16 v[216:217], v2 offset:26624
    ds_read_b64_tr_b16 v[218:219], v2 offset:27136
    s_waitcnt lgkmcnt(12)
    v_mfma_f32_32x32x16_bf16 v[176:191], v[56:59], v[192:195], v[176:191]
    ds_read_b64_tr_b16 v[192:193], v1 offset:28672
    ds_read_b64_tr_b16 v[194:195], v1 offset:29184
    buffer_load_dwordx4 v3, s[24:27], s31 offen lds
    s_waitcnt lgkmcnt(12)
    v_mfma_f32_32x32x16_bf16 v[160:175], v[60:63], v[196:199], v[160:175]
    ds_read_b64_tr_b16 v[196:197], v2 offset:28672
    ds_read_b64_tr_b16 v[198:199], v2 offset:29184
    s_add_u32 m0, m0, 4096
    s_add_u32 s31, s31, s30
    s_waitcnt lgkmcnt(12)
    v_mfma_f32_32x32x16_bf16 v[176:191], v[60:63], v[200:203], v[176:191]
    ds_read_b64_tr_b16 v[200:201], v1 offset:30720
    ds_read_b64_tr_b16 v[202:203], v1 offset:31232
    s_waitcnt lgkmcnt(12)
    v_mfma_f32_32x32x16_bf16 v[160:175], v[64:67], v[204:207], v[160:175]
    ds_read_b64_tr_b16 v[204:205], v2 offset:30720
    ds_read_b64_tr_b16 v[206:207], v2 offset:31232
    buffer_load_dwordx4 v3, s[24:27], s31 offen lds
    s_waitcnt lgkmcnt(12)
    v_mfma_f32_32x32x16_bf16 v[176:191], v[64:67], v[208:211], v[176:191]
    ds_read_b64_tr_b16 v[208:209], v1 offset:32768
    ds_read_b64_tr_b16 v[210:211], v1 offset:33280
    s_add_u32 m0, m0, 4096
    s_add_u32 s31, s31, s30
    s_waitcnt lgkmcnt(12)
    v_mfma_f32_32x32x16_bf16 v[160:175], v[68:71], v[212:215], v[160:175]
    ds_read_b64_tr_b16 v[212:213], v2 offset:32768
    ds_read_b64_tr_b16 v[214:215], v2 offset:33280
    s_waitcnt lgkmcnt(12)
    v_mfma_f32_32x32x16_bf16 v[176:191], v[68:71], v[216:219], v[176:191]
    ds_read_b64_tr_b16 v[216:217], v1 offset:34816
    ds_read_b64_tr_b16 v[218:219], v1 offset:35328
    buffer_load_dwordx4 v3, s[24:27], s31 offen lds
    s_waitcnt lgkmcnt(12)
    v_mfma_f32_32x32x16_bf16 v[160:175], v[72:75], v[192:195], v[160:175]
    ds_read_b64_tr_b16 v[192:193], v2 offset:34816
    ds_read_b64_tr_b16 v[194:195], v2 offset:35328
    s_add_u32 m0, m0, 4096
    s_add_u32 s31, s31, s30
    s_waitcnt lgkmcnt(12)
    v_mfma_f32_32x32x16_bf16 v[176:191], v[72:75], v[196:199], v[176:191]
    v_add_u32 v1, 0x9000, v1
    v_add_u32 v2, 0x9000, v2
    ds_read_b64_tr_b16 v[196:197], v1 offset:0
    ds_read_b64_tr_b16 v[198:199], v1 offset:512
    s_waitcnt lgkmcnt(12)
    v_mfma_f32_32x32x16_bf16 v[160:175], v[76:79], v[200:203], v[160:175]
    ds_read_b64_tr_b16 v[200:201], v2 offset:0
    ds_read_b64_tr_b16 v[202:203], v2 offset:512
    buffer_load_dwordx4 v3, s[24:27], s31 offen lds
    s_waitcnt lgkmcnt(12)
    v_mfma_f32_32x32x16_bf16 v[176:191], v[76:79], v[204:207], v[176:191]
    ds_read_b64_tr_b16 v[204:205], v1 offset:2048
    ds_read_b64_tr_b16 v[206:207], v1 offset:2560
    s_add_u32 m0, m0, 4096
    s_add_u32 s31, s31, s30
    s_waitcnt lgkmcnt(12)
    v_mfma_f32_32x32x16_bf16 v[160:175], v[80:83], v[208:211], v[160:175]
    ds_read_b64_tr_b16 v[208:209], v2 offset:2048
    ds_read_b64_tr_b16 v[210:211], v2 offset:2560
    s_waitcnt lgkmcnt(12)
    v_mfma_f32_32x32x16_bf16 v[176:191], v[80:83], v[212:215], v[176:191]
    ds_read_b64_tr_b16 v[212:213], v1 offset:4096
    ds_read_b64_tr_b16 v[214:215], v1 offset:4608
    buffer_load_dwordx4 v3, s[24:27], s31 offen lds
    s_waitcnt lgkmcnt(12)
    v_mfma_f32_32x32x16_bf16 v[160:175], v[84:87], v[216:219], v[160:175]
    ds_read_b64_tr_b16 v[216:217], v2 offset:4096
    ds_read_b64_tr_b16 v[218:219], v2 offset:4608
    s_add_u32 m0, m0, 4096
    s_add_u32 s31, s31, s30
    s_waitcnt lgkmcnt(12)
    v_mfma_f32_32x32x16_bf16 v[176:191], v[84:87], v[192:195], v[176:191]
    ds_read_b64_tr_b16 v[192:193], v1 offset:6144
    ds_read_b64_tr_b16 v[194:195], v1 offset:6656
    s_waitcnt lgkmcnt(12)
    v_mfma_f32_32x32x16_bf16 v[160:175], v[88:91], v[196:199], v[160:175]
    ds_read_b64_tr_b16 v[196:197], v2 offset:6144
    ds_read_b64_tr_b16 v[198:199], v2 offset:6656
    buffer_load_dwordx4 v3, s[24:27], s31 offen lds
    s_waitcnt lgkmcnt(12)
    v_mfma_f32_32x32x16_bf16 v[176:191], v[88:91], v[200:203], v[176:191]
    ds_read_b64_tr_b16 v[200:201], v1 offset:8192
    ds_read_b64_tr_b16 v[202:203], v1 offset:8704
    s_add_u32 m0, m0, 4096
    s_add_u32 s31, s31, s30
    s_waitcnt lgkmcnt(12)
    v_mfma_f32_32x32x16_bf16 v[160:175], v[92:95], v[204:207], v[160:175]
    ds_read_b64_tr_b16 v[204:205], v2 offset:8192
    ds_read_b64_tr_b16 v[206:207], v2 offset:8704
    s_waitcnt lgkmcnt(12)
    v_mfma_f32_32x32x16_bf16 v[176:191], v[92:95], v[208:211], v[176:191]
    ds_read_b64_tr_b16 v[208:209], v1 offset:10240
    ds_read_b64_tr_b16 v[210:211], v1 offset:10752
    buffer_load_dwordx4 v3, s[24:27], s31 offen lds
    s_waitcnt lgkmcnt(12)
    v_mfma_f32_32x32x16_bf16 v[160:175], v[96:99], v[212:215], v[160:175]
    ds_read_b64_tr_b16 v[212:213], v2 offset:10240
    ds_read_b64_tr_b16 v[214:215], v2 offset:10752
    s_add_u32 m0, m0, 4096
    s_add_u32 s31, s31, s30
    s_waitcnt lgkmcnt(12)
    v_mfma_f32_32x32x16_bf16 v[176:191], v[96:99], v[216:219], v[176:191]
    ds_read_b64_tr_b16 v[216:217], v1 offset:12288
    ds_read_b64_tr_b16 v[218:219], v1 offset:12800
    s_waitcnt lgkmcnt(12)
    v_mfma_f32_32x32x16_bf16 v[160:175], v[100:103], v[192:195], v[160:175]
    ds_read_b64_tr_b16 v[192:193], v2 offset:12288
    ds_read_b64_tr_b16 v[194:195], v2 offset:12800
    buffer_load_dwordx4 v3, s[24:27], s31 offen lds
    s_waitcnt lgkmcnt(12)
    v_mfma_f32_32x32x16_bf16 v[176:191], v[100:103], v[196:199], v[176:191]
    ds_read_b64_tr_b16 v[196:197], v1 offset:14336
    ds_read_b64_tr_b16 v[198:199], v1 offset:14848
    s_add_u32 m0, m0, 4096
    s_add_u32 s31, s31, s30
    s_waitcnt lgkmcnt(12)
    v_mfma_f32_32x32x16_bf16 v[160:175], v[104:107], v[200:203], v[160:175]
    ds_read_b64_tr_b16 v[200:201], v2 offset:14336
    ds_read_b64_tr_b16 v[202:203], v2 offset:14848
    s_waitcnt lgkmcnt(12)
    v_mfma_f32_32x32x16_bf16 v[176:191], v[104:107], v[204:207], v[176:191]
    ds_read_b64_tr_b16 v[204:205], v1 offset:16384
    ds_read_b64_tr_b16 v[206:207], v1 offset:16896
    buffer_load_dwordx4 v3, s[24:27], s31 offen lds
    s_waitcnt lgkmcnt(12)
    v_mfma_f32_32x32x16_bf16 v[160:175], v[108:111], v[208:211], v[160:175]
    ds_read_b64_tr_b16 v[208:209], v2 offset:16384
    ds_read_b64_tr_b16 v[210:211], v2 offset:16896
    s_add_u32 m0, m0, 4096
    s_add_u32 s31, s31, s30
    s_waitcnt lgkmcnt(12)
    v_mfma_f32_32x32x16_bf16 v[176:191], v[108:111], v[212:215], v[176:191]
    ds_read_b64_tr_b16 v[212:213], v1 offset:18432
    ds_read_b64_tr_b16 v[214:215], v1 offset:18944
    s_waitcnt lgkmcnt(12)
    v_mfma_f32_32x32x16_bf16 v[160:175], v[112:115], v[216:219], v[160:175]
    ds_read_b64_tr_b16 v[216:217], v2 offset:18432
    ds_read_b64_tr_b16 v[218:219], v2 offset:18944
    buffer_load_dwordx4 v3, s[24:27], s31 offen lds
    s_waitcnt lgkmcnt(12)
    v_mfma_f32_32x32x16_bf16 v[176:191], v[112:115], v[192:195], v[176:191]
    ds_read_b64_tr_b16 v[192:193], v1 offset:20480
    ds_read_b64_tr_b16 v[194:195], v1 offset:20992
    s_add_u32 m0, m0, 4096
    s_add_u32 s31, s31, s30
    s_waitcnt lgkmcnt(12)
    v_mfma_f32_32x32x16_bf16 v[160:175], v[116:119], v[196:199], v[160:175]
    ds_read_b64_tr_b16 v[196:197], v2 offset:20480
    ds_read_b64_tr_b16 v[198:199], v2 offset:20992
    s_waitcnt lgkmcnt(12)
    v_mfma_f32_32x32x16_bf16 v[176:191], v[116:119], v[200:203], v[176:191]
    ds_read_b64_tr_b16 v[200:201], v1 offset:22528
    ds_read_b64_tr_b16 v[202:203], v1 offset:23040
    buffer_load_dwordx4 v3, s[24:27], s31 offen lds
    s_waitcnt lgkmcnt(12)
    v_mfma_f32_32x32x16_bf16 v[160:175], v[120:123], v[204:207], v[160:175]
    ds_read_b64_tr_b16 v[204:205], v2 offset:22528
    ds_read_b64_tr_b16 v[206:207], v2 offset:23040
    s_waitcnt lgkmcnt(12)
    v_mfma_f32_32x32x16_bf16 v[176:191], v[120:123], v[208:211], v[176:191]
    ds_read_b64_tr_b16 v[208:209], v1 offset:24576
    ds_read_b64_tr_b16 v[210:211], v1 offset:25088
    s_waitcnt lgkmcnt(12)
    v_mfma_f32_32x32x16_bf16 v[160:175], v[124:127], v[212:215], v[160:175]
    ds_read_b64_tr_b16 v[212:213], v2 offset:24576
    ds_read_b64_tr_b16 v[214:215], v2 offset:25088
    s_waitcnt lgkmcnt(12)
    v_mfma_f32_32x32x16_bf16 v[176:191], v[124:127], v[216:219], v[176:191]
    ds_read_b64_tr_b16 v[216:217], v1 offset:26624
    ds_read_b64_tr_b16 v[218:219], v1 offset:27136
    s_waitcnt lgkmcnt(12)
    v_mfma_f32_32x32x16_bf16 v[160:175], v[128:131], v[192:195], v[160:175]
    ds_read_b64_tr_b16 v[192:193], v2 offset:26624
    ds_read_b64_tr_b16 v[194:195], v2 offset:27136
    s_waitcnt lgkmcnt(12)
    v_mfma_f32_32x32x16_bf16 v[176:191], v[128:131], v[196:199], v[176:191]
    ds_read_b64_tr_b16 v[196:197], v1 offset:28672
    ds_read_b64_tr_b16 v[198:199], v1 offset:29184
    s_waitcnt lgkmcnt(12)
    v_mfma_f32_32x32x16_bf16 v[160:175], v[132:135], v[200:203], v[160:175]
    ds_read_b64_tr_b16 v[200:201], v2 offset:28672
    ds_read_b64_tr_b16 v[202:203], v2 offset:29184
    s_waitcnt lgkmcnt(12)
    v_mfma_f32_32x32x16_bf16 v[176:191], v[132:135], v[204:207], v[176:191]
    ds_read_b64_tr_b16 v[204:205], v1 offset:30720
    ds_read_b64_tr_b16 v[206:207], v1 offset:31232
    s_waitcnt lgkmcnt(12)
    v_mfma_f32_32x32x16_bf16 v[160:175], v[136:139], v[208:211], v[160:175]
    ds_read_b64_tr_b16 v[208:209], v2 offset:30720
    ds_read_b64_tr_b16 v[210:211], v2 offset:31232
    s_waitcnt lgkmcnt(12)
    v_mfma_f32_32x32x16_bf16 v[176:191], v[136:139], v[212:215], v[176:191]
    ds_read_b64_tr_b16 v[212:213], v1 offset:32768
    ds_read_b64_tr_b16 v[214:215], v1 offset:33280
    s_waitcnt lgkmcnt(12)
    v_mfma_f32_32x32x16_bf16 v[160:175], v[140:143], v[216:219], v[160:175]
    ds_read_b64_tr_b16 v[216:217], v2 offset:32768
    ds_read_b64_tr_b16 v[218:219], v2 offset:33280
    s_waitcnt lgkmcnt(12)
    v_mfma_f32_32x32x16_bf16 v[176:191], v[140:143], v[192:195], v[176:191]
    ds_read_b64_tr_b16 v[192:193], v1 offset:34816
    ds_read_b64_tr_b16 v[194:195], v1 offset:35328
    s_waitcnt lgkmcnt(12)
    v_mfma_f32_32x32x16_bf16 v[160:175], v[144:147], v[196:199], v[160:175]
    ds_read_b64_tr_b16 v[196:197], v2 offset:34816
    ds_read_b64_tr_b16 v[198:199], v2 offset:35328
    s_waitcnt lgkmcnt(12)
    v_mfma_f32_32x32x16_bf16 v[176:191], v[144:147], v[200:203], v[176:191]
    s_waitcnt lgkmcnt(10)
    v_mfma_f32_32x32x16_bf16 v[160:175], v[148:151], v[204:207], v[160:175]
    s_waitcnt lgkmcnt(8)
    v_mfma_f32_32x32x16_bf16 v[176:191], v[148:151], v[208:211], v[176:191]
    s_waitcnt lgkmcnt(6)
    v_mfma_f32_32x32x16_bf16 v[160:175], v[152:155], v[212:215], v[160:175]
    s_waitcnt lgkmcnt(4)
    v_mfma_f32_32x32x16_bf16 v[176:191], v[152:155], v[216:219], v[176:191]
    s_waitcnt lgkmcnt(2)
    v_mfma_f32_32x32x16_bf16 v[160:175], v[156:159], v[192:195], v[160:175]
    s_waitcnt lgkmcnt(0)
    v_mfma_f32_32x32x16_bf16 v[176:191], v[156:159], v[196:199], v[176:191]
    s_branch k1_afterM
.p2align 6
k1_MSD:
    ds_read_b64_tr_b16 v[192:193], v1 offset:0
    ds_read_b64_tr_b16 v[194:195], v1 offset:512
    ds_read_b64_tr_b16 v[196:197], v2 offset:0
    ds_read_b64_tr_b16 v[198:199], v2 offset:512
    ds_read_b64_tr_b16 v[200:201], v1 offset:2048
    ds_read_b64_tr_b16 v[202:203], v1 offset:2560
    ds_read_b64_tr_b16 v[204:205], v2 offset:2048
    ds_read_b64_tr_b16 v[206:207], v2 offset:2560
    ds_read_b64_tr_b16 v[208:209], v1 offset:4096
    ds_read_b64_tr_b16 v[210:211], v1 offset:4608
    ds_read_b64_tr_b16 v[212:213], v2 offset:4096
    ds_read_b64_tr_b16 v[214:215], v2 offset:4608
    ds_read_b64_tr_b16 v[216:217], v1 offset:6144
    ds_read_b64_tr_b16 v[218:219], v1 offset:6656
    s_waitcnt lgkmcnt(12)
    v_mfma_f32_32x32x16_bf16 v[160:175], v[192:195], v[16:19], 0
    ds_read_b64_tr_b16 v[192:193], v2 offset:6144
    ds_read_b64_tr_b16 v[194:195], v2 offset:6656
    buffer_load_dwordx4 v3, s[24:27], s31 offen lds
    s_waitcnt lgkmcnt(12)
    v_mfma_f32_32x32x16_bf16 v[176:191], v[196:199], v[16:19], 0
    ds_read_b64_tr_b16 v[196:197], v1 offset:8192
    ds_read_b64_tr_b16 v[198:199], v1 offset:8704
    s_add_u32 m0, m0, 4096
    s_add_u32 s31, s31, s30
    s_waitcnt lgkmcnt(12)
    v_mfma_f32_32x32x16_bf16 v[160:175], v[200:203], v[20:23], v[160:175]
    ds_read_b64_tr_b16 v[200:201], v2 offset:8192
    ds_read_b64_tr_b16 v[202:203], v2 offset:8704
    s_waitcnt lgkmcnt(12)
    v_mfma_f32_32x32x16_bf16 v[176:191], v[204:207], v[20:23], v[176:191]
    ds_read_b64_tr_b16 v[204:205], v1 offset:10240
    ds_read_b64_tr_b16 v[206:207], v1 offset:10752
    buffer_load_dwordx4 v3, s[24:27], s31 offen lds
    s_waitcnt lgkmcnt(12)
    v_mfma_f32_32x32x16_bf16 v[160:175], v[208:211], v[24:27], v[160:175]
    ds_read_b64_tr_b16 v[208:209], v2 offset:10240
    ds_read_b64_tr_b16 v[210:211], v2 offset:10752
    s_add_u32 m0, m0, 4096
    s_add_u32 s31, s31, s30
    s_waitcnt lgkmcnt(12)
    v_mfma_f32_32x32x16_bf16 v[176:191], v[212:215], v[24:27], v[176:191]
    ds_read_b64_tr_b16 v[212:213], v1 offset:12288
    ds_read_b64_tr_b16 v[214:215], v1 offset:12800
    s_waitcnt lgkmcnt(12)
    v_mfma_f32_32x32x16_bf16 v[160:175], v[216:219], v[28:31], v[160:175]
    ds_read_b64_tr_b16 v[216:217], v2 offset:12288
    ds_read_b64_tr_b16 v[218:219], v2 offset:12800
    buffer_load_dwordx4 v3, s[24:27], s31 offen lds
    s_waitcnt lgkmcnt(12)
    v_mfma_f32_32x32x16_bf16 v[176:191], v[192:195], v[28:31], v[176:191]
    ds_read_b64_tr_b16 v[192:193], v1 offset:14336
    ds_read_b64_tr_b16 v[194:195], v1 offset:14848
    s_add_u32 m0, m0, 4096
    s_add_u32 s31, s31, s30
    s_waitcnt lgkmcnt(12)
    v_mfma_f32_32x32x16_bf16 v[160:175], v[196:199], v[32:35], v[160:175]
    ds_read_b64_tr_b16 v[196:197], v2 offset:14336
    ds_read_b64_tr_b16 v[198:199], v2 offset:14848
    s_waitcnt lgkmcnt(12)
    v_mfma_f32_32x32x16_bf16 v[176:191], v[200:203], v[32:35], v[176:191]
    ds_read_b64_tr_b16 v[200:201], v1 offset:16384
    ds_read_b64_tr_b16 v[202:203], v1 offset:16896
    buffer_load_dwordx4 v3, s[24:27], s31 offen lds
    s_waitcnt lgkmcnt(12)
    v_mfma_f32_32x32x16_bf16 v[160:175], v[204:207], v[36:39], v[160:175]
    ds_read_b64_tr_b16 v[204:205], v2 offset:16384
    ds_read_b64_tr_b16 v[206:207], v2 offset:16896
    s_add_u32 m0, m0, 4096
    s_add_u32 s31, s31, s30
    s_waitcnt lgkmcnt(12)
    v_mfma_f32_32x32x16_bf16 v[176:191], v[208:211], v[36:39], v[176:191]
    ds_read_b64_tr_b16 v[208:209], v1 offset:18432
    ds_read_b64_tr_b16 v[210:211], v1 offset:18944
    s_waitcnt lgkmcnt(12)
    v_mfma_f32_32x32x16_bf16 v[160:175], v[212:215], v[40:43], v[160:175]
    ds_read_b64_tr_b16 v[212:213], v2 offset:18432
    ds_read_b64_tr_b16 v[214:215], v2 offset:18944
    buffer_load_dwordx4 v3, s[24:27], s31 offen lds
    s_waitcnt lgkmcnt(12)
    v_mfma_f32_32x32x16_bf16 v[176:191], v[216:219], v[40:43], v[176:191]
    ds_read_b64_tr_b16 v[216:217], v1 offset:20480
    ds_read_b64_tr_b16 v[218:219], v1 offset:20992
    s_add_u32 m0, m0, 4096
    s_add_u32 s31, s31, s30
    s_waitcnt lgkmcnt(12)
    v_mfma_f32_32x32x16_bf16 v[160:175], v[192:195], v[44:47], v[160:175]
    ds_read_b64_tr_b16 v[192:193], v2 offset:20480
    ds_read_b64_tr_b16 v[194:195], v2 offset:20992
    s_waitcnt lgkmcnt(12)
    v_mfma_f32_32x32x16_bf16 v[176:191], v[196:199], v[44:47], v[176:191]
    ds_read_b64_tr_b16 v[196:197], v1 offset:22528
    ds_read_b64_tr_b16 v[198:199], v1 offset:23040
    buffer_load_dwordx4 v3, s[24:27], s31 offen lds
    s_waitcnt lgkmcnt(12)
    v_mfma_f32_32x32x16_bf16 v[160:175], v[200:203], v[48:51], v[160:175]
    ds_read_b64_tr_b16 v[200:201], v2 offset:22528
    ds_read_b64_tr_b16 v[202:203], v2 offset:23040
    s_add_u32 m0, m0, 4096
    s_add_u32 s31, s31, s30
    s_waitcnt lgkmcnt(12)
    v_mfma_f32_32x32x16_bf16 v[176:191], v[204:207], v[48:51], v[176:191]
    ds_read_b64_tr_b16 v[204:205], v1 offset:24576
    ds_read_b64_tr_b16 v[206:207], v1 offset:25088
    s_waitcnt lgkmcnt(12)
    v_mfma_f32_32x32x16_bf16 v[160:175], v[208:211], v[52:55], v[160:175]
    ds_read_b64_tr_b16 v[208:209], v2 offset:24576
    ds_read_b64_tr_b16 v[210:211], v2 offset:25088
    buffer_load_dwordx4 v3, s[24:27], s31 offen lds
    s_waitcnt lgkmcnt(12)
    v_mfma_f32_32x32x16_bf16 v[176:191], v[212:215], v[52:55], v[176:191]
    ds_read_b64_tr_b16 v[212:213], v1 offset:26624
    ds_read_b64_tr_b16 v[214:215], v1 offset:27136
    s_add_u32 m0, m0, 4096
    s_add_u32 s31, s31, s30
    s_waitcnt lgkmcnt(12)
    v_mfma_f32_32x32x16_bf16 v[160:175], v[216:219], v[56:59], v[160:175]
    ds_read_b64_tr_b16 v[216:217], v2 offset:26624
    ds_read_b64_tr_b16 v[218:219], v2 offset:27136
    s_waitcnt lgkmcnt(12)
    v_mfma_f32_32x32x16_bf16 v[176:191], v[192:195], v[56:59], v[176:191]
    ds_read_b64_tr_b16 v[192:193], v1 offset:28672
    ds_read_b64_tr_b16 v[194:195], v1 offset:29184
    buffer_load_dwordx4 v3, s[24:27], s31 offen lds
    s_waitcnt lgkmcnt(12)
    v_mfma_f32_32x32x16_bf16 v[160:175], v[196:199], v[60:63], v[160:175]
    ds_read_b64_tr_b16 v[196:197], v2 offset:28672
    ds_read_b64_tr_b16 v[198:199], v2 offset:29184
    s_add_u32 m0, m0, 4096
    s_add_u32 s31, s31, s30
    s_waitcnt lgkmcnt(12)
    v_mfma_f32_32x32x16_bf16 v[176:191], v[200:203], v[60:63], v[176:191]
    ds_read_b64_tr_b16 v[200:201], v1 offset:30720
    ds_read_b64_tr_b16 v[202:203], v1 offset:31232
    s_waitcnt lgkmcnt(12)
    v_mfma_f32_32x32x16_bf16 v[160:175], v[204:207], v[64:67], v[160:175]
    ds_read_b64_tr_b16 v[204:205], v2 offset:30720
    ds_read_b64_tr_b16 v[206:207], v2 offset:31232
    buffer_load_dwordx4 v3, s[24:27], s31 offen lds
    s_waitcnt lgkmcnt(12)
    v_mfma_f32_32x32x16_bf16 v[176:191], v[208:211], v[64:67], v[176:191]
    ds_read_b64_tr_b16 v[208:209], v1 offset:32768
    ds_read_b64_tr_b16 v[210:211], v1 offset:33280
    s_add_u32 m0, m0, 4096
    s_add_u32 s31, s31, s30
    s_waitcnt lgkmcnt(12)
    v_mfma_f32_32x32x16_bf16 v[160:175], v[212:215], v[68:71], v[160:175]
    ds_read_b64_tr_b16 v[212:213], v2 offset:32768
    ds_read_b64_tr_b16 v[214:215], v2 offset:33280
    s_waitcnt lgkmcnt(12)
    v_mfma_f32_32x32x16_bf16 v[176:191], v[216:219], v[68:71], v[176:191]
    ds_read_b64_tr_b16 v[216:217], v1 offset:34816
    ds_read_b64_tr_b16 v[218:219], v1 offset:35328
    buffer_load_dwordx4 v3, s[24:27], s31 offen lds
    s_waitcnt lgkmcnt(12)
    v_mfma_f32_32x32x16_bf16 v[160:175], v[192:195], v[72:75], v[160:175]
    ds_read_b64_tr_b16 v[192:193], v2 offset:34816
    ds_read_b64_tr_b16 v[194:195], v2 offset:35328
    s_add_u32 m0, m0, 4096
    s_add_u32 s31, s31, s30
    s_waitcnt lgkmcnt(12)
    v_mfma_f32_32x32x16_bf16 v[176:191], v[196:199], v[72:75], v[176:191]
    v_add_u32 v1, 0x9000, v1
    v_add_u32 v2, 0x9000, v2
    ds_read_b64_tr_b16 v[196:197], v1 offset:0
    ds_read_b64_tr_b16 v[198:199], v1 offset:512
    s_waitcnt lgkmcnt(12)
    v_mfma_f32_32x32x16_bf16 v[160:175], v[200:203], v[76:79], v[160:175]
    ds_read_b64_tr_b16 v[200:201], v2 offset:0
    ds_read_b64_tr_b16 v[202:203], v2 offset:512
    buffer_load_dwordx4 v3, s[24:27], s31 offen lds
    s_waitcnt lgkmcnt(12)
    v_mfma_f32_32x32x16_bf16 v[176:191], v[204:207], v[76:79], v[176:191]
    ds_read_b64_tr_b16 v[204:205], v1 offset:2048
    ds_read_b64_tr_b16 v[206:207], v1 offset:2560
    s_add_u32 m0, m0, 4096
    s_add_u32 s31, s31, s30
    s_waitcnt lgkmcnt(12)
    v_mfma_f32_32x32x16_bf16 v[160:175], v[208:211], v[80:83], v[160:175]
    ds_read_b64_tr_b16 v[208:209], v2 offset:2048
    ds_read_b64_tr_b16 v[210:211], v2 offset:2560
    s_waitcnt lgkmcnt(12)
    v_mfma_f32_32x32x16_bf16 v[176:191], v[212:215], v[80:83], v[176:191]
    ds_read_b64_tr_b16 v[212:213], v1 offset:4096
    ds_read_b64_tr_b16 v[214:215], v1 offset:4608
    buffer_load_dwordx4 v3, s[24:27], s31 offen lds
    s_waitcnt lgkmcnt(12)
    v_mfma_f32_32x32x16_bf16 v[160:175], v[216:219], v[84:87], v[160:175]
    ds_read_b64_tr_b16 v[216:217], v2 offset:4096
    ds_read_b64_tr_b16 v[218:219], v2 offset:4608
    s_add_u32 m0, m0, 4096
    s_add_u32 s31, s31, s30
    s_waitcnt lgkmcnt(12)
    v_mfma_f32_32x32x16_bf16 v[176:191], v[192:195], v[84:87], v[176:191]
    ds_read_b64_tr_b16 v[192:193], v1 offset:6144
    ds_read_b64_tr_b16 v[194:195], v1 offset:6656
    s_waitcnt lgkmcnt(12)
    v_mfma_f32_32x32x16_bf16 v[160:175], v[196:199], v[88:91], v[160:175]
    ds_read_b64_tr_b16 v[196:197], v2 offset:6144
    ds_read_b64_tr_b16 v[198:199], v2 offset:6656
    buffer_load_dwordx4 v3, s[24:27], s31 offen lds
    s_waitcnt lgkmcnt(12)
    v_mfma_f32_32x32x16_bf16 v[176:191], v[200:203], v[88:91], v[176:191]
    ds_read_b64_tr_b16 v[200:201], v1 offset:8192
    ds_read_b64_tr_b16 v[202:203], v1 offset:8704
    s_add_u32 m0, m0, 4096
    s_add_u32 s31, s31, s30
    s_waitcnt lgkmcnt(12)
    v_mfma_f32_32x32x16_bf16 v[160:175], v[204:207], v[92:95], v[160:175]
    ds_read_b64_tr_b16 v[204:205], v2 offset:8192
    ds_read_b64_tr_b16 v[206:207], v2 offset:8704
    s_waitcnt lgkmcnt(12)
    v_mfma_f32_32x32x16_bf16 v[176:191], v[208:211], v[92:95], v[176:191]
    ds_read_b64_tr_b16 v[208:209], v1 offset:10240
    ds_read_b64_tr_b16 v[210:211], v1 offset:10752
    buffer_load_dwordx4 v3, s[24:27], s31 offen lds
    s_waitcnt lgkmcnt(12)
    v_mfma_f32_32x32x16_bf16 v[160:175], v[212:215], v[96:99], v[160:175]
    ds_read_b64_tr_b16 v[212:213], v2 offset:10240
    ds_read_b64_tr_b16 v[214:215], v2 offset:10752
    s_add_u32 m0, m0, 4096
    s_add_u32 s31, s31, s30
    s_waitcnt lgkmcnt(12)
    v_mfma_f32_32x32x16_bf16 v[176:191], v[216:219], v[96:99], v[176:191]
    ds_read_b64_tr_b16 v[216:217], v1 offset:12288
    ds_read_b64_tr_b16 v[218:219], v1 offset:12800
    s_waitcnt lgkmcnt(12)
    v_mfma_f32_32x32x16_bf16 v[160:175], v[192:195], v[100:103], v[160:175]
    ds_read_b64_tr_b16 v[192:193], v2 offset:12288
    ds_read_b64_tr_b16 v[194:195], v2 offset:12800
    buffer_load_dwordx4 v3, s[24:27], s31 offen lds
    s_waitcnt lgkmcnt(12)
    v_mfma_f32_32x32x16_bf16 v[176:191], v[196:199], v[100:103], v[176:191]
    ds_read_b64_tr_b16 v[196:197], v1 offset:14336
    ds_read_b64_tr_b16 v[198:199], v1 offset:14848
    s_add_u32 m0, m0, 4096
    s_add_u32 s31, s31, s30
    s_waitcnt lgkmcnt(12)
    v_mfma_f32_32x32x16_bf16 v[160:175], v[200:203], v[104:107], v[160:175]
    ds_read_b64_tr_b16 v[200:201], v2 offset:14336
    ds_read_b64_tr_b16 v[202:203], v2 offset:14848
    s_waitcnt lgkmcnt(12)
    v_mfma_f32_32x32x16_bf16 v[176:191], v[204:207], v[104:107], v[176:191]
    ds_read_b64_tr_b16 v[204:205], v1 offset:16384
    ds_read_b64_tr_b16 v[206:207], v1 offset:16896
    buffer_load_dwordx4 v3, s[24:27], s31 offen lds
    s_waitcnt lgkmcnt(12)
    v_mfma_f32_32x32x16_bf16 v[160:175], v[208:211], v[108:111], v[160:175]
    ds_read_b64_tr_b16 v[208:209], v2 offset:16384
    ds_read_b64_tr_b16 v[210:211], v2 offset:16896
    s_add_u32 m0, m0, 4096
    s_add_u32 s31, s31, s30
    s_waitcnt lgkmcnt(12)
    v_mfma_f32_32x32x16_bf16 v[176:191], v[212:215], v[108:111], v[176:191]
    ds_read_b64_tr_b16 v[212:213], v1 offset:18432
    ds_read_b64_tr_b16 v[214:215], v1 offset:18944
    s_waitcnt lgkmcnt(12)
    v_mfma_f32_32x32x16_bf16 v[160:175], v[216:219], v[112:115], v[160:175]
    ds_read_b64_tr_b16 v[216:217], v2 offset:18432
    ds_read_b64_tr_b16 v[218:219], v2 offset:18944
    buffer_load_dwordx4 v3, s[24:27], s31 offen lds
    s_waitcnt lgkmcnt(12)
    v_mfma_f32_32x32x16_bf16 v[176:191], v[192:195], v[112:115], v[176:191]
    ds_read_b64_tr_b16 v[192:193], v1 offset:20480
    ds_read_b64_tr_b16 v[194:195], v1 offset:20992
    s_add_u32 m0, m0, 4096
    s_add_u32 s31, s31, s30
    s_waitcnt lgkmcnt(12)
    v_mfma_f32_32x32x16_bf16 v[160:175], v[196:199], v[116:119], v[160:175]
    ds_read_b64_tr_b16 v[196:197], v2 offset:20480
    ds_read_b64_tr_b16 v[198:199], v2 offset:20992
    s_waitcnt lgkmcnt(12)
    v_mfma_f32_32x32x16_bf16 v[176:191], v[200:203], v[116:119], v[176:191]
    ds_read_b64_tr_b16 v[200:201], v1 offset:22528
    ds_read_b64_tr_b16 v[202:203], v1 offset:23040
    buffer_load_dwordx4 v3, s[24:27], s31 offen lds
    s_waitcnt lgkmcnt(12)
    v_mfma_f32_32x32x16_bf16 v[160:175], v[204:207], v[120:123], v[160:175]
    ds_read_b64_tr_b16 v[204:205], v2 offset:22528
    ds_read_b64_tr_b16 v[206:207], v2 offset:23040
    s_waitcnt lgkmcnt(12)
    v_mfma_f32_32x32x16_bf16 v[176:191], v[208:211], v[120:123], v[176:191]
    ds_read_b64_tr_b16 v[208:209], v1 offset:24576
    ds_read_b64_tr_b16 v[210:211], v1 offset:25088
    s_waitcnt lgkmcnt(12)
    v_mfma_f32_32x32x16_bf16 v[160:175], v[212:215], v[124:127], v[160:175]
    ds_read_b64_tr_b16 v[212:213], v2 offset:24576
    ds_read_b64_tr_b16 v[214:215], v2 offset:25088
    s_waitcnt lgkmcnt(12)
    v_mfma_f32_32x32x16_bf16 v[176:191], v[216:219], v[124:127], v[176:191]
    ds_read_b64_tr_b16 v[216:217], v1 offset:26624
    ds_read_b64_tr_b16 v[218:219], v1 offset:27136
    s_waitcnt lgkmcnt(12)
    v_mfma_f32_32x32x16_bf16 v[160:175], v[192:195], v[128:131], v[160:175]
    ds_read_b64_tr_b16 v[192:193], v2 offset:26624
    ds_read_b64_tr_b16 v[194:195], v2 offset:27136
    s_waitcnt lgkmcnt(12)
    v_mfma_f32_32x32x16_bf16 v[176:191], v[196:199], v[128:131], v[176:191]
    ds_read_b64_tr_b16 v[196:197], v1 offset:28672
    ds_read_b64_tr_b16 v[198:199], v1 offset:29184
    s_waitcnt lgkmcnt(12)
    v_mfma_f32_32x32x16_bf16 v[160:175], v[200:203], v[132:135], v[160:175]
    ds_read_b64_tr_b16 v[200:201], v2 offset:28672
    ds_read_b64_tr_b16 v[202:203], v2 offset:29184
    s_waitcnt lgkmcnt(12)
    v_mfma_f32_32x32x16_bf16 v[176:191], v[204:207], v[132:135], v[176:191]
    ds_read_b64_tr_b16 v[204:205], v1 offset:30720
    ds_read_b64_tr_b16 v[206:207], v1 offset:31232
    s_waitcnt lgkmcnt(12)
    v_mfma_f32_32x32x16_bf16 v[160:175], v[208:211], v[136:139], v[160:175]
    ds_read_b64_tr_b16 v[208:209], v2 offset:30720
    ds_read_b64_tr_b16 v[210:211], v2 offset:31232
    s_waitcnt lgkmcnt(12)
    v_mfma_f32_32x32x16_bf16 v[176:191], v[212:215], v[136:139], v[176:191]
    ds_read_b64_tr_b16 v[212:213], v1 offset:32768
    ds_read_b64_tr_b16 v[214:215], v1 offset:33280
    s_waitcnt lgkmcnt(12)
    v_mfma_f32_32x32x16_bf16 v[160:175], v[216:219], v[140:143], v[160:175]
    ds_read_b64_tr_b16 v[216:217], v2 offset:32768
    ds_read_b64_tr_b16 v[218:219], v2 offset:33280
    s_waitcnt lgkmcnt(12)
    v_mfma_f32_32x32x16_bf16 v[176:191], v[192:195], v[140:143], v[176:191]
    ds_read_b64_tr_b16 v[192:193], v1 offset:34816
    ds_read_b64_tr_b16 v[194:195], v1 offset:35328
    s_waitcnt lgkmcnt(12)
    v_mfma_f32_32x32x16_bf16 v[160:175], v[196:199], v[144:147], v[160:175]
    ds_read_b64_tr_b16 v[196:197], v2 offset:34816
    ds_read_b64_tr_b16 v[198:199], v2 offset:35328
    s_waitcnt lgkmcnt(12)
    v_mfma_f32_32x32x16_bf16 v[176:191], v[200:203], v[144:147], v[176:191]
    s_waitcnt lgkmcnt(10)
    v_mfma_f32_32x32x16_bf16 v[160:175], v[204:207], v[148:151], v[160:175]
    s_waitcnt lgkmcnt(8)
    v_mfma_f32_32x32x16_bf16 v[176:191], v[208:211], v[148:151], v[176:191]
    s_waitcnt lgkmcnt(6)
    v_mfma_f32_32x32x16_bf16 v[160:175], v[212:215], v[152:155], v[160:175]
    s_waitcnt lgkmcnt(4)
    v_mfma_f32_32x32x16_bf16 v[176:191], v[216:219], v[152:155], v[176:191]
    s_waitcnt lgkmcnt(2)
    v_mfma_f32_32x32x16_bf16 v[160:175], v[192:195], v[156:159], v[160:175]
    s_waitcnt lgkmcnt(0)
    v_mfma_f32_32x32x16_bf16 v[176:191], v[196:199], v[156:159], v[176:191]
    s_branch k1_afterM
.p2align 6
k1_MS:
    ds_read_b64_tr_b16 v[192:193], v1 offset:0
    ds_read_b64_tr_b16 v[194:195], v1 offset:512
    ds_read_b64_tr_b16 v[196:197], v2 offset:0
    ds_read_b64_tr_b16 v[198:199], v2 offset:512
    ds_read_b64_tr_b16 v[200:201], v1 offset:2048
    ds_read_b64_tr_b16 v[202:203], v1 offset:2560
    ds_read_b64_tr_b16 v[204:205], v2 offset:2048
    ds_read_b64_tr_b16 v[206:207], v2 offset:2560
    ds_read_b64_tr_b16 v[208:209], v1 offset:4096
    ds_read_b64_tr_b16 v[210:211], v1 offset:4608
    ds_read_b64_tr_b16 v[212:213], v2 offset:4096
    ds_read_b64_tr_b16 v[214:215], v2 offset:4608
    ds_read_b64_tr_b16 v[216:217], v1 offset:6144
    ds_read_b64_tr_b16 v[218:219], v1 offset:6656
    s_waitcnt lgkmcnt(12)
    v_mfma_f32_32x32x16_bf16 v[160:175], v[192:195], v[16:19], 0
    ds_read_b64_tr_b16 v[192:193], v2 offset:6144
    ds_read_b64_tr_b16 v[194:195], v2 offset:6656
    s_waitcnt lgkmcnt(12)
    v_mfma_f32_32x32x16_bf16 v[176:191], v[196:199], v[16:19], 0
    ds_read_b64_tr_b16 v[196:197], v1 offset:8192
    ds_read_b64_tr_b16 v[198:199], v1 offset:8704
    s_waitcnt lgkmcnt(12)
    v_mfma_f32_32x32x16_bf16 v[160:175], v[200:203], v[20:23], v[160:175]
    ds_read_b64_tr_b16 v[200:201], v2 offset:8192
    ds_read_b64_tr_b16 v[202:203], v2 offset:8704
    s_waitcnt lgkmcnt(12)
    v_mfma_f32_32x32x16_bf16 v[176:191], v[204:207], v[20:23], v[176:191]
    ds_read_b64_tr_b16 v[204:205], v1 offset:10240
    ds_read_b64_tr_b16 v[206:207], v1 offset:10752
    s_waitcnt lgkmcnt(12)
    v_mfma_f32_32x32x16_bf16 v[160:175], v[208:211], v[24:27], v[160:175]
    ds_read_b64_tr_b16 v[208:209], v2 offset:10240
    ds_read_b64_tr_b16 v[210:211], v2 offset:10752
    s_waitcnt lgkmcnt(12)
    v_mfma_f32_32x32x16_bf16 v[176:191], v[212:215], v[24:27], v[176:191]
    ds_read_b64_tr_b16 v[212:213], v1 offset:12288
    ds_read_b64_tr_b16 v[214:215], v1 offset:12800
    s_waitcnt lgkmcnt(12)
    v_mfma_f32_32x32x16_bf16 v[160:175], v[216:219], v[28:31], v[160:175]
    ds_read_b64_tr_b16 v[216:217], v2 offset:12288
    ds_read_b64_tr_b16 v[218:219], v2 offset:12800
    s_waitcnt lgkmcnt(12)
    v_mfma_f32_32x32x16_bf16 v[176:191], v[192:195], v[28:31], v[176:191]
    ds_read_b64_tr_b16 v[192:193], v1 offset:14336
    ds_read_b64_tr_b16 v[194:195], v1 offset:14848
    s_waitcnt lgkmcnt(12)
    v_mfma_f32_32x32x16_bf16 v[160:175], v[196:199], v[32:35], v[160:175]
    ds_read_b64_tr_b16 v[196:197], v2 offset:14336
    ds_read_b64_tr_b16 v[198:199], v2 offset:14848
    s_waitcnt lgkmcnt(12)
    v_mfma_f32_32x32x16_bf16 v[176:191], v[200:203], v[32:35], v[176:191]
    ds_read_b64_tr_b16 v[200:201], v1 offset:16384
    ds_read_b64_tr_b16 v[202:203], v1 offset:16896
    s_waitcnt lgkmcnt(12)
    v_mfma_f32_32x32x16_bf16 v[160:175], v[204:207], v[36:39], v[160:175]
    ds_read_b64_tr_b16 v[204:205], v2 offset:16384
    ds_read_b64_tr_b16 v[206:207], v2 offset:16896
    s_waitcnt lgkmcnt(12)
    v_mfma_f32_32x32x16_bf16 v[176:191], v[208:211], v[36:39], v[176:191]
    ds_read_b64_tr_b16 v[208:209], v1 offset:18432
    ds_read_b64_tr_b16 v[210:211], v1 offset:18944
    s_waitcnt lgkmcnt(12)
    v_mfma_f32_32x32x16_bf16 v[160:175], v[212:215], v[40:43], v[160:175]
    ds_read_b64_tr_b16 v[212:213], v2 offset:18432
    ds_read_b64_tr_b16 v[214:215], v2 offset:18944
    s_waitcnt lgkmcnt(12)
    v_mfma_f32_32x32x16_bf16 v[176:191], v[216:219], v[40:43], v[176:191]
    ds_read_b64_tr_b16 v[216:217], v1 offset:20480
    ds_read_b64_tr_b16 v[218:219], v1 offset:20992
    s_waitcnt lgkmcnt(12)
    v_mfma_f32_32x32x16_bf16 v[160:175], v[192:195], v[44:47], v[160:175]
    ds_read_b64_tr_b16 v[192:193], v2 offset:20480
    ds_read_b64_tr_b16 v[194:195], v2 offset:20992
    s_waitcnt lgkmcnt(12)
    v_mfma_f32_32x32x16_bf16 v[176:191], v[196:199], v[44:47], v[176:191]
    ds_read_b64_tr_b16 v[196:197], v1 offset:22528
    ds_read_b64_tr_b16 v[198:199], v1 offset:23040
    s_waitcnt lgkmcnt(12)
    v_mfma_f32_32x32x16_bf16 v[160:175], v[200:203], v[48:51], v[160:175]
    ds_read_b64_tr_b16 v[200:201], v2 offset:22528
    ds_read_b64_tr_b16 v[202:203], v2 offset:23040
    s_waitcnt lgkmcnt(12)
    v_mfma_f32_32x32x16_bf16 v[176:191], v[204:207], v[48:51], v[176:191]
    ds_read_b64_tr_b16 v[204:205], v1 offset:24576
    ds_read_b64_tr_b16 v[206:207], v1 offset:25088
    s_waitcnt lgkmcnt(12)
    v_mfma_f32_32x32x16_bf16 v[160:175], v[208:211], v[52:55], v[160:175]
    ds_read_b64_tr_b16 v[208:209], v2 offset:24576
    ds_read_b64_tr_b16 v[210:211], v2 offset:25088
    s_waitcnt lgkmcnt(12)
    v_mfma_f32_32x32x16_bf16 v[176:191], v[212:215], v[52:55], v[176:191]
    ds_read_b64_tr_b16 v[212:213], v1 offset:26624
    ds_read_b64_tr_b16 v[214:215], v1 offset:27136
    s_waitcnt lgkmcnt(12)
    v_mfma_f32_32x32x16_bf16 v[160:175], v[216:219], v[56:59], v[160:175]
    ds_read_b64_tr_b16 v[216:217], v2 offset:26624
    ds_read_b64_tr_b16 v[218:219], v2 offset:27136
    s_waitcnt lgkmcnt(12)
    v_mfma_f32_32x32x16_bf16 v[176:191], v[192:195], v[56:59], v[176:191]
    ds_read_b64_tr_b16 v[192:193], v1 offset:28672
    ds_read_b64_tr_b16 v[194:195], v1 offset:29184
    s_waitcnt lgkmcnt(12)
    v_mfma_f32_32x32x16_bf16 v[160:175], v[196:199], v[60:63], v[160:175]
    ds_read_b64_tr_b16 v[196:197], v2 offset:28672
    ds_read_b64_tr_b16 v[198:199], v2 offset:29184
    s_waitcnt lgkmcnt(12)
    v_mfma_f32_32x32x16_bf16 v[176:191], v[200:203], v[60:63], v[176:191]
    ds_read_b64_tr_b16 v[200:201], v1 offset:30720
    ds_read_b64_tr_b16 v[202:203], v1 offset:31232
    s_waitcnt lgkmcnt(12)
    v_mfma_f32_32x32x16_bf16 v[160:175], v[204:207], v[64:67], v[160:175]
    ds_read_b64_tr_b16 v[204:205], v2 offset:30720
    ds_read_b64_tr_b16 v[206:207], v2 offset:31232
    s_waitcnt lgkmcnt(12)
    v_mfma_f32_32x32x16_bf16 v[176:191], v[208:211], v[64:67], v[176:191]
    ds_read_b64_tr_b16 v[208:209], v1 offset:32768
    ds_read_b64_tr_b16 v[210:211], v1 offset:33280
    s_waitcnt lgkmcnt(12)
    v_mfma_f32_32x32x16_bf16 v[160:175], v[212:215], v[68:71], v[160:175]
    ds_read_b64_tr_b16 v[212:213], v2 offset:32768
    ds_read_b64_tr_b16 v[214:215], v2 offset:33280
    s_waitcnt lgkmcnt(12)
    v_mfma_f32_32x32x16_bf16 v[176:191], v[216:219], v[68:71], v[176:191]
    ds_read_b64_tr_b16 v[216:217], v1 offset:34816
    ds_read_b64_tr_b16 v[218:219], v1 offset:35328
    s_waitcnt lgkmcnt(12)
    v_mfma_f32_32x32x16_bf16 v[160:175], v[192:195], v[72:75], v[160:175]
    ds_read_b64_tr_b16 v[192:193], v2 offset:34816
    ds_read_b64_tr_b16 v[194:195], v2 offset:35328
    s_waitcnt lgkmcnt(12)
    v_mfma_f32_32x32x16_bf16 v[176:191], v[196:199], v[72:75], v[176:191]
    v_add_u32 v1, 0x9000, v1
    v_add_u32 v2, 0x9000, v2
    ds_read_b64_tr_b16 v[196:197], v1 offset:0
    ds_read_b64_tr_b16 v[198:199], v1 offset:512
    s_waitcnt lgkmcnt(12)
    v_mfma_f32_32x32x16_bf16 v[160:175], v[200:203], v[76:79], v[160:175]
    ds_read_b64_tr_b16 v[200:201], v2 offset:0
    ds_read_b64_tr_b16 v[202:203], v2 offset:512
    s_waitcnt lgkmcnt(12)
    v_mfma_f32_32x32x16_bf16 v[176:191], v[204:207], v[76:79], v[176:191]
    ds_read_b64_tr_b16 v[204:205], v1 offset:2048
    ds_read_b64_tr_b16 v[206:207], v1 offset:2560
    s_waitcnt lgkmcnt(12)
    v_mfma_f32_32x32x16_bf16 v[160:175], v[208:211], v[80:83], v[160:175]
    ds_read_b64_tr_b16 v[208:209], v2 offset:2048
    ds_read_b64_tr_b16 v[210:211], v2 offset:2560
    s_waitcnt lgkmcnt(12)
    v_mfma_f32_32x32x16_bf16 v[176:191], v[212:215], v[80:83], v[176:191]
    ds_read_b64_tr_b16 v[212:213], v1 offset:4096
    ds_read_b64_tr_b16 v[214:215], v1 offset:4608
    s_waitcnt lgkmcnt(12)
    v_mfma_f32_32x32x16_bf16 v[160:175], v[216:219], v[84:87], v[160:175]
    ds_read_b64_tr_b16 v[216:217], v2 offset:4096
    ds_read_b64_tr_b16 v[218:219], v2 offset:4608
    s_waitcnt lgkmcnt(12)
    v_mfma_f32_32x32x16_bf16 v[176:191], v[192:195], v[84:87], v[176:191]
    ds_read_b64_tr_b16 v[192:193], v1 offset:6144
    ds_read_b64_tr_b16 v[194:195], v1 offset:6656
    s_waitcnt lgkmcnt(12)
    v_mfma_f32_32x32x16_bf16 v[160:175], v[196:199], v[88:91], v[160:175]
    ds_read_b64_tr_b16 v[196:197], v2 offset:6144
    ds_read_b64_tr_b16 v[198:199], v2 offset:6656
    s_waitcnt lgkmcnt(12)
    v_mfma_f32_32x32x16_bf16 v[176:191], v[200:203], v[88:91], v[176:191]
    ds_read_b64_tr_b16 v[200:201], v1 offset:8192
    ds_read_b64_tr_b16 v[202:203], v1 offset:8704
    s_waitcnt lgkmcnt(12)
    v_mfma_f32_32x32x16_bf16 v[160:175], v[204:207], v[92:95], v[160:175]
    ds_read_b64_tr_b16 v[204:205], v2 offset:8192
    ds_read_b64_tr_b16 v[206:207], v2 offset:8704
    s_waitcnt lgkmcnt(12)
    v_mfma_f32_32x32x16_bf16 v[176:191], v[208:211], v[92:95], v[176:191]
    ds_read_b64_tr_b16 v[208:209], v1 offset:10240
    ds_read_b64_tr_b16 v[210:211], v1 offset:10752
    s_waitcnt lgkmcnt(12)
    v_mfma_f32_32x32x16_bf16 v[160:175], v[212:215], v[96:99], v[160:175]
    ds_read_b64_tr_b16 v[212:213], v2 offset:10240
    ds_read_b64_tr_b16 v[214:215], v2 offset:10752
    s_waitcnt lgkmcnt(12)
    v_mfma_f32_32x32x16_bf16 v[176:191], v[216:219], v[96:99], v[176:191]
    ds_read_b64_tr_b16 v[216:217], v1 offset:12288
    ds_read_b64_tr_b16 v[218:219], v1 offset:12800
    s_waitcnt lgkmcnt(12)
    v_mfma_f32_32x32x16_bf16 v[160:175], v[192:195], v[100:103], v[160:175]
    ds_read_b64_tr_b16 v[192:193], v2 offset:12288
    ds_read_b64_tr_b16 v[194:195], v2 offset:12800
    s_waitcnt lgkmcnt(12)
    v_mfma_f32_32x32x16_bf16 v[176:191], v[196:199], v[100:103], v[176:191]
    ds_read_b64_tr_b16 v[196:197], v1 offset:14336
    ds_read_b64_tr_b16 v[198:199], v1 offset:14848
    s_waitcnt lgkmcnt(12)
    v_mfma_f32_32x32x16_bf16 v[160:175], v[200:203], v[104:107], v[160:175]
    ds_read_b64_tr_b16 v[200:201], v2 offset:14336
    ds_read_b64_tr_b16 v[202:203], v2 offset:14848
    s_waitcnt lgkmcnt(12)
    v_mfma_f32_32x32x16_bf16 v[176:191], v[204:207], v[104:107], v[176:191]
    ds_read_b64_tr_b16 v[204:205], v1 offset:16384
    ds_read_b64_tr_b16 v[206:207], v1 offset:16896
    s_waitcnt lgkmcnt(12)
    v_mfma_f32_32x32x16_bf16 v[160:175], v[208:211], v[108:111], v[160:175]
    ds_read_b64_tr_b16 v[208:209], v2 offset:16384
    ds_read_b64_tr_b16 v[210:211], v2 offset:16896
    s_waitcnt lgkmcnt(12)
    v_mfma_f32_32x32x16_bf16 v[176:191], v[212:215], v[108:111], v[176:191]
    ds_read_b64_tr_b16 v[212:213], v1 offset:18432
    ds_read_b64_tr_b16 v[214:215], v1 offset:18944
    s_waitcnt lgkmcnt(12)
    v_mfma_f32_32x32x16_bf16 v[160:175], v[216:219], v[112:115], v[160:175]
    ds_read_b64_tr_b16 v[216:217], v2 offset:18432
    ds_read_b64_tr_b16 v[218:219], v2 offset:18944
    s_waitcnt lgkmcnt(12)
    v_mfma_f32_32x32x16_bf16 v[176:191], v[192:195], v[112:115], v[176:191]
    ds_read_b64_tr_b16 v[192:193], v1 offset:20480
    ds_read_b64_tr_b16 v[194:195], v1 offset:20992
    s_waitcnt lgkmcnt(12)
    v_mfma_f32_32x32x16_bf16 v[160:175], v[196:199], v[116:119], v[160:175]
    ds_read_b64_tr_b16 v[196:197], v2 offset:20480
    ds_read_b64_tr_b16 v[198:199], v2 offset:20992
    s_waitcnt lgkmcnt(12)
    v_mfma_f32_32x32x16_bf16 v[176:191], v[200:203], v[116:119], v[176:191]
    ds_read_b64_tr_b16 v[200:201], v1 offset:22528
    ds_read_b64_tr_b16 v[202:203], v1 offset:23040
    s_waitcnt lgkmcnt(12)
    v_mfma_f32_32x32x16_bf16 v[160:175], v[204:207], v[120:123], v[160:175]
    ds_read_b64_tr_b16 v[204:205], v2 offset:22528
    ds_read_b64_tr_b16 v[206:207], v2 offset:23040
    s_waitcnt lgkmcnt(12)
    v_mfma_f32_32x32x16_bf16 v[176:191], v[208:211], v[120:123], v[176:191]
    ds_read_b64_tr_b16 v[208:209], v1 offset:24576
    ds_read_b64_tr_b16 v[210:211], v1 offset:25088
    s_waitcnt lgkmcnt(12)
    v_mfma_f32_32x32x16_bf16 v[160:175], v[212:215], v[124:127], v[160:175]
    ds_read_b64_tr_b16 v[212:213], v2 offset:24576
    ds_read_b64_tr_b16 v[214:215], v2 offset:25088
    s_waitcnt lgkmcnt(12)
    v_mfma_f32_32x32x16_bf16 v[176:191], v[216:219], v[124:127], v[176:191]
    ds_read_b64_tr_b16 v[216:217], v1 offset:26624
    ds_read_b64_tr_b16 v[218:219], v1 offset:27136
    s_waitcnt lgkmcnt(12)
    v_mfma_f32_32x32x16_bf16 v[160:175], v[192:195], v[128:131], v[160:175]
    ds_read_b64_tr_b16 v[192:193], v2 offset:26624
    ds_read_b64_tr_b16 v[194:195], v2 offset:27136
    s_waitcnt lgkmcnt(12)
    v_mfma_f32_32x32x16_bf16 v[176:191], v[196:199], v[128:131], v[176:191]
    ds_read_b64_tr_b16 v[196:197], v1 offset:28672
    ds_read_b64_tr_b16 v[198:199], v1 offset:29184
    s_waitcnt lgkmcnt(12)
    v_mfma_f32_32x32x16_bf16 v[160:175], v[200:203], v[132:135], v[160:175]
    ds_read_b64_tr_b16 v[200:201], v2 offset:28672
    ds_read_b64_tr_b16 v[202:203], v2 offset:29184
    s_waitcnt lgkmcnt(12)
    v_mfma_f32_32x32x16_bf16 v[176:191], v[204:207], v[132:135], v[176:191]
    ds_read_b64_tr_b16 v[204:205], v1 offset:30720
    ds_read_b64_tr_b16 v[206:207], v1 offset:31232
    s_waitcnt lgkmcnt(12)
    v_mfma_f32_32x32x16_bf16 v[160:175], v[208:211], v[136:139], v[160:175]
    ds_read_b64_tr_b16 v[208:209], v2 offset:30720
    ds_read_b64_tr_b16 v[210:211], v2 offset:31232
    s_waitcnt lgkmcnt(12)
    v_mfma_f32_32x32x16_bf16 v[176:191], v[212:215], v[136:139], v[176:191]
    ds_read_b64_tr_b16 v[212:213], v1 offset:32768
    ds_read_b64_tr_b16 v[214:215], v1 offset:33280
    s_waitcnt lgkmcnt(12)
    v_mfma_f32_32x32x16_bf16 v[160:175], v[216:219], v[140:143], v[160:175]
    ds_read_b64_tr_b16 v[216:217], v2 offset:32768
    ds_read_b64_tr_b16 v[218:219], v2 offset:33280
    s_waitcnt lgkmcnt(12)
    v_mfma_f32_32x32x16_bf16 v[176:191], v[192:195], v[140:143], v[176:191]
    ds_read_b64_tr_b16 v[192:193], v1 offset:34816
    ds_read_b64_tr_b16 v[194:195], v1 offset:35328
    s_waitcnt lgkmcnt(12)
    v_mfma_f32_32x32x16_bf16 v[160:175], v[196:199], v[144:147], v[160:175]
    ds_read_b64_tr_b16 v[196:197], v2 offset:34816
    ds_read_b64_tr_b16 v[198:199], v2 offset:35328
    s_waitcnt lgkmcnt(12)
    v_mfma_f32_32x32x16_bf16 v[176:191], v[200:203], v[144:147], v[176:191]
    s_waitcnt lgkmcnt(10)
    v_mfma_f32_32x32x16_bf16 v[160:175], v[204:207], v[148:151], v[160:175]
    s_waitcnt lgkmcnt(8)
    v_mfma_f32_32x32x16_bf16 v[176:191], v[208:211], v[148:151], v[176:191]
    s_waitcnt lgkmcnt(6)
    v_mfma_f32_32x32x16_bf16 v[160:175], v[212:215], v[152:155], v[160:175]
    s_waitcnt lgkmcnt(4)
    v_mfma_f32_32x32x16_bf16 v[176:191], v[216:219], v[152:155], v[176:191]
    s_waitcnt lgkmcnt(2)
    v_mfma_f32_32x32x16_bf16 v[160:175], v[192:195], v[156:159], v[160:175]
    s_waitcnt lgkmcnt(0)
    v_mfma_f32_32x32x16_bf16 v[176:191], v[196:199], v[156:159], v[176:191]
k1_afterM:
    s_setprio 0
    v_add_u32 v1, s44, v1
    v_add_u32 v2, s44, v2
    s_sub_u32 s44, 4294893568, s44
    s_cmp_eq_u32 s35, 0
    s_cbranch_scc0 k1_nowait
    s_waitcnt vmcnt(0)
k1_nowait:
    s_cmp_eq_u32 s37, 0
    s_cbranch_scc1 k1_nby
    s_cmp_eq_u32 s41, 255
    s_cbranch_scc1 k1_nby
    s_barrier
k1_nby:
    s_cmp_eq_u32 s35, 2
    s_cbranch_scc0 k1_doE
    s_cmp_eq_u32 s41, 255
    s_cselect_b32 s46, 1, s37
    s_cmp_eq_u32 s46, 0
    s_cbranch_scc1 k1_doE
    buffer_load_dwordx4 v[16:19], v7, s[20:23], s56 offen offset:0 sc1
    buffer_load_dwordx4 v[20:23], v7, s[20:23], s56 offen offset:512 sc1
    buffer_load_dwordx4 v[24:27], v7, s[20:23], s56 offen offset:1024 sc1
    buffer_load_dwordx4 v[28:31], v7, s[20:23], s56 offen offset:1536 sc1
    buffer_load_dwordx4 v[32:35], v7, s[20:23], s56 offen offset:2048 sc1
    buffer_load_dwordx4 v[36:39], v7, s[20:23], s56 offen offset:2560 sc1
    buffer_load_dwordx4 v[40:43], v7, s[20:23], s56 offen offset:3072 sc1
    buffer_load_dwordx4 v[44:47], v7, s[20:23], s56 offen offset:3584 sc1
    buffer_load_dwordx4 v[48:51], v7, s[20:23], s57 offen offset:0 sc1
k1_doE:
    s_cmp_lt_u32 s39, 16
    s_cbranch_scc1 k1_nowp
    s_cmp_eq_u32 s35, 0
    s_cbranch_scc1 k1_nowp
    s_cmp_eq_u32 s35, 1
    s_cbranch_scc1 k1_wpl
    s_waitcnt vmcnt(13)
    s_add_u32 s46, s88, 4096
    buffer_store_dwordx4 v[236:239], v15, s[20:23], s88 offen offset:0
    buffer_store_dwordx4 v[240:243], v15, s[20:23], s88 offen offset:2048
    buffer_store_dwordx4 v[244:247], v15, s[20:23], s46 offen offset:0
    buffer_store_dwordx4 v[248:251], v15, s[20:23], s46 offen offset:2048
k1_wpl:
    buffer_load_dwordx4 v[236:239], v11, s[60:63], s55 offen offset:0
    buffer_load_dwordx4 v[240:243], v11, s[60:63], s55 offen offset:128
    buffer_load_dwordx4 v[244:247], v11, s[60:63], s55 offen offset:256
    buffer_load_dwordx4 v[248:251], v11, s[60:63], s55 offen offset:384
    s_add_u32 s55, s55, 64
k1_nowp:
    s_nop 7
    s_cmp_lt_u32 s40, 36
    s_cbranch_scc1 k1_EZ1
    s_cmp_lt_u32 s40, 128
    s_cbranch_scc1 k1_EZ2
    s_cmp_lt_u32 s40, 146
    s_cbranch_scc1 k1_EQK
    s_sub_u32 s46, s40, 146
    s_lshl_b32 s46, s46, 10
    s_mul_i32 s47, s38, 36864
    s_add_u32 s46, s46, s47
    s_add_u32 s46, s46, 7077888
    s_cmp_lt_u32 s40, 152
    s_cbranch_scc1 k1_EV
    s_and_b32 s47, s39, 2
    s_lshl_b32 s47, s47, 8
    s_add_u32 s46, s46, s47
    s_add_u32 s47, s46, 18432
    v_cvt_pk_bf16_f32 v200, v160, v161
    v_cvt_pk_bf16_f32 v201, v162, v163
    v_cvt_pk_bf16_f32 v202, v164, v165
    v_cvt_pk_bf16_f32 v203, v166, v167
    buffer_store_dwordx4 v[200:203], v7, s[20:23], s46 offen
    v_cvt_pk_bf16_f32 v204, v168, v169
    v_cvt_pk_bf16_f32 v205, v170, v171
    v_cvt_pk_bf16_f32 v206, v172, v173
    v_cvt_pk_bf16_f32 v207, v174, v175
    buffer_store_dwordx4 v[204:207], v7, s[20:23], s47 offen
    s_branch k1_redq
k1_EV:
    s_add_u32 s47, s46, 18432
    v_cvt_pk_bf16_f32 v200, v160, v161
    v_cvt_pk_bf16_f32 v201, v162, v163
    v_cvt_pk_bf16_f32 v202, v164, v165
    v_cvt_pk_bf16_f32 v203, v166, v167
    buffer_store_dwordx4 v[200:203], v7, s[20:23], s46 offen offset:0
    v_cvt_pk_bf16_f32 v204, v168, v169
    v_cvt_pk_bf16_f32 v205, v170, v171
    v_cvt_pk_bf16_f32 v206, v172, v173
    v_cvt_pk_bf16_f32 v207, v174, v175
    buffer_store_dwordx4 v[204:207], v7, s[20:23], s47 offen offset:0
    v_cvt_pk_bf16_f32 v208, v176, v177
    v_cvt_pk_bf16_f32 v209, v178, v179
    v_cvt_pk_bf16_f32 v210, v180, v181
    v_cvt_pk_bf16_f32 v211, v182, v183
    buffer_store_dwordx4 v[208:211], v7, s[20:23], s46 offen offset:512
    v_cvt_pk_bf16_f32 v212, v184, v185
    v_cvt_pk_bf16_f32 v213, v186, v187
    v_cvt_pk_bf16_f32 v214, v188, v189
    v_cvt_pk_bf16_f32 v215, v190, v191
    buffer_store_dwordx4 v[212:215], v7, s[20:23], s47 offen offset:512
    s_branch k1_afterE
k1_EQK:
    s_sub_u32 s46, s40, 128
    s_lshl_b32 s46, s46, 11
    s_mul_i32 s47, s38, 73728
    s_add_u32 s46, s46, s47
    s_add_u32 s46, s46, 2359296
    v_cvt_pk_bf16_f32 v200, v160, v161
    v_cvt_pk_bf16_f32 v201, v162, v163
    v_cvt_pk_bf16_f32 v202, v164, v165
    v_cvt_pk_bf16_f32 v203, v166, v167
    buffer_store_dwordx4 v[200:203], v12, s[20:23], s46 offen offset:0
    v_cvt_pk_bf16_f32 v204, v168, v169
    v_cvt_pk_bf16_f32 v205, v170, v171
    v_cvt_pk_bf16_f32 v206, v172, v173
    v_cvt_pk_bf16_f32 v207, v174, v175
    buffer_store_dwordx4 v[204:207], v12, s[20:23], s46 offen offset:512
    v_cvt_pk_bf16_f32 v208, v176, v177
    v_cvt_pk_bf16_f32 v209, v178, v179
    v_cvt_pk_bf16_f32 v210, v180, v181
    v_cvt_pk_bf16_f32 v211, v182, v183
    buffer_store_dwordx4 v[208:211], v12, s[20:23], s46 offen offset:1024
    v_cvt_pk_bf16_f32 v212, v184, v185
    v_cvt_pk_bf16_f32 v213, v186, v187
    v_cvt_pk_bf16_f32 v214, v188, v189
    v_cvt_pk_bf16_f32 v215, v190, v191
    buffer_store_dwordx4 v[212:215], v12, s[20:23], s46 offen offset:1536
    s_branch k1_afterE
k1_EZ1:
    s_mul_i32 s46, s38, 147456
    s_lshl_b32 s47, s40, 11
    s_add_u32 s46, s46, s47
    s_add_u32 s46, s46, 9437184
    v_mul_f32 v192, v160, v160
    v_mul_f32 v193, v161, v161
    v_mul_f32 v194, v162, v162
    v_mul_f32 v195, v163, v163
    v_mul_f32 v196, v168, v168
    v_mul_f32 v197, v169, v169
    v_mul_f32 v198, v170, v170
    v_mul_f32 v199, v171, v171
    v_fma_f32 v192, v192, s51, v253
    v_fma_f32 v193, v193, s51, v253
    v_fma_f32 v194, v194, s51, v253
    v_fma_f32 v195, v195, s51, v253
    v_fma_f32 v196, v196, s51, v253
    v_fma_f32 v197, v197, s51, v253
    v_fma_f32 v198, v198, s51, v253
    v_fma_f32 v199, v199, s51, v253
    v_mul_f32 v192, v192, v160
    v_mul_f32 v193, v193, v161
    v_mul_f32 v194, v194, v162
    v_mul_f32 v195, v195, v163
    v_mul_f32 v196, v196, v168
    v_mul_f32 v197, v197, v169
    v_mul_f32 v198, v198, v170
    v_mul_f32 v199, v199, v171
    v_exp_f32 v192, v192
    v_exp_f32 v193, v193
    v_exp_f32 v194, v194
    v_exp_f32 v195, v195
    v_exp_f32 v196, v196
    v_exp_f32 v197, v197
    v_exp_f32 v198, v198
    v_exp_f32 v199, v199
    v_add_f32 v192, 1.0, v192
    v_add_f32 v193, 1.0, v193
    v_add_f32 v194, 1.0, v194
    v_add_f32 v195, 1.0, v195
    v_add_f32 v196, 1.0, v196
    v_add_f32 v197, 1.0, v197
    v_add_f32 v198, 1.0, v198
    v_add_f32 v199, 1.0, v199
    v_rcp_f32 v192, v192
    v_rcp_f32 v193, v193
    v_rcp_f32 v194, v194
    v_rcp_f32 v195, v195
    v_rcp_f32 v196, v196
    v_rcp_f32 v197, v197
    v_rcp_f32 v198, v198
    v_rcp_f32 v199, v199
    v_mul_f32 v160, v160, v192
    v_mul_f32 v161, v161, v193
    v_mul_f32 v162, v162, v194
    v_mul_f32 v163, v163, v195
    v_mul_f32 v168, v168, v196
    v_mul_f32 v169, v169, v197
    v_mul_f32 v170, v170, v198
    v_mul_f32 v171, v171, v199
    v_cvt_pk_bf16_f32 v200, v160, v161
    v_cvt_pk_bf16_f32 v201, v162, v163
    v_cvt_pk_bf16_f32 v202, v168, v169
    v_cvt_pk_bf16_f32 v203, v170, v171
    buffer_store_dwordx4 v[200:203], v5, s[20:23], s46 offen offset:0
    v_mul_f32 v192, v164, v164
    v_mul_f32 v193, v165, v165
    v_mul_f32 v194, v166, v166
    v_mul_f32 v195, v167, v167
    v_mul_f32 v196, v172, v172
    v_mul_f32 v197, v173, v173
    v_mul_f32 v198, v174, v174
    v_mul_f32 v199, v175, v175
    v_fma_f32 v192, v192, s51, v253
    v_fma_f32 v193, v193, s51, v253
    v_fma_f32 v194, v194, s51, v253
    v_fma_f32 v195, v195, s51, v253
    v_fma_f32 v196, v196, s51, v253
    v_fma_f32 v197, v197, s51, v253
    v_fma_f32 v198, v198, s51, v253
    v_fma_f32 v199, v199, s51, v253
    v_mul_f32 v192, v192, v164
    v_mul_f32 v193, v193, v165
    v_mul_f32 v194, v194, v166
    v_mul_f32 v195, v195, v167
    v_mul_f32 v196, v196, v172
    v_mul_f32 v197, v197, v173
    v_mul_f32 v198, v198, v174
    v_mul_f32 v199, v199, v175
    v_exp_f32 v192, v192
    v_exp_f32 v193, v193
    v_exp_f32 v194, v194
    v_exp_f32 v195, v195
    v_exp_f32 v196, v196
    v_exp_f32 v197, v197
    v_exp_f32 v198, v198
    v_exp_f32 v199, v199
    v_add_f32 v192, 1.0, v192
    v_add_f32 v193, 1.0, v193
    v_add_f32 v194, 1.0, v194
    v_add_f32 v195, 1.0, v195
    v_add_f32 v196, 1.0, v196
    v_add_f32 v197, 1.0, v197
    v_add_f32 v198, 1.0, v198
    v_add_f32 v199, 1.0, v199
    v_rcp_f32 v192, v192
    v_rcp_f32 v193, v193
    v_rcp_f32 v194, v194
    v_rcp_f32 v195, v195
    v_rcp_f32 v196, v196
    v_rcp_f32 v197, v197
    v_rcp_f32 v198, v198
    v_rcp_f32 v199, v199
    v_mul_f32 v164, v164, v192
    v_mul_f32 v165, v165, v193
    v_mul_f32 v166, v166, v194
    v_mul_f32 v167, v167, v195
    v_mul_f32 v172, v172, v196
    v_mul_f32 v173, v173, v197
    v_mul_f32 v174, v174, v198
    v_mul_f32 v175, v175, v199
    v_cvt_pk_bf16_f32 v204, v164, v165
    v_cvt_pk_bf16_f32 v205, v166, v167
    v_cvt_pk_bf16_f32 v206, v172, v173
    v_cvt_pk_bf16_f32 v207, v174, v175
    buffer_store_dwordx4 v[204:207], v5, s[20:23], s46 offen offset:512
    v_mul_f32 v192, v176, v176
    v_mul_f32 v193, v177, v177
    v_mul_f32 v194, v178, v178
    v_mul_f32 v195, v179, v179
    v_mul_f32 v196, v184, v184
    v_mul_f32 v197, v185, v185
    v_mul_f32 v198, v186, v186
    v_mul_f32 v199, v187, v187
    v_fma_f32 v192, v192, s51, v253
    v_fma_f32 v193, v193, s51, v253
    v_fma_f32 v194, v194, s51, v253
    v_fma_f32 v195, v195, s51, v253
    v_fma_f32 v196, v196, s51, v253
    v_fma_f32 v197, v197, s51, v253
    v_fma_f32 v198, v198, s51, v253
    v_fma_f32 v199, v199, s51, v253
    v_mul_f32 v192, v192, v176
    v_mul_f32 v193, v193, v177
    v_mul_f32 v194, v194, v178
    v_mul_f32 v195, v195, v179
    v_mul_f32 v196, v196, v184
    v_mul_f32 v197, v197, v185
    v_mul_f32 v198, v198, v186
    v_mul_f32 v199, v199, v187
    v_exp_f32 v192, v192
    v_exp_f32 v193, v193
    v_exp_f32 v194, v194
    v_exp_f32 v195, v195
    v_exp_f32 v196, v196
    v_exp_f32 v197, v197
    v_exp_f32 v198, v198
    v_exp_f32 v199, v199
    v_add_f32 v192, 1.0, v192
    v_add_f32 v193, 1.0, v193
    v_add_f32 v194, 1.0, v194
    v_add_f32 v195, 1.0, v195
    v_add_f32 v196, 1.0, v196
    v_add_f32 v197, 1.0, v197
    v_add_f32 v198, 1.0, v198
    v_add_f32 v199, 1.0, v199
    v_rcp_f32 v192, v192
    v_rcp_f32 v193, v193
    v_rcp_f32 v194, v194
    v_rcp_f32 v195, v195
    v_rcp_f32 v196, v196
    v_rcp_f32 v197, v197
    v_rcp_f32 v198, v198
    v_rcp_f32 v199, v199
    v_mul_f32 v176, v176, v192
    v_mul_f32 v177, v177, v193
    v_mul_f32 v178, v178, v194
    v_mul_f32 v179, v179, v195
    v_mul_f32 v184, v184, v196
    v_mul_f32 v185, v185, v197
    v_mul_f32 v186, v186, v198
    v_mul_f32 v187, v187, v199
    v_cvt_pk_bf16_f32 v208, v176, v177
    v_cvt_pk_bf16_f32 v209, v178, v179
    v_cvt_pk_bf16_f32 v210, v184, v185
    v_cvt_pk_bf16_f32 v211, v186, v187
    buffer_store_dwordx4 v[208:211], v5, s[20:23], s46 offen offset:1024
    v_mul_f32 v192, v180, v180
    v_mul_f32 v193, v181, v181
    v_mul_f32 v194, v182, v182
    v_mul_f32 v195, v183, v183
    v_mul_f32 v196, v188, v188
    v_mul_f32 v197, v189, v189
    v_mul_f32 v198, v190, v190
    v_mul_f32 v199, v191, v191
    v_fma_f32 v192, v192, s51, v253
    v_fma_f32 v193, v193, s51, v253
    v_fma_f32 v194, v194, s51, v253
    v_fma_f32 v195, v195, s51, v253
    v_fma_f32 v196, v196, s51, v253
    v_fma_f32 v197, v197, s51, v253
    v_fma_f32 v198, v198, s51, v253
    v_fma_f32 v199, v199, s51, v253
    v_mul_f32 v192, v192, v180
    v_mul_f32 v193, v193, v181
    v_mul_f32 v194, v194, v182
    v_mul_f32 v195, v195, v183
    v_mul_f32 v196, v196, v188
    v_mul_f32 v197, v197, v189
    v_mul_f32 v198, v198, v190
    v_mul_f32 v199, v199, v191
    v_exp_f32 v192, v192
    v_exp_f32 v193, v193
    v_exp_f32 v194, v194
    v_exp_f32 v195, v195
    v_exp_f32 v196, v196
    v_exp_f32 v197, v197
    v_exp_f32 v198, v198
    v_exp_f32 v199, v199
    v_add_f32 v192, 1.0, v192
    v_add_f32 v193, 1.0, v193
    v_add_f32 v194, 1.0, v194
    v_add_f32 v195, 1.0, v195
    v_add_f32 v196, 1.0, v196
    v_add_f32 v197, 1.0, v197
    v_add_f32 v198, 1.0, v198
    v_add_f32 v199, 1.0, v199
    v_rcp_f32 v192, v192
    v_rcp_f32 v193, v193
    v_rcp_f32 v194, v194
    v_rcp_f32 v195, v195
    v_rcp_f32 v196, v196
    v_rcp_f32 v197, v197
    v_rcp_f32 v198, v198
    v_rcp_f32 v199, v199
    v_mul_f32 v180, v180, v192
    v_mul_f32 v181, v181, v193
    v_mul_f32 v182, v182, v194
    v_mul_f32 v183, v183, v195
    v_mul_f32 v188, v188, v196
    v_mul_f32 v189, v189, v197
    v_mul_f32 v190, v190, v198
    v_mul_f32 v191, v191, v199
    v_cvt_pk_bf16_f32 v212, v180, v181
    v_cvt_pk_bf16_f32 v213, v182, v183
    v_cvt_pk_bf16_f32 v214, v188, v189
    v_cvt_pk_bf16_f32 v215, v190, v191
    buffer_store_dwordx4 v[212:215], v5, s[20:23], s46 offen offset:1536
    s_branch k1_afterE
k1_EZ2:
    s_cmp_eq_u32 s35, 0
    s_cbranch_scc1 k1_EZ2b
    v_mov_b32 v236, v220
    v_mov_b32 v237, v221
    v_mov_b32 v238, v222
    v_mov_b32 v239, v223
    v_mov_b32 v240, v224
    v_mov_b32 v241, v225
    v_mov_b32 v242, v226
    v_mov_b32 v243, v227
    v_mov_b32 v244, v228
    v_mov_b32 v245, v229
    v_mov_b32 v246, v230
    v_mov_b32 v247, v231
    v_mov_b32 v248, v232
    v_mov_b32 v249, v233
    v_mov_b32 v250, v234
    v_mov_b32 v251, v235
k1_EZ2b:
    s_mov_b32 s34, s33
    s_mov_b32 s33, s40
    v_mul_f32 v192, v160, v160
    v_mul_f32 v193, v161, v161
    v_mul_f32 v194, v162, v162
    v_mul_f32 v195, v163, v163
    v_mul_f32 v196, v164, v164
    v_mul_f32 v197, v165, v165
    v_mul_f32 v198, v166, v166
    v_mul_f32 v199, v167, v167
    v_fma_f32 v192, v192, s51, v253
    v_fma_f32 v193, v193, s51, v253
    v_fma_f32 v194, v194, s51, v253
    v_fma_f32 v195, v195, s51, v253
    v_fma_f32 v196, v196, s51, v253
    v_fma_f32 v197, v197, s51, v253
    v_fma_f32 v198, v198, s51, v253
    v_fma_f32 v199, v199, s51, v253
    v_mul_f32 v192, v192, v160
    v_mul_f32 v193, v193, v161
    v_mul_f32 v194, v194, v162
    v_mul_f32 v195, v195, v163
    v_mul_f32 v196, v196, v164
    v_mul_f32 v197, v197, v165
    v_mul_f32 v198, v198, v166
    v_mul_f32 v199, v199, v167
    v_exp_f32 v192, v192
    v_exp_f32 v193, v193
    v_exp_f32 v194, v194
    v_exp_f32 v195, v195
    v_exp_f32 v196, v196
    v_exp_f32 v197, v197
    v_exp_f32 v198, v198
    v_exp_f32 v199, v199
    v_add_f32 v192, 1.0, v192
    v_add_f32 v193, 1.0, v193
    v_add_f32 v194, 1.0, v194
    v_add_f32 v195, 1.0, v195
    v_add_f32 v196, 1.0, v196
    v_add_f32 v197, 1.0, v197
    v_add_f32 v198, 1.0, v198
    v_add_f32 v199, 1.0, v199
    v_rcp_f32 v192, v192
    v_rcp_f32 v193, v193
    v_rcp_f32 v194, v194
    v_rcp_f32 v195, v195
    v_rcp_f32 v196, v196
    v_rcp_f32 v197, v197
    v_rcp_f32 v198, v198
    v_rcp_f32 v199, v199
    v_mul_f32 v160, v160, v192
    v_mul_f32 v161, v161, v193
    v_mul_f32 v162, v162, v194
    v_mul_f32 v163, v163, v195
    v_mul_f32 v164, v164, v196
    v_mul_f32 v165, v165, v197
    v_mul_f32 v166, v166, v198
    v_mul_f32 v167, v167, v199
    v_cvt_pk_bf16_f32 v220, v160, v161
    v_cvt_pk_bf16_f32 v221, v162, v163
    v_cvt_pk_bf16_f32 v222, v164, v165
    v_cvt_pk_bf16_f32 v223, v166, v167
    v_mul_f32 v192, v168, v168
    v_mul_f32 v193, v169, v169
    v_mul_f32 v194, v170, v170
    v_mul_f32 v195, v171, v171
    v_mul_f32 v196, v172, v172
    v_mul_f32 v197, v173, v173
    v_mul_f32 v198, v174, v174
    v_mul_f32 v199, v175, v175
    v_fma_f32 v192, v192, s51, v253
    v_fma_f32 v193, v193, s51, v253
    v_fma_f32 v194, v194, s51, v253
    v_fma_f32 v195, v195, s51, v253
    v_fma_f32 v196, v196, s51, v253
    v_fma_f32 v197, v197, s51, v253
    v_fma_f32 v198, v198, s51, v253
    v_fma_f32 v199, v199, s51, v253
    v_mul_f32 v192, v192, v168
    v_mul_f32 v193, v193, v169
    v_mul_f32 v194, v194, v170
    v_mul_f32 v195, v195, v171
    v_mul_f32 v196, v196, v172
    v_mul_f32 v197, v197, v173
    v_mul_f32 v198, v198, v174
    v_mul_f32 v199, v199, v175
    v_exp_f32 v192, v192
    v_exp_f32 v193, v193
    v_exp_f32 v194, v194
    v_exp_f32 v195, v195
    v_exp_f32 v196, v196
    v_exp_f32 v197, v197
    v_exp_f32 v198, v198
    v_exp_f32 v199, v199
    v_add_f32 v192, 1.0, v192
    v_add_f32 v193, 1.0, v193
    v_add_f32 v194, 1.0, v194
    v_add_f32 v195, 1.0, v195
    v_add_f32 v196, 1.0, v196
    v_add_f32 v197, 1.0, v197
    v_add_f32 v198, 1.0, v198
    v_add_f32 v199, 1.0, v199
    v_rcp_f32 v192, v192
    v_rcp_f32 v193, v193
    v_rcp_f32 v194, v194
    v_rcp_f32 v195, v195
    v_rcp_f32 v196, v196
    v_rcp_f32 v197, v197
    v_rcp_f32 v198, v198
    v_rcp_f32 v199, v199
    v_mul_f32 v168, v168, v192
    v_mul_f32 v169, v169, v193
    v_mul_f32 v170, v170, v194
    v_mul_f32 v171, v171, v195
    v_mul_f32 v172, v172, v196
    v_mul_f32 v173, v173, v197
    v_mul_f32 v174, v174, v198
    v_mul_f32 v175, v175, v199
    v_cvt_pk_bf16_f32 v224, v168, v169
    v_cvt_pk_bf16_f32 v225, v170, v171
    v_cvt_pk_bf16_f32 v226, v172, v173
    v_cvt_pk_bf16_f32 v227, v174, v175
    v_mul_f32 v192, v176, v176
    v_mul_f32 v193, v177, v177
    v_mul_f32 v194, v178, v178
    v_mul_f32 v195, v179, v179
    v_mul_f32 v196, v180, v180
    v_mul_f32 v197, v181, v181
    v_mul_f32 v198, v182, v182
    v_mul_f32 v199, v183, v183
    v_fma_f32 v192, v192, s51, v253
    v_fma_f32 v193, v193, s51, v253
    v_fma_f32 v194, v194, s51, v253
    v_fma_f32 v195, v195, s51, v253
    v_fma_f32 v196, v196, s51, v253
    v_fma_f32 v197, v197, s51, v253
    v_fma_f32 v198, v198, s51, v253
    v_fma_f32 v199, v199, s51, v253
    v_mul_f32 v192, v192, v176
    v_mul_f32 v193, v193, v177
    v_mul_f32 v194, v194, v178
    v_mul_f32 v195, v195, v179
    v_mul_f32 v196, v196, v180
    v_mul_f32 v197, v197, v181
    v_mul_f32 v198, v198, v182
    v_mul_f32 v199, v199, v183
    v_exp_f32 v192, v192
    v_exp_f32 v193, v193
    v_exp_f32 v194, v194
    v_exp_f32 v195, v195
    v_exp_f32 v196, v196
    v_exp_f32 v197, v197
    v_exp_f32 v198, v198
    v_exp_f32 v199, v199
    v_add_f32 v192, 1.0, v192
    v_add_f32 v193, 1.0, v193
    v_add_f32 v194, 1.0, v194
    v_add_f32 v195, 1.0, v195
    v_add_f32 v196, 1.0, v196
    v_add_f32 v197, 1.0, v197
    v_add_f32 v198, 1.0, v198
    v_add_f32 v199, 1.0, v199
    v_rcp_f32 v192, v192
    v_rcp_f32 v193, v193
    v_rcp_f32 v194, v194
    v_rcp_f32 v195, v195
    v_rcp_f32 v196, v196
    v_rcp_f32 v197, v197
    v_rcp_f32 v198, v198
    v_rcp_f32 v199, v199
    v_mul_f32 v176, v176, v192
    v_mul_f32 v177, v177, v193
    v_mul_f32 v178, v178, v194
    v_mul_f32 v179, v179, v195
    v_mul_f32 v180, v180, v196
    v_mul_f32 v181, v181, v197
    v_mul_f32 v182, v182, v198
    v_mul_f32 v183, v183, v199
    v_cvt_pk_bf16_f32 v228, v176, v177
    v_cvt_pk_bf16_f32 v229, v178, v179
    v_cvt_pk_bf16_f32 v230, v180, v181
    v_cvt_pk_bf16_f32 v231, v182, v183
    v_mul_f32 v192, v184, v184
    v_mul_f32 v193, v185, v185
    v_mul_f32 v194, v186, v186
    v_mul_f32 v195, v187, v187
    v_mul_f32 v196, v188, v188
    v_mul_f32 v197, v189, v189
    v_mul_f32 v198, v190, v190
    v_mul_f32 v199, v191, v191
    v_fma_f32 v192, v192, s51, v253
    v_fma_f32 v193, v193, s51, v253
    v_fma_f32 v194, v194, s51, v253
    v_fma_f32 v195, v195, s51, v253
    v_fma_f32 v196, v196, s51, v253
    v_fma_f32 v197, v197, s51, v253
    v_fma_f32 v198, v198, s51, v253
    v_fma_f32 v199, v199, s51, v253
    v_mul_f32 v192, v192, v184
    v_mul_f32 v193, v193, v185
    v_mul_f32 v194, v194, v186
    v_mul_f32 v195, v195, v187
    v_mul_f32 v196, v196, v188
    v_mul_f32 v197, v197, v189
    v_mul_f32 v198, v198, v190
    v_mul_f32 v199, v199, v191
    v_exp_f32 v192, v192
    v_exp_f32 v193, v193
    v_exp_f32 v194, v194
    v_exp_f32 v195, v195
    v_exp_f32 v196, v196
    v_exp_f32 v197, v197
    v_exp_f32 v198, v198
    v_exp_f32 v199, v199
    v_add_f32 v192, 1.0, v192
    v_add_f32 v193, 1.0, v193
    v_add_f32 v194, 1.0, v194
    v_add_f32 v195, 1.0, v195
    v_add_f32 v196, 1.0, v196
    v_add_f32 v197, 1.0, v197
    v_add_f32 v198, 1.0, v198
    v_add_f32 v199, 1.0, v199
    v_rcp_f32 v192, v192
    v_rcp_f32 v193, v193
    v_rcp_f32 v194, v194
    v_rcp_f32 v195, v195
    v_rcp_f32 v196, v196
    v_rcp_f32 v197, v197
    v_rcp_f32 v198, v198
    v_rcp_f32 v199, v199
    v_mul_f32 v184, v184, v192
    v_mul_f32 v185, v185, v193
    v_mul_f32 v186, v186, v194
    v_mul_f32 v187, v187, v195
    v_mul_f32 v188, v188, v196
    v_mul_f32 v189, v189, v197
    v_mul_f32 v190, v190, v198
    v_mul_f32 v191, v191, v199
    v_cvt_pk_bf16_f32 v232, v184, v185
    v_cvt_pk_bf16_f32 v233, v186, v187
    v_cvt_pk_bf16_f32 v234, v188, v189
    v_cvt_pk_bf16_f32 v235, v190, v191
    v_mul_f32 v192, v160, v160
    v_add_f32 v160, v160, v176
    v_fma_f32 v176, v176, v176, v192
    v_mul_f32 v193, v161, v161
    v_add_f32 v161, v161, v177
    v_fma_f32 v177, v177, v177, v193
    v_mul_f32 v194, v162, v162
    v_add_f32 v162, v162, v178
    v_fma_f32 v178, v178, v178, v194
    v_mul_f32 v195, v163, v163
    v_add_f32 v163, v163, v179
    v_fma_f32 v179, v179, v179, v195
    v_mul_f32 v196, v164, v164
    v_add_f32 v164, v164, v180
    v_fma_f32 v180, v180, v180, v196
    v_mul_f32 v197, v165, v165
    v_add_f32 v165, v165, v181
    v_fma_f32 v181, v181, v181, v197
    v_mul_f32 v198, v166, v166
    v_add_f32 v166, v166, v182
    v_fma_f32 v182, v182, v182, v198
    v_mul_f32 v199, v167, v167
    v_add_f32 v167, v167, v183
    v_fma_f32 v183, v183, v183, v199
    v_mul_f32 v200, v168, v168
    v_add_f32 v168, v168, v184
    v_fma_f32 v184, v184, v184, v200
    v_mul_f32 v201, v169, v169
    v_add_f32 v169, v169, v185
    v_fma_f32 v185, v185, v185, v201
    v_mul_f32 v202, v170, v170
    v_add_f32 v170, v170, v186
    v_fma_f32 v186, v186, v186, v202
    v_mul_f32 v203, v171, v171
    v_add_f32 v171, v171, v187
    v_fma_f32 v187, v187, v187, v203
    v_mul_f32 v204, v172, v172
    v_add_f32 v172, v172, v188
    v_fma_f32 v188, v188, v188, v204
    v_mul_f32 v205, v173, v173
    v_add_f32 v173, v173, v189
    v_fma_f32 v189, v189, v189, v205
    v_mul_f32 v206, v174, v174
    v_add_f32 v174, v174, v190
    v_fma_f32 v190, v190, v190, v206
    v_mul_f32 v207, v175, v175
    v_add_f32 v175, v175, v191
    v_fma_f32 v191, v191, v191, v207
    s_nop 1
    v_permlane16_swap_b32 v160, v168
    v_permlane16_swap_b32 v161, v169
    v_permlane16_swap_b32 v162, v170
    v_permlane16_swap_b32 v163, v171
    v_permlane16_swap_b32 v164, v172
    v_permlane16_swap_b32 v165, v173
    v_permlane16_swap_b32 v166, v174
    v_permlane16_swap_b32 v167, v175
    v_permlane16_swap_b32 v176, v184
    v_permlane16_swap_b32 v177, v185
    v_permlane16_swap_b32 v178, v186
    v_permlane16_swap_b32 v179, v187
    v_permlane16_swap_b32 v180, v188
    v_permlane16_swap_b32 v181, v189
    v_permlane16_swap_b32 v182, v190
    v_permlane16_swap_b32 v183, v191
    v_add_f32 v160, v160, v168
    v_add_f32 v161, v161, v169
    v_add_f32 v162, v162, v170
    v_add_f32 v163, v163, v171
    v_add_f32 v164, v164, v172
    v_add_f32 v165, v165, v173
    v_add_f32 v166, v166, v174
    v_add_f32 v167, v167, v175
    v_add_f32 v176, v176, v184
    v_add_f32 v177, v177, v185
    v_add_f32 v178, v178, v186
    v_add_f32 v179, v179, v187
    v_add_f32 v180, v180, v188
    v_add_f32 v181, v181, v189
    v_add_f32 v182, v182, v190
    v_add_f32 v183, v183, v191
    s_nop 1
    v_add_f32_dpp v168, v160, v160 row_ror:8 row_mask:0xf bank_mask:0x3
    v_add_f32_dpp v168, v176, v176 row_ror:8 row_mask:0xf bank_mask:0xc
    v_add_f32_dpp v169, v161, v161 row_ror:8 row_mask:0xf bank_mask:0x3
    v_add_f32_dpp v169, v177, v177 row_ror:8 row_mask:0xf bank_mask:0xc
    v_add_f32_dpp v170, v162, v162 row_ror:8 row_mask:0xf bank_mask:0x3
    v_add_f32_dpp v170, v178, v178 row_ror:8 row_mask:0xf bank_mask:0xc
    v_add_f32_dpp v171, v163, v163 row_ror:8 row_mask:0xf bank_mask:0x3
    v_add_f32_dpp v171, v179, v179 row_ror:8 row_mask:0xf bank_mask:0xc
    v_add_f32_dpp v172, v164, v164 row_ror:8 row_mask:0xf bank_mask:0x3
    v_add_f32_dpp v172, v180, v180 row_ror:8 row_mask:0xf bank_mask:0xc
    v_add_f32_dpp v173, v165, v165 row_ror:8 row_mask:0xf bank_mask:0x3
    v_add_f32_dpp v173, v181, v181 row_ror:8 row_mask:0xf bank_mask:0xc
    v_add_f32_dpp v174, v166, v166 row_ror:8 row_mask:0xf bank_mask:0x3
    v_add_f32_dpp v174, v182, v182 row_ror:8 row_mask:0xf bank_mask:0xc
    v_add_f32_dpp v175, v167, v167 row_ror:8 row_mask:0xf bank_mask:0x3
    v_add_f32_dpp v175, v183, v183 row_ror:8 row_mask:0xf bank_mask:0xc
    s_nop 1
    v_add_f32_dpp v160, v168, v168 row_half_mirror row_mask:0xf bank_mask:0x5
    v_add_f32_dpp v160, v172, v172 row_half_mirror row_mask:0xf bank_mask:0xa
    v_add_f32_dpp v161, v169, v169 row_half_mirror row_mask:0xf bank_mask:0x5
    v_add_f32_dpp v161, v173, v173 row_half_mirror row_mask:0xf bank_mask:0xa
    v_add_f32_dpp v162, v170, v170 row_half_mirror row_mask:0xf bank_mask:0x5
    v_add_f32_dpp v162, v174, v174 row_half_mirror row_mask:0xf bank_mask:0xa
    v_add_f32_dpp v163, v171, v171 row_half_mirror row_mask:0xf bank_mask:0x5
    v_add_f32_dpp v163, v175, v175 row_half_mirror row_mask:0xf bank_mask:0xa
    s_nop 1
    v_add_f32_dpp v160, v160, v160 quad_perm:[1,0,3,2] row_mask:0xf bank_mask:0xf
    v_add_f32_dpp v161, v161, v161 quad_perm:[1,0,3,2] row_mask:0xf bank_mask:0xf
    v_add_f32_dpp v162, v162, v162 quad_perm:[1,0,3,2] row_mask:0xf bank_mask:0xf
    v_add_f32_dpp v163, v163, v163 quad_perm:[1,0,3,2] row_mask:0xf bank_mask:0xf
    s_nop 1
    v_add_f32_dpp v160, v160, v160 quad_perm:[2,3,0,1] row_mask:0xf bank_mask:0xf
    v_add_f32_dpp v161, v161, v161 quad_perm:[2,3,0,1] row_mask:0xf bank_mask:0xf
    v_add_f32_dpp v162, v162, v162 quad_perm:[2,3,0,1] row_mask:0xf bank_mask:0xf
    v_add_f32_dpp v163, v163, v163 quad_perm:[2,3,0,1] row_mask:0xf bank_mask:0xf
    s_mov_b32 s46, 0xaaaaaaaa
    s_mov_b32 s47, 0xaaaaaaaa
    s_mov_b32 s48, 0xcccccccc
    s_mov_b32 s49, 0xcccccccc
    v_cndmask_b32 v160, v160, v161, s[46:47]
    v_cndmask_b32 v162, v162, v163, s[46:47]
    v_cndmask_b32 v160, v160, v162, s[48:49]
    s_sub_u32 s46, s40, 36
    s_lshl_b32 s46, s46, 7
    s_add_u32 s46, s46, s56
    v_or_b32 v160, 1, v160
    buffer_store_dword v160, v8, s[20:23], s46 offen sc1
k1_afterE:
    s_cmp_eq_u32 s35, 2
    s_cbranch_scc0 k1_nonorm
    s_cmp_eq_u32 s41, 255
    s_cselect_b32 s46, 1, s37
    s_cmp_eq_u32 s46, 0
    s_cbranch_scc1 k1_nonorm
    s_mov_b32 s32, 0
    s_cmp_ge_u32 s39, 16
    s_cbranch_scc1 k1_red2
    s_waitcnt vmcnt(4)
k1_red2:
    s_waitcnt vmcnt(12)
    v_and_b32 v255, v16, v17
    v_and_b32 v255, v255, v18
    v_and_b32 v255, v255, v19
    v_and_b32 v255, v255, v20
    v_and_b32 v255, v255, v21
    v_and_b32 v255, v255, v22
    v_and_b32 v255, v255, v23
    v_and_b32 v255, v255, v24
    v_and_b32 v255, v255, v25
    v_and_b32 v255, v255, v26
    v_and_b32 v255, v255, v27
    v_and_b32 v255, v255, v28
    v_and_b32 v255, v255, v29
    v_and_b32 v255, v255, v30
    v_and_b32 v255, v255, v31
    v_and_b32 v255, v255, v32
    v_and_b32 v255, v255, v33
    v_and_b32 v255, v255, v34
    v_and_b32 v255, v255, v35
    v_and_b32 v255, v255, v36
    v_and_b32 v255, v255, v37
    v_and_b32 v255, v255, v38
    v_and_b32 v255, v255, v39
    v_and_b32 v255, v255, v40
    v_and_b32 v255, v255, v41
    v_and_b32 v255, v255, v42
    v_and_b32 v255, v255, v43
    v_and_b32 v255, v255, v44
    v_and_b32 v255, v255, v45
    v_and_b32 v255, v255, v46
    v_and_b32 v255, v255, v47
    v_and_b32 v255, v255, v48
    v_and_b32 v255, v255, v49
    v_and_b32 v255, v255, v50
    v_and_b32 v255, v255, v51
    v_add_f32 v196, v16, v20
    v_add_f32 v197, v17, v21
    v_add_f32 v198, v18, v22
    v_add_f32 v199, v19, v23
    v_add_f32 v196, v196, v24
    v_add_f32 v197, v197, v25
    v_add_f32 v198, v198, v26
    v_add_f32 v199, v199, v27
    v_add_f32 v196, v196, v28
    v_add_f32 v197, v197, v29
    v_add_f32 v198, v198, v30
    v_add_f32 v199, v199, v31
    v_add_f32 v196, v196, v32
    v_add_f32 v197, v197, v33
    v_add_f32 v198, v198, v34
    v_add_f32 v199, v199, v35
    v_add_f32 v196, v196, v36
    v_add_f32 v197, v197, v37
    v_add_f32 v198, v198, v38
    v_add_f32 v199, v199, v39
    v_add_f32 v196, v196, v40
    v_add_f32 v197, v197, v41
    v_add_f32 v198, v198, v42
    v_add_f32 v199, v199, v43
    v_add_f32 v196, v196, v44
    v_add_f32 v197, v197, v45
    v_add_f32 v198, v198, v46
    v_add_f32 v199, v199, v47
    v_add_f32 v196, v196, v48
    v_add_f32 v197, v197, v49
    v_add_f32 v198, v198, v50
    v_add_f32 v199, v199, v51
    s_branch k1_chk
k1_redq:
    s_mov_b32 s32, 0
    s_waitcnt vmcnt(2)
    v_and_b32 v255, v176, v177
    v_and_b32 v255, v255, v178
    v_and_b32 v255, v255, v179
    v_and_b32 v255, v255, v180
    v_and_b32 v255, v255, v181
    v_and_b32 v255, v255, v182
    v_and_b32 v255, v255, v183
    v_and_b32 v255, v255, v184
    v_and_b32 v255, v255, v185
    v_and_b32 v255, v255, v186
    v_and_b32 v255, v255, v187
    v_and_b32 v255, v255, v188
    v_and_b32 v255, v255, v189
    v_and_b32 v255, v255, v190
    v_and_b32 v255, v255, v191
    v_and_b32 v255, v255, v236
    v_and_b32 v255, v255, v237
    v_and_b32 v255, v255, v238
    v_and_b32 v255, v255, v239
    v_and_b32 v255, v255, v240
    v_and_b32 v255, v255, v241
    v_and_b32 v255, v255, v242
    v_and_b32 v255, v255, v243
    v_and_b32 v255, v255, v244
    v_and_b32 v255, v255, v245
    v_and_b32 v255, v255, v246
    v_and_b32 v255, v255, v247
    v_and_b32 v255, v255, v248
    v_and_b32 v255, v255, v249
    v_and_b32 v255, v255, v250
    v_and_b32 v255, v255, v251
    v_and_b32 v255, v255, v216
    v_and_b32 v255, v255, v217
    v_and_b32 v255, v255, v218
    v_and_b32 v255, v255, v219
    v_add_f32 v196, v176, v180
    v_add_f32 v197, v177, v181
    v_add_f32 v198, v178, v182
    v_add_f32 v199, v179, v183
    v_add_f32 v196, v196, v184
    v_add_f32 v197, v197, v185
    v_add_f32 v198, v198, v186
    v_add_f32 v199, v199, v187
    v_add_f32 v196, v196, v188
    v_add_f32 v197, v197, v189
    v_add_f32 v198, v198, v190
    v_add_f32 v199, v199, v191
    v_add_f32 v196, v196, v236
    v_add_f32 v197, v197, v237
    v_add_f32 v198, v198, v238
    v_add_f32 v199, v199, v239
    v_add_f32 v196, v196, v240
    v_add_f32 v197, v197, v241
    v_add_f32 v198, v198, v242
    v_add_f32 v199, v199, v243
    v_add_f32 v196, v196, v244
    v_add_f32 v197, v197, v245
    v_add_f32 v198, v198, v246
    v_add_f32 v199, v199, v247
    v_add_f32 v196, v196, v248
    v_add_f32 v197, v197, v249
    v_add_f32 v198, v198, v250
    v_add_f32 v199, v199, v251
    v_add_f32 v196, v196, v216
    v_add_f32 v197, v197, v217
    v_add_f32 v198, v198, v218
    v_add_f32 v199, v199, v219
    s_branch k1_chk
k1_late:
    buffer_load_dwordx4 v[160:163], v7, s[20:23], s56 offen offset:0 sc1
    buffer_load_dwordx4 v[164:167], v7, s[20:23], s56 offen offset:512 sc1
    buffer_load_dwordx4 v[168:171], v7, s[20:23], s56 offen offset:1024 sc1
    buffer_load_dwordx4 v[172:175], v7, s[20:23], s56 offen offset:1536 sc1
    buffer_load_dwordx4 v[176:179], v7, s[20:23], s56 offen offset:2048 sc1
    buffer_load_dwordx4 v[180:183], v7, s[20:23], s56 offen offset:2560 sc1
    buffer_load_dwordx4 v[184:187], v7, s[20:23], s56 offen offset:3072 sc1
    buffer_load_dwordx4 v[188:191], v7, s[20:23], s56 offen offset:3584 sc1
    buffer_load_dwordx4 v[192:195], v7, s[20:23], s57 offen offset:0 sc1
    s_waitcnt vmcnt(0)
    v_and_b32 v255, v160, v161
    v_and_b32 v255, v255, v162
    v_and_b32 v255, v255, v163
    v_and_b32 v255, v255, v164
    v_and_b32 v255, v255, v165
    v_and_b32 v255, v255, v166
    v_and_b32 v255, v255, v167
    v_and_b32 v255, v255, v168
    v_and_b32 v255, v255, v169
    v_and_b32 v255, v255, v170
    v_and_b32 v255, v255, v171
    v_and_b32 v255, v255, v172
    v_and_b32 v255, v255, v173
    v_and_b32 v255, v255, v174
    v_and_b32 v255, v255, v175
    v_and_b32 v255, v255, v176
    v_and_b32 v255, v255, v177
    v_and_b32 v255, v255, v178
    v_and_b32 v255, v255, v179
    v_and_b32 v255, v255, v180
    v_and_b32 v255, v255, v181
    v_and_b32 v255, v255, v182
    v_and_b32 v255, v255, v183
    v_and_b32 v255, v255, v184
    v_and_b32 v255, v255, v185
    v_and_b32 v255, v255, v186
    v_and_b32 v255, v255, v187
    v_and_b32 v255, v255, v188
    v_and_b32 v255, v255, v189
    v_and_b32 v255, v255, v190
    v_and_b32 v255, v255, v191
    v_and_b32 v255, v255, v192
    v_and_b32 v255, v255, v193
    v_and_b32 v255, v255, v194
    v_and_b32 v255, v255, v195
    v_add_f32 v196, v160, v164
    v_add_f32 v197, v161, v165
    v_add_f32 v198, v162, v166
    v_add_f32 v199, v163, v167
    v_add_f32 v196, v196, v168
    v_add_f32 v197, v197, v169
    v_add_f32 v198, v198, v170
    v_add_f32 v199, v199, v171
    v_add_f32 v196, v196, v172
    v_add_f32 v197, v197, v173
    v_add_f32 v198, v198, v174
    v_add_f32 v199, v199, v175
    v_add_f32 v196, v196, v176
    v_add_f32 v197, v197, v177
    v_add_f32 v198, v198, v178
    v_add_f32 v199, v199, v179
    v_add_f32 v196, v196, v180
    v_add_f32 v197, v197, v181
    v_add_f32 v198, v198, v182
    v_add_f32 v199, v199, v183
    v_add_f32 v196, v196, v184
    v_add_f32 v197, v197, v185
    v_add_f32 v198, v198, v186
    v_add_f32 v199, v199, v187
    v_add_f32 v196, v196, v188
    v_add_f32 v197, v197, v189
    v_add_f32 v198, v198, v190
    v_add_f32 v199, v199, v191
    v_add_f32 v196, v196, v192
    v_add_f32 v197, v197, v193
    v_add_f32 v198, v198, v194
    v_add_f32 v199, v199, v195
k1_chk:
    v_and_b32 v255, 1, v255
    v_cmp_eq_u32 vcc, 0, v255
    s_add_u32 s32, s32, 1
    s_cbranch_vccz k1_ready
    s_cmp_lt_u32 s32, 0x40000
    s_cbranch_scc1 k1_late
k1_ready:
    v_add_f32_dpp v196, v196, v196 row_ror:8 row_mask:0xf bank_mask:0xf
    v_add_f32_dpp v197, v197, v197 row_ror:8 row_mask:0xf bank_mask:0xf
    v_add_f32_dpp v198, v198, v198 row_ror:8 row_mask:0xf bank_mask:0xf
    v_add_f32_dpp v199, v199, v199 row_ror:8 row_mask:0xf bank_mask:0xf
    v_mov_b32 v200, v196
    v_mov_b32 v201, v197
    v_mov_b32 v202, v198
    v_mov_b32 v203, v199
    s_nop 1
    v_permlane16_swap_b32 v196, v200
    v_permlane16_swap_b32 v197, v201
    v_permlane16_swap_b32 v198, v202
    v_permlane16_swap_b32 v199, v203
    s_mov_b32 s46, 0x39e38e39
    v_add_f32 v196, v196, v200
    v_add_f32 v197, v197, v201
    v_add_f32 v198, v198, v202
    v_add_f32 v199, v199, v203
    v_mul_f32 v196, s46, v196
    v_mul_f32 v197, s46, v197
    v_mul_f32 v198, s46, v198
    v_mul_f32 v199, s46, v199
    s_nop 1
    v_mov_b32_dpp v200, v196 quad_perm:[0,0,2,2] row_mask:0xf bank_mask:0xf
    v_mov_b32_dpp v204, v196 quad_perm:[1,1,3,3] row_mask:0xf bank_mask:0xf
    v_mov_b32_dpp v201, v197 quad_perm:[0,0,2,2] row_mask:0xf bank_mask:0xf
    v_mov_b32_dpp v205, v197 quad_perm:[1,1,3,3] row_mask:0xf bank_mask:0xf
    v_mov_b32_dpp v202, v198 quad_perm:[0,0,2,2] row_mask:0xf bank_mask:0xf
    v_mov_b32_dpp v206, v198 quad_perm:[1,1,3,3] row_mask:0xf bank_mask:0xf
    v_mov_b32_dpp v203, v199 quad_perm:[0,0,2,2] row_mask:0xf bank_mask:0xf
    v_mov_b32_dpp v207, v199 quad_perm:[1,1,3,3] row_mask:0xf bank_mask:0xf
    v_fma_f32 v204, -v200, v200, v204
    v_fma_f32 v205, -v201, v201, v205
    v_fma_f32 v206, -v202, v202, v206
    v_fma_f32 v207, -v203, v203, v207
    v_max_f32 v204, 0, v204
    v_max_f32 v205, 0, v205
    v_max_f32 v206, 0, v206
    v_max_f32 v207, 0, v207
    v_add_f32 v204, 0x3727c5ac, v204
    v_add_f32 v205, 0x3727c5ac, v205
    v_add_f32 v206, 0x3727c5ac, v206
    v_add_f32 v207, 0x3727c5ac, v207
    v_rsq_f32 v204, v204
    v_rsq_f32 v205, v205
    v_rsq_f32 v206, v206
    v_rsq_f32 v207, v207
    s_mul_i32 s52, s38, 9216
    s_add_u32 s52, s52, 18874368
k1_norm:
    s_sub_u32 s46, s33, 36
    s_lshl_b32 s46, s46, 2
    s_add_u32 s46, s46, 0
    s_mul_i32 s47, s46, 7282
    s_lshr_b32 s47, s47, 16
    s_mul_i32 s48, s47, 9
    s_sub_u32 s48, s46, s48
    s_mul_i32 s47, s47, 589824
    s_cmp_eq_u32 s48, 8
    s_movk_i32 s49, 1024
    s_cselect_b32 s49, 581632, s49
    s_lshl_b32 s48, s48, 10
    s_add_u32 s47, s47, s48
    s_add_u32 s53, s47, s52
    v_mad_u32_u24 v9, v254, s49, v6
    s_sub_u32 s46, s33, 36
    s_lshl_b32 s46, s46, 2
    s_add_u32 s46, s46, 2
    s_mul_i32 s47, s46, 7282
    s_lshr_b32 s47, s47, 16
    s_mul_i32 s48, s47, 9
    s_sub_u32 s48, s46, s48
    s_mul_i32 s47, s47, 589824
    s_cmp_eq_u32 s48, 8
    s_movk_i32 s49, 1024
    s_cselect_b32 s49, 581632, s49
    s_lshl_b32 s48, s48, 10
    s_add_u32 s47, s47, s48
    s_add_u32 s54, s47, s52
    v_mad_u32_u24 v10, v254, s49, v6
    v_lshlrev_b32 v160, 16, v220
    v_and_b32 v161, 0xffff0000, v220
    v_lshlrev_b32 v162, 16, v221
    v_and_b32 v163, 0xffff0000, v221
    v_lshlrev_b32 v164, 16, v222
    v_and_b32 v165, 0xffff0000, v222
    v_lshlrev_b32 v166, 16, v223
    v_and_b32 v167, 0xffff0000, v223
    v_subrev_f32_dpp v160, v200, v160 row_newbcast:0 row_mask:0xf bank_mask:0xf
    v_subrev_f32_dpp v161, v201, v161 row_newbcast:0 row_mask:0xf bank_mask:0xf
    v_subrev_f32_dpp v162, v202, v162 row_newbcast:0 row_mask:0xf bank_mask:0xf
    v_subrev_f32_dpp v163, v203, v163 row_newbcast:0 row_mask:0xf bank_mask:0xf
    v_subrev_f32_dpp v164, v200, v164 row_newbcast:2 row_mask:0xf bank_mask:0xf
    v_subrev_f32_dpp v165, v201, v165 row_newbcast:2 row_mask:0xf bank_mask:0xf
    v_subrev_f32_dpp v166, v202, v166 row_newbcast:2 row_mask:0xf bank_mask:0xf
    v_subrev_f32_dpp v167, v203, v167 row_newbcast:2 row_mask:0xf bank_mask:0xf
    v_mul_f32_dpp v160, v204, v160 row_newbcast:0 row_mask:0xf bank_mask:0xf
    v_mul_f32_dpp v161, v205, v161 row_newbcast:0 row_mask:0xf bank_mask:0xf
    v_mul_f32_dpp v162, v206, v162 row_newbcast:0 row_mask:0xf bank_mask:0xf
    v_mul_f32_dpp v163, v207, v163 row_newbcast:0 row_mask:0xf bank_mask:0xf
    v_mul_f32_dpp v164, v204, v164 row_newbcast:2 row_mask:0xf bank_mask:0xf
    v_mul_f32_dpp v165, v205, v165 row_newbcast:2 row_mask:0xf bank_mask:0xf
    v_mul_f32_dpp v166, v206, v166 row_newbcast:2 row_mask:0xf bank_mask:0xf
    v_mul_f32_dpp v167, v207, v167 row_newbcast:2 row_mask:0xf bank_mask:0xf
    v_cvt_pk_bf16_f32 v220, v160, v161
    v_cvt_pk_bf16_f32 v221, v162, v163
    v_cvt_pk_bf16_f32 v222, v164, v165
    v_cvt_pk_bf16_f32 v223, v166, v167
    buffer_store_dwordx4 v[220:223], v9, s[20:23], s53 offen offset:0
    v_lshlrev_b32 v168, 16, v224
    v_and_b32 v169, 0xffff0000, v224
    v_lshlrev_b32 v170, 16, v225
    v_and_b32 v171, 0xffff0000, v225
    v_lshlrev_b32 v172, 16, v226
    v_and_b32 v173, 0xffff0000, v226
    v_lshlrev_b32 v174, 16, v227
    v_and_b32 v175, 0xffff0000, v227
    v_subrev_f32_dpp v168, v200, v168 row_newbcast:4 row_mask:0xf bank_mask:0xf
    v_subrev_f32_dpp v169, v201, v169 row_newbcast:4 row_mask:0xf bank_mask:0xf
    v_subrev_f32_dpp v170, v202, v170 row_newbcast:4 row_mask:0xf bank_mask:0xf
    v_subrev_f32_dpp v171, v203, v171 row_newbcast:4 row_mask:0xf bank_mask:0xf
    v_subrev_f32_dpp v172, v200, v172 row_newbcast:6 row_mask:0xf bank_mask:0xf
    v_subrev_f32_dpp v173, v201, v173 row_newbcast:6 row_mask:0xf bank_mask:0xf
    v_subrev_f32_dpp v174, v202, v174 row_newbcast:6 row_mask:0xf bank_mask:0xf
    v_subrev_f32_dpp v175, v203, v175 row_newbcast:6 row_mask:0xf bank_mask:0xf
    v_mul_f32_dpp v168, v204, v168 row_newbcast:4 row_mask:0xf bank_mask:0xf
    v_mul_f32_dpp v169, v205, v169 row_newbcast:4 row_mask:0xf bank_mask:0xf
    v_mul_f32_dpp v170, v206, v170 row_newbcast:4 row_mask:0xf bank_mask:0xf
    v_mul_f32_dpp v171, v207, v171 row_newbcast:4 row_mask:0xf bank_mask:0xf
    v_mul_f32_dpp v172, v204, v172 row_newbcast:6 row_mask:0xf bank_mask:0xf
    v_mul_f32_dpp v173, v205, v173 row_newbcast:6 row_mask:0xf bank_mask:0xf
    v_mul_f32_dpp v174, v206, v174 row_newbcast:6 row_mask:0xf bank_mask:0xf
    v_mul_f32_dpp v175, v207, v175 row_newbcast:6 row_mask:0xf bank_mask:0xf
    v_cvt_pk_bf16_f32 v224, v168, v169
    v_cvt_pk_bf16_f32 v225, v170, v171
    v_cvt_pk_bf16_f32 v226, v172, v173
    v_cvt_pk_bf16_f32 v227, v174, v175
    buffer_store_dwordx4 v[224:227], v9, s[20:23], s53 offen offset:512
    v_lshlrev_b32 v176, 16, v228
    v_and_b32 v177, 0xffff0000, v228
    v_lshlrev_b32 v178, 16, v229
    v_and_b32 v179, 0xffff0000, v229
    v_lshlrev_b32 v180, 16, v230
    v_and_b32 v181, 0xffff0000, v230
    v_lshlrev_b32 v182, 16, v231
    v_and_b32 v183, 0xffff0000, v231
    v_subrev_f32_dpp v176, v200, v176 row_newbcast:0 row_mask:0xf bank_mask:0xf
    v_subrev_f32_dpp v177, v201, v177 row_newbcast:0 row_mask:0xf bank_mask:0xf
    v_subrev_f32_dpp v178, v202, v178 row_newbcast:0 row_mask:0xf bank_mask:0xf
    v_subrev_f32_dpp v179, v203, v179 row_newbcast:0 row_mask:0xf bank_mask:0xf
    v_subrev_f32_dpp v180, v200, v180 row_newbcast:2 row_mask:0xf bank_mask:0xf
    v_subrev_f32_dpp v181, v201, v181 row_newbcast:2 row_mask:0xf bank_mask:0xf
    v_subrev_f32_dpp v182, v202, v182 row_newbcast:2 row_mask:0xf bank_mask:0xf
    v_subrev_f32_dpp v183, v203, v183 row_newbcast:2 row_mask:0xf bank_mask:0xf
    v_mul_f32_dpp v176, v204, v176 row_newbcast:0 row_mask:0xf bank_mask:0xf
    v_mul_f32_dpp v177, v205, v177 row_newbcast:0 row_mask:0xf bank_mask:0xf
    v_mul_f32_dpp v178, v206, v178 row_newbcast:0 row_mask:0xf bank_mask:0xf
    v_mul_f32_dpp v179, v207, v179 row_newbcast:0 row_mask:0xf bank_mask:0xf
    v_mul_f32_dpp v180, v204, v180 row_newbcast:2 row_mask:0xf bank_mask:0xf
    v_mul_f32_dpp v181, v205, v181 row_newbcast:2 row_mask:0xf bank_mask:0xf
    v_mul_f32_dpp v182, v206, v182 row_newbcast:2 row_mask:0xf bank_mask:0xf
    v_mul_f32_dpp v183, v207, v183 row_newbcast:2 row_mask:0xf bank_mask:0xf
    v_cvt_pk_bf16_f32 v228, v176, v177
    v_cvt_pk_bf16_f32 v229, v178, v179
    v_cvt_pk_bf16_f32 v230, v180, v181
    v_cvt_pk_bf16_f32 v231, v182, v183
    buffer_store_dwordx4 v[228:231], v10, s[20:23], s54 offen offset:0
    v_lshlrev_b32 v184, 16, v232
    v_and_b32 v185, 0xffff0000, v232
    v_lshlrev_b32 v186, 16, v233
    v_and_b32 v187, 0xffff0000, v233
    v_lshlrev_b32 v188, 16, v234
    v_and_b32 v189, 0xffff0000, v234
    v_lshlrev_b32 v190, 16, v235
    v_and_b32 v191, 0xffff0000, v235
    v_subrev_f32_dpp v184, v200, v184 row_newbcast:4 row_mask:0xf bank_mask:0xf
    v_subrev_f32_dpp v185, v201, v185 row_newbcast:4 row_mask:0xf bank_mask:0xf
    v_subrev_f32_dpp v186, v202, v186 row_newbcast:4 row_mask:0xf bank_mask:0xf
    v_subrev_f32_dpp v187, v203, v187 row_newbcast:4 row_mask:0xf bank_mask:0xf
    v_subrev_f32_dpp v188, v200, v188 row_newbcast:6 row_mask:0xf bank_mask:0xf
    v_subrev_f32_dpp v189, v201, v189 row_newbcast:6 row_mask:0xf bank_mask:0xf
    v_subrev_f32_dpp v190, v202, v190 row_newbcast:6 row_mask:0xf bank_mask:0xf
    v_subrev_f32_dpp v191, v203, v191 row_newbcast:6 row_mask:0xf bank_mask:0xf
    v_mul_f32_dpp v184, v204, v184 row_newbcast:4 row_mask:0xf bank_mask:0xf
    v_mul_f32_dpp v185, v205, v185 row_newbcast:4 row_mask:0xf bank_mask:0xf
    v_mul_f32_dpp v186, v206, v186 row_newbcast:4 row_mask:0xf bank_mask:0xf
    v_mul_f32_dpp v187, v207, v187 row_newbcast:4 row_mask:0xf bank_mask:0xf
    v_mul_f32_dpp v188, v204, v188 row_newbcast:6 row_mask:0xf bank_mask:0xf
    v_mul_f32_dpp v189, v205, v189 row_newbcast:6 row_mask:0xf bank_mask:0xf
    v_mul_f32_dpp v190, v206, v190 row_newbcast:6 row_mask:0xf bank_mask:0xf
    v_mul_f32_dpp v191, v207, v191 row_newbcast:6 row_mask:0xf bank_mask:0xf
    v_cvt_pk_bf16_f32 v232, v184, v185
    v_cvt_pk_bf16_f32 v233, v186, v187
    v_cvt_pk_bf16_f32 v234, v188, v189
    v_cvt_pk_bf16_f32 v235, v190, v191
    buffer_store_dwordx4 v[232:235], v10, s[20:23], s54 offen offset:512
    s_cmp_lt_u32 s33, 68
    s_cbranch_scc1 k1_normed
    s_mov_b32 s33, s34
    s_nop 1
    v_mov_b32 v220, v236
    v_mov_b32 v221, v237
    v_mov_b32 v222, v238
    v_mov_b32 v223, v239
    v_mov_b32 v224, v240
    v_mov_b32 v225, v241
    v_mov_b32 v226, v242
    v_mov_b32 v227, v243
    v_mov_b32 v228, v244
    v_mov_b32 v229, v245
    v_mov_b32 v230, v246
    v_mov_b32 v231, v247
    v_mov_b32 v232, v248
    v_mov_b32 v233, v249
    v_mov_b32 v234, v250
    v_mov_b32 v235, v251
    s_branch k1_norm
k1_normed:
    s_cmp_lt_u32 s39, 16
    s_cbranch_scc1 k1_fin
    s_waitcnt vmcnt(8)
    s_add_u32 s46, s88, 4096
    buffer_store_dwordx4 v[236:239], v15, s[20:23], s88 offen offset:1024
    buffer_store_dwordx4 v[240:243], v15, s[20:23], s88 offen offset:3072
    buffer_store_dwordx4 v[244:247], v15, s[20:23], s46 offen offset:1024
    buffer_store_dwordx4 v[248:251], v15, s[20:23], s46 offen offset:3072
    s_branch k1_fin
k1_nonorm:
    s_cmp_eq_u32 s37, 0
    s_cbranch_scc0 k1_nobar
    s_cmp_ge_u32 s39, 16
    s_cbranch_scc1 k1_xw2
    s_cmp_lt_u32 s39, 12
    s_cbranch_scc1 k1_xw0
    s_waitcnt vmcnt(1)
k1_xw0:
    s_waitcnt vmcnt(4)
k1_xw2:
    s_waitcnt vmcnt(8)
    s_barrier
k1_nobar:
    s_mov_b32 s40, s41
    s_mov_b32 s41, s42
    s_mov_b32 s42, s43
    s_movk_i32 s43, 255
    s_add_u32 s35, s35, 1
    s_sub_u32 s45, 73728, s45
    s_branch k1_top
k1_fin:
k1_end:
    s_endpgm
.globl k3_kernel
.p2align 8
.type k3_kernel,@function
k3_kernel:
    s_cmp_ge_u32 s2, 256
    s_cbranch_scc1 k3_end
    s_load_dwordx2 s[4:5], s[0:1], 80
    s_load_dwordx2 s[30:31], s[0:1], 48
    s_and_b32 s32, s2, 7
    s_lshr_b32 s33, s2, 3
    s_and_b32 s34, s32, 1
    s_lshl_b32 s34, s34, 3
    s_and_b32 s35, s33, 7
    s_add_u32 s34, s34, s35
    s_lshr_b32 s35, s32, 1
    s_lshl_b32 s35, s35, 2
    s_lshr_b32 s36, s33, 3
    s_add_u32 s35, s35, s36
    v_lshrrev_b32 v6, 6, v0
    v_and_b32 v0, 63, v0
    s_nop 0
    v_readfirstlane_b32 s36, v6
    s_lshr_b32 s37, s36, 2
    s_and_b32 s38, s36, 3
    s_lshl_b32 s39, s34, 2
    s_add_u32 s38, s38, s39
    v_lshlrev_b32 v7, 4, v0
    s_and_b32 s50, s2, 7
    s_lshl_b32 s50, s50, 2
    s_bfe_u32 s43, s2, 0x20003
    s_add_u32 s50, s50, s43
    s_lshr_b32 s44, s2, 5
    s_lshl_b32 s44, s44, 3
    s_add_u32 s51, s44, s36
    s_mul_i32 s43, s50, 9
    s_lshr_b32 s43, s43, 3
    s_lshl_b32 s45, s43, 9
    s_mul_i32 s46, s51, 73728
    s_add_u32 s46, s46, s45
    s_add_u32 s46, s46, 2359296
    s_add_u32 s47, s46, 36864
    s_waitcnt lgkmcnt(0)
    s_mov_b32 s52, s4
    s_mov_b32 s53, s5
    s_mov_b32 s54, 0x3100000
    s_mov_b32 s55, 0x00020000
    buffer_load_dwordx4 v[164:167], v7, s[52:55], s46 offen
    buffer_load_dwordx4 v[168:171], v7, s[52:55], s47 offen
    s_lshl_b32 s46, s36, 1
    s_add_u32 s46, s46, s44
    s_sub_u32 s47, s46, 8
    s_cmp_lt_u32 s46, 8
    s_cselect_b32 s46, s46, s47
    s_mul_i32 s47, s46, 73728
    s_add_u32 s47, s47, s45
    s_add_u32 s47, s47, 2377728
    s_lshl_b32 s48, s36, 12
    s_add_u32 m0, s48, 110592
    v_lshrrev_b32 v8, 4, v0
    v_and_b32 v9, 15, v0
    buffer_load_dwordx4 v7, s[52:55], s47 offen offset:0 lds
    s_add_u32 s47, s47, 35840
    buffer_load_dwordx4 v7, s[52:55], s47 offen offset:1024 lds
    s_add_u32 s47, s47, 35840
    buffer_load_dwordx4 v7, s[52:55], s47 offen offset:2048 lds
    s_add_u32 s47, s47, 35840
    buffer_load_dwordx4 v7, s[52:55], s47 offen offset:3072 lds
    v_mul_u32_u24 v10, 9216, v8
    v_lshl_add_u32 v10, v9, 4, v10
    s_mul_i32 s47, s46, 36864
    s_mul_i32 s45, s50, 288
    s_add_u32 s45, s45, 7077888
    s_add_u32 s47, s47, s45
    s_lshl_b32 s48, s36, 11
    s_add_u32 m0, s48, 143360
    s_add_u32 s48, s47, 35840
    buffer_load_dwordx4 v10, s[52:55], s47 offen lds
    buffer_load_dwordx4 v10, s[52:55], s48 offen offset:1024 lds
    s_cmp_lt_u32 s36, 6
    s_cbranch_scc1 k3_nox
    v_lshrrev_b32 v11, 1, v0
    v_mul_u32_u24 v11, 9216, v11
    v_and_b32 v12, 1, v0
    v_lshl_add_u32 v11, v12, 4, v11
    s_and_b32 s47, s36, 1
    s_lshl_b32 s48, s47, 10
    s_add_u32 m0, s48, 159488
    s_lshl_b32 s47, s47, 3
    s_add_u32 s47, s47, s44
    s_sub_u32 s48, s47, 8
    s_cmp_lt_u32 s47, 8
    s_cselect_b32 s47, s47, s48
    s_mul_i32 s47, s47, 36864
    s_add_u32 s47, s47, s45
    buffer_load_dwordx4 v11, s[52:55], s47 offen offset:256 lds
    v_lshlrev_b32 v11, 7, v9
    v_mov_b32 v12, 0x3f803f80
    v_mov_b32 v13, 0x3f803f80
    v_mov_b32 v14, 0x3f803f80
    v_mov_b32 v15, 0x3f803f80
    v_add_u32 v11, 161792, v11
    ds_write_b128 v11, v[12:15]
k3_nox:
    s_mul_i32 s40, s37, 18432
    v_add_u32 v1, s40, v7
    v_add_u32 v2, 0x12000, v1
    s_lshl_b32 s41, s36, 12
    v_add_u32 v3, s41, v7
    s_lshl_b32 s42, s36, 10
    s_add_u32 s42, s42, 0x8000
    v_add_u32 v252, s42, v7
    s_sub_u32 s42, s42, s41
    s_lshl_b32 s43, s38, 17
    s_lshl_b32 s44, s37, 11
    s_add_u32 s43, s43, s44
    v_add_u32 v4, s43, v7
    v_add_u32 v5, 0x10000, v4
    s_mul_i32 s43, s35, 589824
    s_add_u32 s43, s43, 0x1200000
    s_add_u32 s8, s4, s43
    s_addc_u32 s9, s5, 0
    s_mov_b32 s10, 0x90000
    s_mov_b32 s11, 0x00020000
    s_add_u32 s12, s4, 0x2800000
    s_addc_u32 s13, s5, 0
    s_mov_b32 s14, 0x800000
    s_mov_b32 s15, 0x00020000
    s_mov_b32 s24, s30
    s_mov_b32 s25, s31
    s_mov_b32 s26, 0x1000
    s_mov_b32 s27, 0x00020000
    s_lshl_b32 s43, s38, 1
    s_add_u32 s43, s43, s37
    s_mul_i32 s44, s35, 9
    s_lshr_b32 s44, s44, 1
    s_mul_i32 s45, s43, 72
    s_add_u32 s45, s45, s44
    s_lshl_b32 s45, s45, 10
    s_add_u32 s45, s45, 0x900000
    s_add_u32 s16, s4, s45
    s_addc_u32 s17, s5, 0
    s_mov_b32 s18, 0x1400
    s_mov_b32 s19, 0x00020000
    s_mul_i32 s45, s43, 90
    s_add_u32 s45, s45, s44
    s_add_u32 s45, s45, 18
    s_lshl_b32 s45, s45, 10
    s_add_u32 s45, s45, 0x1c00000
    s_add_u32 s20, s4, s45
    s_addc_u32 s21, s5, 0
    s_mov_b32 s22, 0x1400
    s_mov_b32 s23, 0x00020000
    s_mov_b32 s46, 0
    s_mov_b32 s47, 0
    v_lshrrev_b32 v81, 2, v9
    v_sub_u32 v81, v81, v8
    v_lshlrev_b32 v81, 3, v81
    v_and_b32 v82, 3, v9
    v_add_u32 v81, v81, v82
    v_lshrrev_b32 v82, 1, v8
    v_lshlrev_b32 v82, 4, v82
    v_and_b32 v83, 1, v8
    v_lshl_add_u32 v82, v83, 2, v82
    s_mul_i32 s43, s50, 18
    s_and_b32 s43, s43, 15
    v_subrev_u32 v82, s43, v82
    v_lshlrev_b32 v253, 5, v8
    v_lshl_add_u32 v253, v9, 4, v253
    s_lshl_b32 s43, s36, 7
    s_add_u32 s43, s43, 159744
    v_add_u32 v253, s43, v253
    v_cmp_gt_u32 vcc, 2, v9
    v_mov_b32 v83, 161792
    s_lshl_b32 s43, s36, 11
    s_add_u32 s43, s43, 110592
    v_add_u32 v6, s43, v7
    v_cndmask_b32 v253, v83, v253, vcc
    v_mov_b32 v80, 0xf149f2ca
    v_add_u32 v83, 0, v82
    v_cmp_gt_u32 s[86:87], 18, v83
    v_add_u32 v83, 2, v82
    v_cmp_gt_u32 s[88:89], 18, v83
    v_add_u32 v83, 8, v82
    v_cmp_gt_u32 s[90:91], 18, v83
    v_add_u32 v83, 10, v82
    v_cmp_gt_u32 s[92:93], 18, v83
    v_cmp_le_i32 s[56:57], -4, v81
    v_cmp_le_i32 s[58:59], -3, v81
    v_cmp_le_i32 s[60:61], -2, v81
    v_cmp_le_i32 s[62:63], -1, v81
    v_cndmask_b32 v244, v80, 0, s[56:57]
    v_cndmask_b32 v180, 0, v80, s[56:57]
    v_cndmask_b32 v245, v80, 0, s[58:59]
    v_cndmask_b32 v181, 0, v80, s[58:59]
    v_cndmask_b32 v246, v80, 0, s[60:61]
    v_cndmask_b32 v182, 0, v80, s[60:61]
    v_cndmask_b32 v247, v80, 0, s[62:63]
    v_cndmask_b32 v183, 0, v80, s[62:63]
    v_cmp_le_i32 s[56:57], 0, v81
    v_cmp_le_i32 s[58:59], 1, v81
    v_cmp_le_i32 s[60:61], 2, v81
    v_cmp_le_i32 s[62:63], 3, v81
    v_cndmask_b32 v72, v80, 0, s[56:57]
    v_cndmask_b32 v8, 0, v80, s[56:57]
    v_cndmask_b32 v73, v80, 0, s[58:59]
    v_cndmask_b32 v9, 0, v80, s[58:59]
    v_cndmask_b32 v74, v80, 0, s[60:61]
    v_cndmask_b32 v10, 0, v80, s[60:61]
    v_cndmask_b32 v75, v80, 0, s[62:63]
    v_cndmask_b32 v11, 0, v80, s[62:63]
    v_cndmask_b32 v248, v80, 0, s[56:57]
    v_cndmask_b32 v184, 0, v80, s[56:57]
    v_cndmask_b32 v249, v80, 0, s[58:59]
    v_cndmask_b32 v185, 0, v80, s[58:59]
    v_cndmask_b32 v250, v80, 0, s[60:61]
    v_cndmask_b32 v186, 0, v80, s[60:61]
    v_cndmask_b32 v251, v80, 0, s[62:63]
    v_cndmask_b32 v187, 0, v80, s[62:63]
    v_cmp_le_i32 s[56:57], 4, v81
    v_cmp_le_i32 s[58:59], 5, v81
    v_cmp_le_i32 s[60:61], 6, v81
    v_cmp_le_i32 s[62:63], 7, v81
    v_cndmask_b32 v76, v80, 0, s[56:57]
    v_cndmask_b32 v12, 0, v80, s[56:57]
    v_cndmask_b32 v77, v80, 0, s[58:59]
    v_cndmask_b32 v13, 0, v80, s[58:59]
    v_cndmask_b32 v78, v80, 0, s[60:61]
    v_cndmask_b32 v14, 0, v80, s[60:61]
    v_cndmask_b32 v79, v80, 0, s[62:63]
    v_cndmask_b32 v15, 0, v80, s[62:63]
    s_mov_b32 s56, 0x3eae1a93
    s_mov_b32 s57, 0x3eae1a93
    s_waitcnt vmcnt(0) lgkmcnt(0)
    s_barrier
    ds_read_b128 v[96:99], v6 offset:0
    ds_read_b128 v[100:103], v6 offset:1024
    ds_read_b128 v[104:107], v6 offset:2048
    ds_read_b128 v[108:111], v6 offset:3072
    ds_read_b128 v[112:115], v6 offset:4096
    ds_read_b128 v[172:175], v6 offset:5120
    ds_read_b128 v[176:179], v6 offset:6144
    v_cndmask_b32 v164, 0, v164, s[86:87]
    v_cndmask_b32 v165, 0, v165, s[88:89]
    v_cndmask_b32 v166, 0, v166, s[90:91]
    v_cndmask_b32 v167, 0, v167, s[92:93]
    v_cndmask_b32 v168, 0, v168, s[86:87]
    v_cndmask_b32 v169, 0, v169, s[88:89]
    v_cndmask_b32 v170, 0, v170, s[90:91]
    v_cndmask_b32 v171, 0, v171, s[92:93]
    s_waitcnt lgkmcnt(6)
    v_mfma_f32_16x16x32_bf16 v[8:11], v[96:99], v[164:167], v[8:11]
    v_mfma_f32_16x16x32_bf16 v[180:183], v[96:99], v[168:171], v[180:183]
    ds_read_b128 v[96:99], v6 offset:7168
    buffer_load_dwordx4 v[116:119], v4, s[12:15], s46 offen offset:0
    buffer_load_dwordx4 v[120:123], v5, s[12:15], s46 offen offset:0
    s_waitcnt lgkmcnt(6)
    v_mfma_f32_16x16x32_bf16 v[12:15], v[100:103], v[164:167], v[12:15]
    v_mfma_f32_16x16x32_bf16 v[184:187], v[100:103], v[168:171], v[184:187]
    ds_read_b128 v[100:103], v6 offset:8192
    buffer_load_dwordx4 v[124:127], v4, s[12:15], s46 offen offset:1024
    buffer_load_dwordx4 v[128:131], v5, s[12:15], s46 offen offset:1024
    s_waitcnt lgkmcnt(6)
    v_mfma_f32_16x16x32_bf16 v[16:19], v[104:107], v[164:167], 0
    v_mfma_f32_16x16x32_bf16 v[188:191], v[104:107], v[168:171], 0
    ds_read_b128 v[104:107], v6 offset:9216
    s_add_u32 s46, s46, 4096
    s_add_u32 m0, s41, 0
    s_nop 0
    buffer_load_dwordx4 v3, s[8:11], s47 offen offset:0 lds
    s_waitcnt lgkmcnt(6)
    v_mfma_f32_16x16x32_bf16 v[20:23], v[108:111], v[164:167], 0
    v_mfma_f32_16x16x32_bf16 v[192:195], v[108:111], v[168:171], 0
    ds_read_b128 v[108:111], v6 offset:10240
    buffer_load_dwordx4 v3, s[8:11], s47 offen offset:1024 lds
    buffer_load_dwordx4 v3, s[8:11], s47 offen offset:2048 lds
    s_waitcnt lgkmcnt(6)
    v_mfma_f32_16x16x32_bf16 v[24:27], v[112:115], v[164:167], 0
    v_mfma_f32_16x16x32_bf16 v[196:199], v[112:115], v[168:171], 0
    ds_read_b128 v[112:115], v6 offset:11264
    buffer_load_dwordx4 v3, s[8:11], s47 offen offset:3072 lds
    s_cmp_lg_u32 s37, 0
    s_cbranch_scc1 k3_sk1
    s_add_u32 m0, m0, s42
    s_nop 0
    buffer_load_dwordx4 v252, s[8:11], s47 offen lds
k3_sk1:
    s_add_u32 s47, s47, 36864
    s_waitcnt lgkmcnt(6)
    v_mfma_f32_16x16x32_bf16 v[28:31], v[172:175], v[164:167], 0
    v_mfma_f32_16x16x32_bf16 v[200:203], v[172:175], v[168:171], 0
    ds_read_b128 v[172:175], v6 offset:12288
    buffer_load_dwordx4 v[132:135], v4, s[12:15], s46 offen offset:0
    buffer_load_dwordx4 v[136:139], v5, s[12:15], s46 offen offset:0
    s_waitcnt lgkmcnt(6)
    v_mfma_f32_16x16x32_bf16 v[32:35], v[176:179], v[164:167], 0
    v_mfma_f32_16x16x32_bf16 v[204:207], v[176:179], v[168:171], 0
    ds_read_b128 v[176:179], v6 offset:13312
    buffer_load_dwordx4 v[140:143], v4, s[12:15], s46 offen offset:1024
    buffer_load_dwordx4 v[144:147], v5, s[12:15], s46 offen offset:1024
    s_waitcnt lgkmcnt(6)
    v_mfma_f32_16x16x32_bf16 v[36:39], v[96:99], v[164:167], 0
    v_mfma_f32_16x16x32_bf16 v[208:211], v[96:99], v[168:171], 0
    ds_read_b128 v[96:99], v6 offset:14336
    s_add_u32 s46, s46, 4096
    s_add_u32 m0, s41, 36864
    s_nop 0
    buffer_load_dwordx4 v3, s[8:11], s47 offen offset:0 lds
    s_waitcnt lgkmcnt(6)
    v_mfma_f32_16x16x32_bf16 v[40:43], v[100:103], v[164:167], 0
    v_mfma_f32_16x16x32_bf16 v[212:215], v[100:103], v[168:171], 0
    ds_read_b128 v[100:103], v6 offset:15360
    buffer_load_dwordx4 v3, s[8:11], s47 offen offset:1024 lds
    buffer_load_dwordx4 v3, s[8:11], s47 offen offset:2048 lds
    s_waitcnt lgkmcnt(6)
    v_mfma_f32_16x16x32_bf16 v[44:47], v[104:107], v[164:167], 0
    v_mfma_f32_16x16x32_bf16 v[216:219], v[104:107], v[168:171], 0
    ds_read_b128 v[104:107], v6 offset:16384
    buffer_load_dwordx4 v3, s[8:11], s47 offen offset:3072 lds
    s_cmp_lg_u32 s37, 0
    s_cbranch_scc1 k3_sk2
    s_add_u32 m0, m0, s42
    s_nop 0
    buffer_load_dwordx4 v252, s[8:11], s47 offen lds
k3_sk2:
    s_add_u32 s47, s47, 36864
    s_waitcnt lgkmcnt(6)
    v_mfma_f32_16x16x32_bf16 v[48:51], v[108:111], v[164:167], 0
    v_mfma_f32_16x16x32_bf16 v[220:223], v[108:111], v[168:171], 0
    ds_read_b128 v[108:111], v6 offset:17408
    buffer_load_dwordx4 v[148:151], v4, s[12:15], s46 offen offset:0
    buffer_load_dwordx4 v[152:155], v5, s[12:15], s46 offen offset:0
    s_waitcnt lgkmcnt(6)
    v_mfma_f32_16x16x32_bf16 v[52:55], v[112:115], v[164:167], 0
    v_mfma_f32_16x16x32_bf16 v[224:227], v[112:115], v[168:171], 0
    s_lshl_b32 s43, s36, 10
    s_sub_u32 s43, 32768, s43
    v_add_u32 v6, s43, v6
    ds_read_b128 v[112:115], v6 offset:0
    buffer_load_dwordx4 v[156:159], v4, s[12:15], s46 offen offset:1024
    buffer_load_dwordx4 v[160:163], v5, s[12:15], s46 offen offset:1024
    s_waitcnt lgkmcnt(6)
    v_mfma_f32_16x16x32_bf16 v[56:59], v[172:175], v[164:167], 0
    v_mfma_f32_16x16x32_bf16 v[228:231], v[172:175], v[168:171], 0
    ds_read_b128 v[172:175], v253 offset:0
    s_add_u32 s46, s46, 4096
    s_add_u32 m0, s41, 73728
    s_nop 0
    buffer_load_dwordx4 v3, s[8:11], s47 offen offset:0 lds
    s_waitcnt lgkmcnt(6)
    v_mfma_f32_16x16x32_bf16 v[60:63], v[176:179], v[164:167], 0
    v_mfma_f32_16x16x32_bf16 v[232:235], v[176:179], v[168:171], 0
    ds_read_b128 v[176:179], v6 offset:1024
    buffer_load_dwordx4 v3, s[8:11], s47 offen offset:1024 lds
    buffer_load_dwordx4 v3, s[8:11], s47 offen offset:2048 lds
    s_waitcnt lgkmcnt(6)
    v_mfma_f32_16x16x32_bf16 v[64:67], v[96:99], v[164:167], 0
    v_mfma_f32_16x16x32_bf16 v[236:239], v[96:99], v[168:171], 0
    ds_read_b128 v[96:99], v253 offset:128
    buffer_load_dwordx4 v3, s[8:11], s47 offen offset:3072 lds
    s_cmp_lg_u32 s37, 0
    s_cbranch_scc1 k3_sk3
    s_add_u32 m0, m0, s42
    s_nop 0
    buffer_load_dwordx4 v252, s[8:11], s47 offen lds
k3_sk3:
    s_add_u32 s47, s47, 36864
    s_waitcnt lgkmcnt(6)
    v_mfma_f32_16x16x32_bf16 v[68:71], v[100:103], v[164:167], 0
    v_mfma_f32_16x16x32_bf16 v[240:243], v[100:103], v[168:171], 0
    ds_read_b128 v[100:103], v6 offset:2048
    s_waitcnt lgkmcnt(6)
    v_mfma_f32_16x16x32_bf16 v[72:75], v[104:107], v[164:167], v[72:75]
    v_mfma_f32_16x16x32_bf16 v[244:247], v[104:107], v[168:171], v[244:247]
    ds_read_b128 v[104:107], v253 offset:256
    s_waitcnt lgkmcnt(6)
    v_mfma_f32_16x16x32_bf16 v[76:79], v[108:111], v[164:167], v[76:79]
    v_mfma_f32_16x16x32_bf16 v[248:251], v[108:111], v[168:171], v[248:251]
    ds_read_b128 v[108:111], v6 offset:3072
    s_cmp_ge_u32 s51, 8
    s_cbranch_scc1 k3_nofix
    s_nop 7
    s_cmp_ge_u32 s51, 8
    s_cbranch_scc1 k3_nofix
    v_mov_b32 v8, v80
    v_mov_b32 v9, v80
    v_mov_b32 v10, v80
    v_mov_b32 v11, v80
    v_mov_b32 v12, v80
    v_mov_b32 v13, v80
    v_mov_b32 v14, v80
    v_mov_b32 v15, v80
    v_mov_b32 v180, v80
    v_mov_b32 v181, v80
    v_mov_b32 v182, v80
    v_mov_b32 v183, v80
    v_mov_b32 v184, v80
    v_mov_b32 v185, v80
    v_mov_b32 v186, v80
    v_mov_b32 v187, v80
    s_cmp_ge_u32 s51, 7
    s_cbranch_scc1 k3_nofix
    v_mov_b32 v16, v80
    v_mov_b32 v17, v80
    v_mov_b32 v18, v80
    v_mov_b32 v19, v80
    v_mov_b32 v20, v80
    v_mov_b32 v21, v80
    v_mov_b32 v22, v80
    v_mov_b32 v23, v80
    v_mov_b32 v188, v80
    v_mov_b32 v189, v80
    v_mov_b32 v190, v80
    v_mov_b32 v191, v80
    v_mov_b32 v192, v80
    v_mov_b32 v193, v80
    v_mov_b32 v194, v80
    v_mov_b32 v195, v80
    s_cmp_ge_u32 s51, 6
    s_cbranch_scc1 k3_nofix
    v_mov_b32 v24, v80
    v_mov_b32 v25, v80
    v_mov_b32 v26, v80
    v_mov_b32 v27, v80
    v_mov_b32 v28, v80
    v_mov_b32 v29, v80
    v_mov_b32 v30, v80
    v_mov_b32 v31, v80
    v_mov_b32 v196, v80
    v_mov_b32 v197, v80
    v_mov_b32 v198, v80
    v_mov_b32 v199, v80
    v_mov_b32 v200, v80
    v_mov_b32 v201, v80
    v_mov_b32 v202, v80
    v_mov_b32 v203, v80
    s_cmp_ge_u32 s51, 5
    s_cbranch_scc1 k3_nofix
    v_mov_b32 v32, v80
    v_mov_b32 v33, v80
    v_mov_b32 v34, v80
    v_mov_b32 v35, v80
    v_mov_b32 v36, v80
    v_mov_b32 v37, v80
    v_mov_b32 v38, v80
    v_mov_b32 v39, v80
    v_mov_b32 v204, v80
    v_mov_b32 v205, v80
    v_mov_b32 v206, v80
    v_mov_b32 v207, v80
    v_mov_b32 v208, v80
    v_mov_b32 v209, v80
    v_mov_b32 v210, v80
    v_mov_b32 v211, v80
    s_cmp_ge_u32 s51, 4
    s_cbranch_scc1 k3_nofix
    v_mov_b32 v40, v80
    v_mov_b32 v41, v80
    v_mov_b32 v42, v80
    v_mov_b32 v43, v80
    v_mov_b32 v44, v80
    v_mov_b32 v45, v80
    v_mov_b32 v46, v80
    v_mov_b32 v47, v80
    v_mov_b32 v212, v80
    v_mov_b32 v213, v80
    v_mov_b32 v214, v80
    v_mov_b32 v215, v80
    v_mov_b32 v216, v80
    v_mov_b32 v217, v80
    v_mov_b32 v218, v80
    v_mov_b32 v219, v80
    s_cmp_ge_u32 s51, 3
    s_cbranch_scc1 k3_nofix
    v_mov_b32 v48, v80
    v_mov_b32 v49, v80
    v_mov_b32 v50, v80
    v_mov_b32 v51, v80
    v_mov_b32 v52, v80
    v_mov_b32 v53, v80
    v_mov_b32 v54, v80
    v_mov_b32 v55, v80
    v_mov_b32 v220, v80
    v_mov_b32 v221, v80
    v_mov_b32 v222, v80
    v_mov_b32 v223, v80
    v_mov_b32 v224, v80
    v_mov_b32 v225, v80
    v_mov_b32 v226, v80
    v_mov_b32 v227, v80
    s_cmp_ge_u32 s51, 2
    s_cbranch_scc1 k3_nofix
    v_mov_b32 v56, v80
    v_mov_b32 v57, v80
    v_mov_b32 v58, v80
    v_mov_b32 v59, v80
    v_mov_b32 v60, v80
    v_mov_b32 v61, v80
    v_mov_b32 v62, v80
    v_mov_b32 v63, v80
    v_mov_b32 v228, v80
    v_mov_b32 v229, v80
    v_mov_b32 v230, v80
    v_mov_b32 v231, v80
    v_mov_b32 v232, v80
    v_mov_b32 v233, v80
    v_mov_b32 v234, v80
    v_mov_b32 v235, v80
    s_cmp_ge_u32 s51, 1
    s_cbranch_scc1 k3_nofix
    v_mov_b32 v64, v80
    v_mov_b32 v65, v80
    v_mov_b32 v66, v80
    v_mov_b32 v67, v80
    v_mov_b32 v68, v80
    v_mov_b32 v69, v80
    v_mov_b32 v70, v80
    v_mov_b32 v71, v80
    v_mov_b32 v236, v80
    v_mov_b32 v237, v80
    v_mov_b32 v238, v80
    v_mov_b32 v239, v80
    v_mov_b32 v240, v80
    v_mov_b32 v241, v80
    v_mov_b32 v242, v80
    v_mov_b32 v243, v80
k3_nofix:
    v_max3_f32 v254, v8, v9, v10
    v_max3_f32 v255, v180, v181, v182
    v_max3_f32 v254, v11, v12, v254
    v_max3_f32 v255, v183, v184, v255
    v_max3_f32 v254, v13, v14, v254
    v_max3_f32 v255, v185, v186, v255
    v_max3_f32 v254, v15, v16, v254
    v_max3_f32 v255, v187, v188, v255
    v_max3_f32 v254, v17, v18, v254
    v_max3_f32 v255, v189, v190, v255
    v_max3_f32 v254, v19, v20, v254
    v_max3_f32 v255, v191, v192, v255
    v_max3_f32 v254, v21, v22, v254
    v_max3_f32 v255, v193, v194, v255
    v_max3_f32 v254, v23, v24, v254
    v_max3_f32 v255, v195, v196, v255
    v_max3_f32 v254, v25, v26, v254
    v_max3_f32 v255, v197, v198, v255
    v_max3_f32 v254, v27, v28, v254
    v_max3_f32 v255, v199, v200, v255
    v_max3_f32 v254, v29, v30, v254
    v_max3_f32 v255, v201, v202, v255
    v_max3_f32 v254, v31, v32, v254
    v_max3_f32 v255, v203, v204, v255
    v_max3_f32 v254, v33, v34, v254
    v_max3_f32 v255, v205, v206, v255
    v_max3_f32 v254, v35, v36, v254
    v_max3_f32 v255, v207, v208, v255
    v_max3_f32 v254, v37, v38, v254
    v_max3_f32 v255, v209, v210, v255
    v_max3_f32 v254, v39, v40, v254
    v_max3_f32 v255, v211, v212, v255
    v_max3_f32 v254, v41, v42, v254
    v_max3_f32 v255, v213, v214, v255
    v_max3_f32 v254, v43, v44, v254
    v_max3_f32 v255, v215, v216, v255
    v_max3_f32 v254, v45, v46, v254
    v_max3_f32 v255, v217, v218, v255
    v_max3_f32 v254, v47, v48, v254
    v_max3_f32 v255, v219, v220, v255
    v_max3_f32 v254, v49, v50, v254
    v_max3_f32 v255, v221, v222, v255
    v_max3_f32 v254, v51, v52, v254
    v_max3_f32 v255, v223, v224, v255
    v_max3_f32 v254, v53, v54, v254
    v_max3_f32 v255, v225, v226, v255
    v_max3_f32 v254, v55, v56, v254
    v_max3_f32 v255, v227, v228, v255
    v_max3_f32 v254, v57, v58, v254
    v_max3_f32 v255, v229, v230, v255
    v_max3_f32 v254, v59, v60, v254
    v_max3_f32 v255, v231, v232, v255
    v_max3_f32 v254, v61, v62, v254
    v_max3_f32 v255, v233, v234, v255
    v_max3_f32 v254, v63, v64, v254
    v_max3_f32 v255, v235, v236, v255
    v_max3_f32 v254, v65, v66, v254
    v_max3_f32 v255, v237, v238, v255
    v_max3_f32 v254, v67, v68, v254
    v_max3_f32 v255, v239, v240, v255
    v_max3_f32 v254, v69, v70, v254
    v_max3_f32 v255, v241, v242, v255
    v_max3_f32 v254, v71, v72, v254
    v_max3_f32 v255, v243, v244, v255
    v_max3_f32 v254, v73, v74, v254
    v_max3_f32 v255, v245, v246, v255
    v_max3_f32 v254, v75, v76, v254
    v_max3_f32 v255, v247, v248, v255
    v_max3_f32 v254, v77, v78, v254
    v_max3_f32 v255, v249, v250, v255
    v_max_f32 v254, v79, v254
    v_max_f32 v255, v251, v255
    v_mov_b32 v164, v254
    v_mov_b32 v165, v255
    s_nop 0
    v_permlane32_swap_b32 v254, v164
    v_permlane32_swap_b32 v255, v165
    s_nop 0
    v_max_f32 v254, v254, v164
    v_max_f32 v255, v255, v165
    v_mov_b32 v164, v254
    v_mov_b32 v165, v255
    s_nop 0
    v_permlane16_swap_b32 v254, v164
    v_permlane16_swap_b32 v255, v165
    s_nop 0
    v_max_f32 v254, v254, v164
    v_max_f32 v255, v255, v165
    v_mul_f32 v166, s56, v254
    v_mul_f32 v167, s56, v254
    v_mul_f32 v168, s56, v255
    v_mul_f32 v169, s56, v255
    v_pk_fma_f32 v[8:9], v[8:9], s[56:57], v[166:167] neg_lo:[0,0,1] neg_hi:[0,0,1]
    v_pk_fma_f32 v[10:11], v[10:11], s[56:57], v[166:167] neg_lo:[0,0,1] neg_hi:[0,0,1]
    v_pk_fma_f32 v[12:13], v[12:13], s[56:57], v[166:167] neg_lo:[0,0,1] neg_hi:[0,0,1]
    v_pk_fma_f32 v[14:15], v[14:15], s[56:57], v[166:167] neg_lo:[0,0,1] neg_hi:[0,0,1]
    v_exp_f32 v8, v8
    v_exp_f32 v9, v9
    v_exp_f32 v10, v10
    v_exp_f32 v11, v11
    v_exp_f32 v12, v12
    v_exp_f32 v13, v13
    v_exp_f32 v14, v14
    v_exp_f32 v15, v15
    s_nop 0
    v_cvt_pk_bf16_f32 v8, v8, v9
    v_cvt_pk_bf16_f32 v9, v10, v11
    v_cvt_pk_bf16_f32 v10, v12, v13
    v_cvt_pk_bf16_f32 v11, v14, v15
    v_pk_fma_f32 v[180:181], v[180:181], s[56:57], v[168:169] neg_lo:[0,0,1] neg_hi:[0,0,1]
    v_pk_fma_f32 v[182:183], v[182:183], s[56:57], v[168:169] neg_lo:[0,0,1] neg_hi:[0,0,1]
    v_pk_fma_f32 v[184:185], v[184:185], s[56:57], v[168:169] neg_lo:[0,0,1] neg_hi:[0,0,1]
    v_pk_fma_f32 v[186:187], v[186:187], s[56:57], v[168:169] neg_lo:[0,0,1] neg_hi:[0,0,1]
    v_exp_f32 v180, v180
    v_exp_f32 v181, v181
    v_exp_f32 v182, v182
    v_exp_f32 v183, v183
    v_exp_f32 v184, v184
    v_exp_f32 v185, v185
    v_exp_f32 v186, v186
    v_exp_f32 v187, v187
    s_nop 0
    v_cvt_pk_bf16_f32 v180, v180, v181
    v_cvt_pk_bf16_f32 v181, v182, v183
    v_cvt_pk_bf16_f32 v182, v184, v185
    v_cvt_pk_bf16_f32 v183, v186, v187
    v_pk_fma_f32 v[16:17], v[16:17], s[56:57], v[166:167] neg_lo:[0,0,1] neg_hi:[0,0,1]
    v_pk_fma_f32 v[18:19], v[18:19], s[56:57], v[166:167] neg_lo:[0,0,1] neg_hi:[0,0,1]
    v_pk_fma_f32 v[20:21], v[20:21], s[56:57], v[166:167] neg_lo:[0,0,1] neg_hi:[0,0,1]
    v_pk_fma_f32 v[22:23], v[22:23], s[56:57], v[166:167] neg_lo:[0,0,1] neg_hi:[0,0,1]
    v_exp_f32 v16, v16
    v_exp_f32 v17, v17
    v_exp_f32 v18, v18
    v_exp_f32 v19, v19
    v_exp_f32 v20, v20
    v_exp_f32 v21, v21
    v_exp_f32 v22, v22
    v_exp_f32 v23, v23
    s_waitcnt lgkmcnt(6)
    v_mfma_f32_16x16x32_bf16 v[80:83], v[112:115], v[8:11], 0
    v_mfma_f32_16x16x32_bf16 v[88:91], v[112:115], v[180:183], 0
    ds_read_b128 v[112:115], v253 offset:384
    v_cvt_pk_bf16_f32 v16, v16, v17
    v_cvt_pk_bf16_f32 v17, v18, v19
    v_cvt_pk_bf16_f32 v18, v20, v21
    v_cvt_pk_bf16_f32 v19, v22, v23
    v_pk_fma_f32 v[188:189], v[188:189], s[56:57], v[168:169] neg_lo:[0,0,1] neg_hi:[0,0,1]
    v_pk_fma_f32 v[190:191], v[190:191], s[56:57], v[168:169] neg_lo:[0,0,1] neg_hi:[0,0,1]
    v_pk_fma_f32 v[192:193], v[192:193], s[56:57], v[168:169] neg_lo:[0,0,1] neg_hi:[0,0,1]
    v_pk_fma_f32 v[194:195], v[194:195], s[56:57], v[168:169] neg_lo:[0,0,1] neg_hi:[0,0,1]
    v_exp_f32 v188, v188
    v_exp_f32 v189, v189
    v_exp_f32 v190, v190
    v_exp_f32 v191, v191
    v_exp_f32 v192, v192
    v_exp_f32 v193, v193
    v_exp_f32 v194, v194
    v_exp_f32 v195, v195
    s_waitcnt lgkmcnt(6)
    v_mfma_f32_16x16x32_bf16 v[84:87], v[172:175], v[8:11], 0
    v_mfma_f32_16x16x32_bf16 v[92:95], v[172:175], v[180:183], 0
    ds_read_b128 v[172:175], v6 offset:4096
    v_cvt_pk_bf16_f32 v188, v188, v189
    v_cvt_pk_bf16_f32 v189, v190, v191
    v_cvt_pk_bf16_f32 v190, v192, v193
    v_cvt_pk_bf16_f32 v191, v194, v195
    v_pk_fma_f32 v[24:25], v[24:25], s[56:57], v[166:167] neg_lo:[0,0,1] neg_hi:[0,0,1]
    v_pk_fma_f32 v[26:27], v[26:27], s[56:57], v[166:167] neg_lo:[0,0,1] neg_hi:[0,0,1]
    v_pk_fma_f32 v[28:29], v[28:29], s[56:57], v[166:167] neg_lo:[0,0,1] neg_hi:[0,0,1]
    v_pk_fma_f32 v[30:31], v[30:31], s[56:57], v[166:167] neg_lo:[0,0,1] neg_hi:[0,0,1]
    v_exp_f32 v24, v24
    v_exp_f32 v25, v25
    v_exp_f32 v26, v26
    v_exp_f32 v27, v27
    v_exp_f32 v28, v28
    v_exp_f32 v29, v29
    v_exp_f32 v30, v30
    v_exp_f32 v31, v31
    s_waitcnt lgkmcnt(6)
    v_mfma_f32_16x16x32_bf16 v[80:83], v[176:179], v[16:19], v[80:83]
    v_mfma_f32_16x16x32_bf16 v[88:91], v[176:179], v[188:191], v[88:91]
    ds_read_b128 v[176:179], v253 offset:512
    v_cvt_pk_bf16_f32 v24, v24, v25
    v_cvt_pk_bf16_f32 v25, v26, v27
    v_cvt_pk_bf16_f32 v26, v28, v29
    v_cvt_pk_bf16_f32 v27, v30, v31
    v_pk_fma_f32 v[196:197], v[196:197], s[56:57], v[168:169] neg_lo:[0,0,1] neg_hi:[0,0,1]
    v_pk_fma_f32 v[198:199], v[198:199], s[56:57], v[168:169] neg_lo:[0,0,1] neg_hi:[0,0,1]
    v_pk_fma_f32 v[200:201], v[200:201], s[56:57], v[168:169] neg_lo:[0,0,1] neg_hi:[0,0,1]
    v_pk_fma_f32 v[202:203], v[202:203], s[56:57], v[168:169] neg_lo:[0,0,1] neg_hi:[0,0,1]
    v_exp_f32 v196, v196
    v_exp_f32 v197, v197
    v_exp_f32 v198, v198
    v_exp_f32 v199, v199
    v_exp_f32 v200, v200
    v_exp_f32 v201, v201
    v_exp_f32 v202, v202
    v_exp_f32 v203, v203
    s_waitcnt lgkmcnt(6)
    v_mfma_f32_16x16x32_bf16 v[84:87], v[96:99], v[16:19], v[84:87]
    v_mfma_f32_16x16x32_bf16 v[92:95], v[96:99], v[188:191], v[92:95]
    ds_read_b128 v[96:99], v6 offset:5120
    v_cvt_pk_bf16_f32 v196, v196, v197
    v_cvt_pk_bf16_f32 v197, v198, v199
    v_cvt_pk_bf16_f32 v198, v200, v201
    v_cvt_pk_bf16_f32 v199, v202, v203
    v_pk_fma_f32 v[32:33], v[32:33], s[56:57], v[166:167] neg_lo:[0,0,1] neg_hi:[0,0,1]
    v_pk_fma_f32 v[34:35], v[34:35], s[56:57], v[166:167] neg_lo:[0,0,1] neg_hi:[0,0,1]
    v_pk_fma_f32 v[36:37], v[36:37], s[56:57], v[166:167] neg_lo:[0,0,1] neg_hi:[0,0,1]
    v_pk_fma_f32 v[38:39], v[38:39], s[56:57], v[166:167] neg_lo:[0,0,1] neg_hi:[0,0,1]
    v_exp_f32 v32, v32
    v_exp_f32 v33, v33
    v_exp_f32 v34, v34
    v_exp_f32 v35, v35
    v_exp_f32 v36, v36
    v_exp_f32 v37, v37
    v_exp_f32 v38, v38
    v_exp_f32 v39, v39
    s_waitcnt lgkmcnt(6)
    v_mfma_f32_16x16x32_bf16 v[80:83], v[100:103], v[24:27], v[80:83]
    v_mfma_f32_16x16x32_bf16 v[88:91], v[100:103], v[196:199], v[88:91]
    ds_read_b128 v[100:103], v253 offset:640
    v_cvt_pk_bf16_f32 v32, v32, v33
    v_cvt_pk_bf16_f32 v33, v34, v35
    v_cvt_pk_bf16_f32 v34, v36, v37
    v_cvt_pk_bf16_f32 v35, v38, v39
    v_pk_fma_f32 v[204:205], v[204:205], s[56:57], v[168:169] neg_lo:[0,0,1] neg_hi:[0,0,1]
    v_pk_fma_f32 v[206:207], v[206:207], s[56:57], v[168:169] neg_lo:[0,0,1] neg_hi:[0,0,1]
    v_pk_fma_f32 v[208:209], v[208:209], s[56:57], v[168:169] neg_lo:[0,0,1] neg_hi:[0,0,1]
    v_pk_fma_f32 v[210:211], v[210:211], s[56:57], v[168:169] neg_lo:[0,0,1] neg_hi:[0,0,1]
    v_exp_f32 v204, v204
    v_exp_f32 v205, v205
    v_exp_f32 v206, v206
    v_exp_f32 v207, v207
    v_exp_f32 v208, v208
    v_exp_f32 v209, v209
    v_exp_f32 v210, v210
    v_exp_f32 v211, v211
    s_waitcnt lgkmcnt(6)
    v_mfma_f32_16x16x32_bf16 v[84:87], v[104:107], v[24:27], v[84:87]
    v_mfma_f32_16x16x32_bf16 v[92:95], v[104:107], v[196:199], v[92:95]
    ds_read_b128 v[104:107], v6 offset:6144
    v_cvt_pk_bf16_f32 v204, v204, v205
    v_cvt_pk_bf16_f32 v205, v206, v207
    v_cvt_pk_bf16_f32 v206, v208, v209
    v_cvt_pk_bf16_f32 v207, v210, v211
    v_pk_fma_f32 v[40:41], v[40:41], s[56:57], v[166:167] neg_lo:[0,0,1] neg_hi:[0,0,1]
    v_pk_fma_f32 v[42:43], v[42:43], s[56:57], v[166:167] neg_lo:[0,0,1] neg_hi:[0,0,1]
    v_pk_fma_f32 v[44:45], v[44:45], s[56:57], v[166:167] neg_lo:[0,0,1] neg_hi:[0,0,1]
    v_pk_fma_f32 v[46:47], v[46:47], s[56:57], v[166:167] neg_lo:[0,0,1] neg_hi:[0,0,1]
    v_exp_f32 v40, v40
    v_exp_f32 v41, v41
    v_exp_f32 v42, v42
    v_exp_f32 v43, v43
    v_exp_f32 v44, v44
    v_exp_f32 v45, v45
    v_exp_f32 v46, v46
    v_exp_f32 v47, v47
    s_waitcnt lgkmcnt(6)
    v_mfma_f32_16x16x32_bf16 v[80:83], v[108:111], v[32:35], v[80:83]
    v_mfma_f32_16x16x32_bf16 v[88:91], v[108:111], v[204:207], v[88:91]
    ds_read_b128 v[108:111], v253 offset:768
    v_cvt_pk_bf16_f32 v40, v40, v41
    v_cvt_pk_bf16_f32 v41, v42, v43
    v_cvt_pk_bf16_f32 v42, v44, v45
    v_cvt_pk_bf16_f32 v43, v46, v47
    v_pk_fma_f32 v[212:213], v[212:213], s[56:57], v[168:169] neg_lo:[0,0,1] neg_hi:[0,0,1]
    v_pk_fma_f32 v[214:215], v[214:215], s[56:57], v[168:169] neg_lo:[0,0,1] neg_hi:[0,0,1]
    v_pk_fma_f32 v[216:217], v[216:217], s[56:57], v[168:169] neg_lo:[0,0,1] neg_hi:[0,0,1]
    v_pk_fma_f32 v[218:219], v[218:219], s[56:57], v[168:169] neg_lo:[0,0,1] neg_hi:[0,0,1]
    v_exp_f32 v212, v212
    v_exp_f32 v213, v213
    v_exp_f32 v214, v214
    v_exp_f32 v215, v215
    v_exp_f32 v216, v216
    v_exp_f32 v217, v217
    v_exp_f32 v218, v218
    v_exp_f32 v219, v219
    s_waitcnt lgkmcnt(6)
    v_mfma_f32_16x16x32_bf16 v[84:87], v[112:115], v[32:35], v[84:87]
    v_mfma_f32_16x16x32_bf16 v[92:95], v[112:115], v[204:207], v[92:95]
    ds_read_b128 v[112:115], v6 offset:7168
    v_cvt_pk_bf16_f32 v212, v212, v213
    v_cvt_pk_bf16_f32 v213, v214, v215
    v_cvt_pk_bf16_f32 v214, v216, v217
    v_cvt_pk_bf16_f32 v215, v218, v219
    v_pk_fma_f32 v[48:49], v[48:49], s[56:57], v[166:167] neg_lo:[0,0,1] neg_hi:[0,0,1]
    v_pk_fma_f32 v[50:51], v[50:51], s[56:57], v[166:167] neg_lo:[0,0,1] neg_hi:[0,0,1]
    v_pk_fma_f32 v[52:53], v[52:53], s[56:57], v[166:167] neg_lo:[0,0,1] neg_hi:[0,0,1]
    v_pk_fma_f32 v[54:55], v[54:55], s[56:57], v[166:167] neg_lo:[0,0,1] neg_hi:[0,0,1]
    v_exp_f32 v48, v48
    v_exp_f32 v49, v49
    v_exp_f32 v50, v50
    v_exp_f32 v51, v51
    v_exp_f32 v52, v52
    v_exp_f32 v53, v53
    v_exp_f32 v54, v54
    v_exp_f32 v55, v55
    s_waitcnt lgkmcnt(6)
    v_mfma_f32_16x16x32_bf16 v[80:83], v[172:175], v[40:43], v[80:83]
    v_mfma_f32_16x16x32_bf16 v[88:91], v[172:175], v[212:215], v[88:91]
    ds_read_b128 v[172:175], v253 offset:896
    v_cvt_pk_bf16_f32 v48, v48, v49
    v_cvt_pk_bf16_f32 v49, v50, v51
    v_cvt_pk_bf16_f32 v50, v52, v53
    v_cvt_pk_bf16_f32 v51, v54, v55
    v_pk_fma_f32 v[220:221], v[220:221], s[56:57], v[168:169] neg_lo:[0,0,1] neg_hi:[0,0,1]
    v_pk_fma_f32 v[222:223], v[222:223], s[56:57], v[168:169] neg_lo:[0,0,1] neg_hi:[0,0,1]
    v_pk_fma_f32 v[224:225], v[224:225], s[56:57], v[168:169] neg_lo:[0,0,1] neg_hi:[0,0,1]
    v_pk_fma_f32 v[226:227], v[226:227], s[56:57], v[168:169] neg_lo:[0,0,1] neg_hi:[0,0,1]
    v_exp_f32 v220, v220
    v_exp_f32 v221, v221
    v_exp_f32 v222, v222
    v_exp_f32 v223, v223
    v_exp_f32 v224, v224
    v_exp_f32 v225, v225
    v_exp_f32 v226, v226
    v_exp_f32 v227, v227
    s_waitcnt lgkmcnt(6)
    v_mfma_f32_16x16x32_bf16 v[84:87], v[176:179], v[40:43], v[84:87]
    v_mfma_f32_16x16x32_bf16 v[92:95], v[176:179], v[212:215], v[92:95]
    ds_read_b128 v[176:179], v6 offset:8192
    v_cvt_pk_bf16_f32 v220, v220, v221
    v_cvt_pk_bf16_f32 v221, v222, v223
    v_cvt_pk_bf16_f32 v222, v224, v225
    v_cvt_pk_bf16_f32 v223, v226, v227
    v_pk_fma_f32 v[56:57], v[56:57], s[56:57], v[166:167] neg_lo:[0,0,1] neg_hi:[0,0,1]
    v_pk_fma_f32 v[58:59], v[58:59], s[56:57], v[166:167] neg_lo:[0,0,1] neg_hi:[0,0,1]
    v_pk_fma_f32 v[60:61], v[60:61], s[56:57], v[166:167] neg_lo:[0,0,1] neg_hi:[0,0,1]
    v_pk_fma_f32 v[62:63], v[62:63], s[56:57], v[166:167] neg_lo:[0,0,1] neg_hi:[0,0,1]
    v_exp_f32 v56, v56
    v_exp_f32 v57, v57
    v_exp_f32 v58, v58
    v_exp_f32 v59, v59
    v_exp_f32 v60, v60
    v_exp_f32 v61, v61
    v_exp_f32 v62, v62
    v_exp_f32 v63, v63
    s_waitcnt lgkmcnt(6)
    v_mfma_f32_16x16x32_bf16 v[80:83], v[96:99], v[48:51], v[80:83]
    v_mfma_f32_16x16x32_bf16 v[88:91], v[96:99], v[220:223], v[88:91]
    ds_read_b128 v[96:99], v253 offset:1024
    v_cvt_pk_bf16_f32 v56, v56, v57
    v_cvt_pk_bf16_f32 v57, v58, v59
    v_cvt_pk_bf16_f32 v58, v60, v61
    v_cvt_pk_bf16_f32 v59, v62, v63
    v_pk_fma_f32 v[228:229], v[228:229], s[56:57], v[168:169] neg_lo:[0,0,1] neg_hi:[0,0,1]
    v_pk_fma_f32 v[230:231], v[230:231], s[56:57], v[168:169] neg_lo:[0,0,1] neg_hi:[0,0,1]
    v_pk_fma_f32 v[232:233], v[232:233], s[56:57], v[168:169] neg_lo:[0,0,1] neg_hi:[0,0,1]
    v_pk_fma_f32 v[234:235], v[234:235], s[56:57], v[168:169] neg_lo:[0,0,1] neg_hi:[0,0,1]
    v_exp_f32 v228, v228
    v_exp_f32 v229, v229
    v_exp_f32 v230, v230
    v_exp_f32 v231, v231
    v_exp_f32 v232, v232
    v_exp_f32 v233, v233
    v_exp_f32 v234, v234
    v_exp_f32 v235, v235
    s_waitcnt lgkmcnt(6)
    v_mfma_f32_16x16x32_bf16 v[84:87], v[100:103], v[48:51], v[84:87]
    v_mfma_f32_16x16x32_bf16 v[92:95], v[100:103], v[220:223], v[92:95]
    v_cvt_pk_bf16_f32 v228, v228, v229
    v_cvt_pk_bf16_f32 v229, v230, v231
    v_cvt_pk_bf16_f32 v230, v232, v233
    v_cvt_pk_bf16_f32 v231, v234, v235
    v_pk_fma_f32 v[64:65], v[64:65], s[56:57], v[166:167] neg_lo:[0,0,1] neg_hi:[0,0,1]
    v_pk_fma_f32 v[66:67], v[66:67], s[56:57], v[166:167] neg_lo:[0,0,1] neg_hi:[0,0,1]
    v_pk_fma_f32 v[68:69], v[68:69], s[56:57], v[166:167] neg_lo:[0,0,1] neg_hi:[0,0,1]
    v_pk_fma_f32 v[70:71], v[70:71], s[56:57], v[166:167] neg_lo:[0,0,1] neg_hi:[0,0,1]
    v_exp_f32 v64, v64
    v_exp_f32 v65, v65
    v_exp_f32 v66, v66
    v_exp_f32 v67, v67
    v_exp_f32 v68, v68
    v_exp_f32 v69, v69
    v_exp_f32 v70, v70
    v_exp_f32 v71, v71
    s_waitcnt lgkmcnt(5)
    v_mfma_f32_16x16x32_bf16 v[80:83], v[104:107], v[56:59], v[80:83]
    v_mfma_f32_16x16x32_bf16 v[88:91], v[104:107], v[228:231], v[88:91]
    v_cvt_pk_bf16_f32 v64, v64, v65
    v_cvt_pk_bf16_f32 v65, v66, v67
    v_cvt_pk_bf16_f32 v66, v68, v69
    v_cvt_pk_bf16_f32 v67, v70, v71
    v_pk_fma_f32 v[236:237], v[236:237], s[56:57], v[168:169] neg_lo:[0,0,1] neg_hi:[0,0,1]
    v_pk_fma_f32 v[238:239], v[238:239], s[56:57], v[168:169] neg_lo:[0,0,1] neg_hi:[0,0,1]
    v_pk_fma_f32 v[240:241], v[240:241], s[56:57], v[168:169] neg_lo:[0,0,1] neg_hi:[0,0,1]
    v_pk_fma_f32 v[242:243], v[242:243], s[56:57], v[168:169] neg_lo:[0,0,1] neg_hi:[0,0,1]
    v_exp_f32 v236, v236
    v_exp_f32 v237, v237
    v_exp_f32 v238, v238
    v_exp_f32 v239, v239
    v_exp_f32 v240, v240
    v_exp_f32 v241, v241
    v_exp_f32 v242, v242
    v_exp_f32 v243, v243
    s_waitcnt lgkmcnt(4)
    v_mfma_f32_16x16x32_bf16 v[84:87], v[108:111], v[56:59], v[84:87]
    v_mfma_f32_16x16x32_bf16 v[92:95], v[108:111], v[228:231], v[92:95]
    v_cvt_pk_bf16_f32 v236, v236, v237
    v_cvt_pk_bf16_f32 v237, v238, v239
    v_cvt_pk_bf16_f32 v238, v240, v241
    v_cvt_pk_bf16_f32 v239, v242, v243
    v_pk_fma_f32 v[72:73], v[72:73], s[56:57], v[166:167] neg_lo:[0,0,1] neg_hi:[0,0,1]
    v_pk_fma_f32 v[74:75], v[74:75], s[56:57], v[166:167] neg_lo:[0,0,1] neg_hi:[0,0,1]
    v_pk_fma_f32 v[76:77], v[76:77], s[56:57], v[166:167] neg_lo:[0,0,1] neg_hi:[0,0,1]
    v_pk_fma_f32 v[78:79], v[78:79], s[56:57], v[166:167] neg_lo:[0,0,1] neg_hi:[0,0,1]
    v_exp_f32 v72, v72
    v_exp_f32 v73, v73
    v_exp_f32 v74, v74
    v_exp_f32 v75, v75
    v_exp_f32 v76, v76
    v_exp_f32 v77, v77
    v_exp_f32 v78, v78
    v_exp_f32 v79, v79
    s_waitcnt lgkmcnt(3)
    v_mfma_f32_16x16x32_bf16 v[80:83], v[112:115], v[64:67], v[80:83]
    v_mfma_f32_16x16x32_bf16 v[88:91], v[112:115], v[236:239], v[88:91]
    v_cvt_pk_bf16_f32 v72, v72, v73
    v_cvt_pk_bf16_f32 v73, v74, v75
    v_cvt_pk_bf16_f32 v74, v76, v77
    v_cvt_pk_bf16_f32 v75, v78, v79
    v_pk_fma_f32 v[244:245], v[244:245], s[56:57], v[168:169] neg_lo:[0,0,1] neg_hi:[0,0,1]
    v_pk_fma_f32 v[246:247], v[246:247], s[56:57], v[168:169] neg_lo:[0,0,1] neg_hi:[0,0,1]
    v_pk_fma_f32 v[248:249], v[248:249], s[56:57], v[168:169] neg_lo:[0,0,1] neg_hi:[0,0,1]
    v_pk_fma_f32 v[250:251], v[250:251], s[56:57], v[168:169] neg_lo:[0,0,1] neg_hi:[0,0,1]
    v_exp_f32 v244, v244
    v_exp_f32 v245, v245
    v_exp_f32 v246, v246
    v_exp_f32 v247, v247
    v_exp_f32 v248, v248
    v_exp_f32 v249, v249
    v_exp_f32 v250, v250
    v_exp_f32 v251, v251
    s_waitcnt lgkmcnt(2)
    v_mfma_f32_16x16x32_bf16 v[84:87], v[172:175], v[64:67], v[84:87]
    v_mfma_f32_16x16x32_bf16 v[92:95], v[172:175], v[236:239], v[92:95]
    v_cvt_pk_bf16_f32 v244, v244, v245
    v_cvt_pk_bf16_f32 v245, v246, v247
    v_cvt_pk_bf16_f32 v246, v248, v249
    v_cvt_pk_bf16_f32 v247, v250, v251
    v_lshrrev_b32 v8, 4, v0
    v_and_b32 v9, 15, v0
    s_waitcnt lgkmcnt(1)
    v_mfma_f32_16x16x32_bf16 v[80:83], v[176:179], v[72:75], v[80:83]
    v_mfma_f32_16x16x32_bf16 v[88:91], v[176:179], v[244:247], v[88:91]
    s_waitcnt lgkmcnt(0)
    v_mfma_f32_16x16x32_bf16 v[84:87], v[96:99], v[72:75], v[84:87]
    v_mfma_f32_16x16x32_bf16 v[92:95], v[96:99], v[244:247], v[92:95]
    s_mul_i32 s44, s50, 18
    s_add_u32 s44, s44, 0
    v_lshl_add_u32 v14, v8, 2, s44
    v_lshrrev_b32 v164, 5, v14
    v_lshlrev_b32 v164, 10, v164
    v_bfe_u32 v15, v14, 2, 2
    v_lshl_add_u32 v164, v15, 8, v164
    v_lshl_add_u32 v164, v9, 4, v164
    v_bfe_u32 v15, v14, 4, 1
    v_lshl_add_u32 v164, v15, 3, v164
    v_and_b32 v15, 3, v14
    v_lshl_add_u32 v164, v15, 1, v164
    s_mul_i32 s44, s50, 18
    s_add_u32 s44, s44, 2
    v_lshl_add_u32 v14, v8, 2, s44
    v_lshrrev_b32 v165, 5, v14
    v_lshlrev_b32 v165, 10, v165
    v_bfe_u32 v15, v14, 2, 2
    v_lshl_add_u32 v165, v15, 8, v165
    v_lshl_add_u32 v165, v9, 4, v165
    v_bfe_u32 v15, v14, 4, 1
    v_lshl_add_u32 v165, v15, 3, v165
    v_and_b32 v15, 3, v14
    v_lshl_add_u32 v165, v15, 1, v165
    s_mul_i32 s44, s50, 18
    s_add_u32 s44, s44, 16
    v_mov_b32 v14, s44
    v_lshrrev_b32 v166, 5, v14
    v_lshlrev_b32 v166, 10, v166
    v_bfe_u32 v15, v14, 2, 2
    v_lshl_add_u32 v166, v15, 8, v166
    v_lshl_add_u32 v166, v9, 4, v166
    v_bfe_u32 v15, v14, 4, 1
    v_lshl_add_u32 v166, v15, 3, v166
    v_and_b32 v15, 3, v14
    v_lshl_add_u32 v166, v15, 1, v166
    v_cmp_eq_u32 vcc, 0, v8
    v_mov_b32 v14, 0x10000000
    s_mul_i32 s44, s51, 184320
    s_add_u32 s44, s44, 29360128
    s_add_u32 s45, s44, 92160
    v_cndmask_b32 v166, v14, v166, vcc
    v_rcp_f32 v87, v86
    v_rcp_f32 v95, v94
    v_mul_f32 v80, v80, v87
    v_mul_f32 v81, v81, v87
    v_mul_f32 v82, v82, v87
    v_mul_f32 v83, v83, v87
    v_mul_f32 v84, v84, v87
    v_mul_f32 v85, v85, v87
    v_cvt_pk_bf16_f32 v168, v80, v81
    v_cvt_pk_bf16_f32 v169, v82, v83
    v_cvt_pk_bf16_f32 v170, v84, v85
    buffer_store_dword v168, v164, s[52:55], s44 offen
    buffer_store_dword v169, v165, s[52:55], s44 offen
    buffer_store_dword v170, v166, s[52:55], s44 offen
    v_mul_f32 v88, v88, v95
    v_mul_f32 v89, v89, v95
    v_mul_f32 v90, v90, v95
    v_mul_f32 v91, v91, v95
    v_mul_f32 v92, v92, v95
    v_mul_f32 v93, v93, v95
    v_cvt_pk_bf16_f32 v172, v88, v89
    v_cvt_pk_bf16_f32 v173, v90, v91
    v_cvt_pk_bf16_f32 v174, v92, v93
    buffer_store_dword v172, v164, s[52:55], s45 offen
    buffer_store_dword v173, v165, s[52:55], s45 offen
    buffer_store_dword v174, v166, s[52:55], s45 offen
    v_lshrrev_b32 v199, 2, v9
    v_lshlrev_b32 v199, 3, v199
    v_and_b32 v6, 3, v9
    v_add_u32 v199, v199, v6
    s_lshl_b32 s43, s38, 5
    s_lshl_b32 s44, s37, 2
    s_add_u32 s43, s43, s44
    v_add_u32 v199, s43, v199
    v_lshlrev_b32 v199, 1, v199
    v_mov_b32 v8, 0
    v_mov_b32 v9, 0
    v_mov_b32 v10, 0
    v_mov_b32 v11, 0
    v_mov_b32 v12, 0
    v_mov_b32 v13, 0
    v_mov_b32 v14, 0
    v_mov_b32 v15, 0
    v_mov_b32 v16, 0
    v_mov_b32 v17, 0
    v_mov_b32 v18, 0
    v_mov_b32 v19, 0
    v_mov_b32 v20, 0
    v_mov_b32 v21, 0
    v_mov_b32 v22, 0
    v_mov_b32 v23, 0
    v_mov_b32 v24, 0
    v_mov_b32 v25, 0
    v_mov_b32 v26, 0
    v_mov_b32 v27, 0
    v_mov_b32 v28, 0
    v_mov_b32 v29, 0
    v_mov_b32 v30, 0
    v_mov_b32 v31, 0
    v_mov_b32 v32, 0
    v_mov_b32 v33, 0
    v_mov_b32 v34, 0
    v_mov_b32 v35, 0
    v_mov_b32 v36, 0
    v_mov_b32 v37, 0
    v_mov_b32 v38, 0
    v_mov_b32 v39, 0
    v_mov_b32 v40, 0
    v_mov_b32 v41, 0
    v_mov_b32 v42, 0
    v_mov_b32 v43, 0
    v_mov_b32 v44, 0
    v_mov_b32 v45, 0
    v_mov_b32 v46, 0
    v_mov_b32 v47, 0
    v_mov_b32 v48, 0
    v_mov_b32 v49, 0
    v_mov_b32 v50, 0
    v_mov_b32 v51, 0
    v_mov_b32 v52, 0
    v_mov_b32 v53, 0
    v_mov_b32 v54, 0
    v_mov_b32 v55, 0
    v_mov_b32 v56, 0
    v_mov_b32 v57, 0
    v_mov_b32 v58, 0
    v_mov_b32 v59, 0
    v_mov_b32 v60, 0
    v_mov_b32 v61, 0
    v_mov_b32 v62, 0
    v_mov_b32 v63, 0
    v_mov_b32 v64, 0
    v_mov_b32 v65, 0
    v_mov_b32 v66, 0
    v_mov_b32 v67, 0
    v_mov_b32 v68, 0
    v_mov_b32 v69, 0
    v_mov_b32 v70, 0
    v_mov_b32 v71, 0
    v_mov_b32 v72, 0
    v_mov_b32 v73, 0
    v_mov_b32 v74, 0
    v_mov_b32 v75, 0
    v_mov_b32 v76, 0
    v_mov_b32 v77, 0
    v_mov_b32 v78, 0
    v_mov_b32 v79, 0
    s_mov_b32 s48, 0
    s_waitcnt vmcnt(22)
    s_barrier
    ds_read_b128 v[80:83], v1 offset:0
    ds_read_b128 v[84:87], v1 offset:1024
    ds_read_b128 v[88:91], v1 offset:2048
    ds_read_b128 v[92:95], v1 offset:3072
    ds_read_b128 v[96:99], v1 offset:4096
    ds_read_b128 v[100:103], v1 offset:5120
    ds_read_b128 v[104:107], v1 offset:6144
    ds_read_b128 v[108:111], v1 offset:7168
    ds_read_b128 v[112:115], v1 offset:8192
.p2align 6
k3_loop:
    s_waitcnt lgkmcnt(8)
    v_mfma_f32_16x16x32_bf16 v[8:11], v[80:83], v[116:119], v[8:11]
    v_mfma_f32_16x16x32_bf16 v[44:47], v[80:83], v[120:123], v[44:47]
    ds_read_b128 v[80:83], v1 offset:9216
    buffer_load_dwordx4 v[164:167], v4, s[12:15], s46 offen offset:0
    s_waitcnt lgkmcnt(8)
    v_mfma_f32_16x16x32_bf16 v[12:15], v[84:87], v[116:119], v[12:15]
    v_mfma_f32_16x16x32_bf16 v[48:51], v[84:87], v[120:123], v[48:51]
    ds_read_b128 v[84:87], v1 offset:10240
    s_waitcnt lgkmcnt(8)
    v_mfma_f32_16x16x32_bf16 v[16:19], v[88:91], v[116:119], v[16:19]
    v_mfma_f32_16x16x32_bf16 v[52:55], v[88:91], v[120:123], v[52:55]
    ds_read_b128 v[88:91], v1 offset:11264
    buffer_load_dwordx4 v[168:171], v5, s[12:15], s46 offen offset:0
    s_waitcnt lgkmcnt(8)
    v_mfma_f32_16x16x32_bf16 v[20:23], v[92:95], v[116:119], v[20:23]
    v_mfma_f32_16x16x32_bf16 v[56:59], v[92:95], v[120:123], v[56:59]
    ds_read_b128 v[92:95], v1 offset:12288
    s_waitcnt lgkmcnt(8)
    v_mfma_f32_16x16x32_bf16 v[24:27], v[96:99], v[116:119], v[24:27]
    v_mfma_f32_16x16x32_bf16 v[60:63], v[96:99], v[120:123], v[60:63]
    ds_read_b128 v[96:99], v1 offset:13312
    buffer_load_dwordx4 v[172:175], v4, s[12:15], s46 offen offset:1024
    s_waitcnt lgkmcnt(8)
    v_mfma_f32_16x16x32_bf16 v[28:31], v[100:103], v[116:119], v[28:31]
    v_mfma_f32_16x16x32_bf16 v[64:67], v[100:103], v[120:123], v[64:67]
    ds_read_b128 v[100:103], v1 offset:14336
    s_waitcnt lgkmcnt(8)
    v_mfma_f32_16x16x32_bf16 v[32:35], v[104:107], v[116:119], v[32:35]
    v_mfma_f32_16x16x32_bf16 v[68:71], v[104:107], v[120:123], v[68:71]
    ds_read_b128 v[104:107], v1 offset:15360
    buffer_load_dwordx4 v[176:179], v5, s[12:15], s46 offen offset:1024
    s_waitcnt lgkmcnt(8)
    v_mfma_f32_16x16x32_bf16 v[36:39], v[108:111], v[116:119], v[36:39]
    v_mfma_f32_16x16x32_bf16 v[72:75], v[108:111], v[120:123], v[72:75]
    ds_read_b128 v[108:111], v1 offset:16384
    s_add_u32 s46, s46, 4096
    s_waitcnt lgkmcnt(8)
    v_mfma_f32_16x16x32_bf16 v[40:43], v[112:115], v[116:119], v[40:43]
    v_mfma_f32_16x16x32_bf16 v[76:79], v[112:115], v[120:123], v[76:79]
    ds_read_b128 v[112:115], v1 offset:17408
    s_waitcnt vmcnt(12)
    s_barrier
    s_waitcnt lgkmcnt(8)
    v_mfma_f32_16x16x32_bf16 v[8:11], v[80:83], v[124:127], v[8:11]
    v_mfma_f32_16x16x32_bf16 v[44:47], v[80:83], v[128:131], v[44:47]
    ds_read_b128 v[80:83], v1 offset:36864
    s_add_u32 m0, s41, 110592
    s_nop 0
    buffer_load_dwordx4 v3, s[8:11], s47 offen offset:0 lds
    s_waitcnt lgkmcnt(8)
    v_mfma_f32_16x16x32_bf16 v[12:15], v[84:87], v[124:127], v[12:15]
    v_mfma_f32_16x16x32_bf16 v[48:51], v[84:87], v[128:131], v[48:51]
    ds_read_b128 v[84:87], v1 offset:37888
    s_waitcnt lgkmcnt(8)
    v_mfma_f32_16x16x32_bf16 v[16:19], v[88:91], v[124:127], v[16:19]
    v_mfma_f32_16x16x32_bf16 v[52:55], v[88:91], v[128:131], v[52:55]
    ds_read_b128 v[88:91], v1 offset:38912
    buffer_load_dwordx4 v3, s[8:11], s47 offen offset:1024 lds
    s_waitcnt lgkmcnt(8)
    v_mfma_f32_16x16x32_bf16 v[20:23], v[92:95], v[124:127], v[20:23]
    v_mfma_f32_16x16x32_bf16 v[56:59], v[92:95], v[128:131], v[56:59]
    ds_read_b128 v[92:95], v1 offset:39936
    s_waitcnt lgkmcnt(8)
    v_mfma_f32_16x16x32_bf16 v[24:27], v[96:99], v[124:127], v[24:27]
    v_mfma_f32_16x16x32_bf16 v[60:63], v[96:99], v[128:131], v[60:63]
    ds_read_b128 v[96:99], v1 offset:40960
    buffer_load_dwordx4 v3, s[8:11], s47 offen offset:2048 lds
    s_waitcnt lgkmcnt(8)
    v_mfma_f32_16x16x32_bf16 v[28:31], v[100:103], v[124:127], v[28:31]
    v_mfma_f32_16x16x32_bf16 v[64:67], v[100:103], v[128:131], v[64:67]
    ds_read_b128 v[100:103], v1 offset:41984
    s_waitcnt lgkmcnt(8)
    v_mfma_f32_16x16x32_bf16 v[32:35], v[104:107], v[124:127], v[32:35]
    v_mfma_f32_16x16x32_bf16 v[68:71], v[104:107], v[128:131], v[68:71]
    ds_read_b128 v[104:107], v1 offset:43008
    buffer_load_dwordx4 v3, s[8:11], s47 offen offset:3072 lds
    s_waitcnt lgkmcnt(8)
    v_mfma_f32_16x16x32_bf16 v[36:39], v[108:111], v[124:127], v[36:39]
    v_mfma_f32_16x16x32_bf16 v[72:75], v[108:111], v[128:131], v[72:75]
    ds_read_b128 v[108:111], v1 offset:44032
    s_waitcnt lgkmcnt(8)
    v_mfma_f32_16x16x32_bf16 v[40:43], v[112:115], v[124:127], v[40:43]
    v_mfma_f32_16x16x32_bf16 v[76:79], v[112:115], v[128:131], v[76:79]
    ds_read_b128 v[112:115], v1 offset:45056
    s_cmp_lg_u32 s37, 0
    s_cbranch_scc1 k3_sk4
    s_add_u32 m0, m0, s42
    s_nop 0
    buffer_load_dwordx4 v252, s[8:11], s47 offen lds
k3_sk4:
    s_add_u32 s47, s47, 36864
    s_waitcnt lgkmcnt(8)
    v_mfma_f32_16x16x32_bf16 v[8:11], v[80:83], v[132:135], v[8:11]
    v_mfma_f32_16x16x32_bf16 v[44:47], v[80:83], v[136:139], v[44:47]
    ds_read_b128 v[80:83], v1 offset:46080
    buffer_load_dwordx4 v[116:119], v4, s[12:15], s46 offen offset:0
    s_waitcnt lgkmcnt(8)
    v_mfma_f32_16x16x32_bf16 v[12:15], v[84:87], v[132:135], v[12:15]
    v_mfma_f32_16x16x32_bf16 v[48:51], v[84:87], v[136:139], v[48:51]
    ds_read_b128 v[84:87], v1 offset:47104
    s_waitcnt lgkmcnt(8)
    v_mfma_f32_16x16x32_bf16 v[16:19], v[88:91], v[132:135], v[16:19]
    v_mfma_f32_16x16x32_bf16 v[52:55], v[88:91], v[136:139], v[52:55]
    ds_read_b128 v[88:91], v1 offset:48128
    buffer_load_dwordx4 v[120:123], v5, s[12:15], s46 offen offset:0
    s_waitcnt lgkmcnt(8)
    v_mfma_f32_16x16x32_bf16 v[20:23], v[92:95], v[132:135], v[20:23]
    v_mfma_f32_16x16x32_bf16 v[56:59], v[92:95], v[136:139], v[56:59]
    ds_read_b128 v[92:95], v1 offset:49152
    s_waitcnt lgkmcnt(8)
    v_mfma_f32_16x16x32_bf16 v[24:27], v[96:99], v[132:135], v[24:27]
    v_mfma_f32_16x16x32_bf16 v[60:63], v[96:99], v[136:139], v[60:63]
    ds_read_b128 v[96:99], v1 offset:50176
    buffer_load_dwordx4 v[124:127], v4, s[12:15], s46 offen offset:1024
    s_waitcnt lgkmcnt(8)
    v_mfma_f32_16x16x32_bf16 v[28:31], v[100:103], v[132:135], v[28:31]
    v_mfma_f32_16x16x32_bf16 v[64:67], v[100:103], v[136:139], v[64:67]
    ds_read_b128 v[100:103], v1 offset:51200
    s_waitcnt lgkmcnt(8)
    v_mfma_f32_16x16x32_bf16 v[32:35], v[104:107], v[132:135], v[32:35]
    v_mfma_f32_16x16x32_bf16 v[68:71], v[104:107], v[136:139], v[68:71]
    ds_read_b128 v[104:107], v1 offset:52224
    buffer_load_dwordx4 v[128:131], v5, s[12:15], s46 offen offset:1024
    s_waitcnt lgkmcnt(8)
    v_mfma_f32_16x16x32_bf16 v[36:39], v[108:111], v[132:135], v[36:39]
    v_mfma_f32_16x16x32_bf16 v[72:75], v[108:111], v[136:139], v[72:75]
    ds_read_b128 v[108:111], v1 offset:53248
    s_add_u32 s46, s46, 4096
    s_waitcnt lgkmcnt(8)
    v_mfma_f32_16x16x32_bf16 v[40:43], v[112:115], v[132:135], v[40:43]
    v_mfma_f32_16x16x32_bf16 v[76:79], v[112:115], v[136:139], v[76:79]
    ds_read_b128 v[112:115], v1 offset:54272
    s_waitcnt vmcnt(12)
    s_barrier
    s_waitcnt lgkmcnt(8)
    v_mfma_f32_16x16x32_bf16 v[8:11], v[80:83], v[140:143], v[8:11]
    v_mfma_f32_16x16x32_bf16 v[44:47], v[80:83], v[144:147], v[44:47]
    ds_read_b128 v[80:83], v2 offset:0
    s_add_u32 m0, s41, 0
    s_nop 0
    buffer_load_dwordx4 v3, s[8:11], s47 offen offset:0 lds
    s_waitcnt lgkmcnt(8)
    v_mfma_f32_16x16x32_bf16 v[12:15], v[84:87], v[140:143], v[12:15]
    v_mfma_f32_16x16x32_bf16 v[48:51], v[84:87], v[144:147], v[48:51]
    ds_read_b128 v[84:87], v2 offset:1024
    s_waitcnt lgkmcnt(8)
    v_mfma_f32_16x16x32_bf16 v[16:19], v[88:91], v[140:143], v[16:19]
    v_mfma_f32_16x16x32_bf16 v[52:55], v[88:91], v[144:147], v[52:55]
    ds_read_b128 v[88:91], v2 offset:2048
    buffer_load_dwordx4 v3, s[8:11], s47 offen offset:1024 lds
    s_waitcnt lgkmcnt(8)
    v_mfma_f32_16x16x32_bf16 v[20:23], v[92:95], v[140:143], v[20:23]
    v_mfma_f32_16x16x32_bf16 v[56:59], v[92:95], v[144:147], v[56:59]
    ds_read_b128 v[92:95], v2 offset:3072
    s_waitcnt lgkmcnt(8)
    v_mfma_f32_16x16x32_bf16 v[24:27], v[96:99], v[140:143], v[24:27]
    v_mfma_f32_16x16x32_bf16 v[60:63], v[96:99], v[144:147], v[60:63]
    ds_read_b128 v[96:99], v2 offset:4096
    buffer_load_dwordx4 v3, s[8:11], s47 offen offset:2048 lds
    s_waitcnt lgkmcnt(8)
    v_mfma_f32_16x16x32_bf16 v[28:31], v[100:103], v[140:143], v[28:31]
    v_mfma_f32_16x16x32_bf16 v[64:67], v[100:103], v[144:147], v[64:67]
    ds_read_b128 v[100:103], v2 offset:5120
    s_waitcnt lgkmcnt(8)
    v_mfma_f32_16x16x32_bf16 v[32:35], v[104:107], v[140:143], v[32:35]
    v_mfma_f32_16x16x32_bf16 v[68:71], v[104:107], v[144:147], v[68:71]
    ds_read_b128 v[104:107], v2 offset:6144
    buffer_load_dwordx4 v3, s[8:11], s47 offen offset:3072 lds
    s_waitcnt lgkmcnt(8)
    v_mfma_f32_16x16x32_bf16 v[36:39], v[108:111], v[140:143], v[36:39]
    v_mfma_f32_16x16x32_bf16 v[72:75], v[108:111], v[144:147], v[72:75]
    ds_read_b128 v[108:111], v2 offset:7168
    s_waitcnt lgkmcnt(8)
    v_mfma_f32_16x16x32_bf16 v[40:43], v[112:115], v[140:143], v[40:43]
    v_mfma_f32_16x16x32_bf16 v[76:79], v[112:115], v[144:147], v[76:79]
    ds_read_b128 v[112:115], v2 offset:8192
    s_cmp_lg_u32 s37, 0
    s_cbranch_scc1 k3_sk5
    s_add_u32 m0, m0, s42
    s_nop 0
    buffer_load_dwordx4 v252, s[8:11], s47 offen lds
k3_sk5:
    s_add_u32 s47, s47, 36864
    s_waitcnt lgkmcnt(8)
    v_mfma_f32_16x16x32_bf16 v[8:11], v[80:83], v[148:151], v[8:11]
    v_mfma_f32_16x16x32_bf16 v[44:47], v[80:83], v[152:155], v[44:47]
    ds_read_b128 v[80:83], v2 offset:9216
    buffer_load_dwordx4 v[132:135], v4, s[12:15], s46 offen offset:0
    s_waitcnt lgkmcnt(8)
    v_mfma_f32_16x16x32_bf16 v[12:15], v[84:87], v[148:151], v[12:15]
    v_mfma_f32_16x16x32_bf16 v[48:51], v[84:87], v[152:155], v[48:51]
    ds_read_b128 v[84:87], v2 offset:10240
    s_waitcnt lgkmcnt(8)
    v_mfma_f32_16x16x32_bf16 v[16:19], v[88:91], v[148:151], v[16:19]
    v_mfma_f32_16x16x32_bf16 v[52:55], v[88:91], v[152:155], v[52:55]
    ds_read_b128 v[88:91], v2 offset:11264
    buffer_load_dwordx4 v[136:139], v5, s[12:15], s46 offen offset:0
    s_waitcnt lgkmcnt(8)
    v_mfma_f32_16x16x32_bf16 v[20:23], v[92:95], v[148:151], v[20:23]
    v_mfma_f32_16x16x32_bf16 v[56:59], v[92:95], v[152:155], v[56:59]
    ds_read_b128 v[92:95], v2 offset:12288
    s_waitcnt lgkmcnt(8)
    v_mfma_f32_16x16x32_bf16 v[24:27], v[96:99], v[148:151], v[24:27]
    v_mfma_f32_16x16x32_bf16 v[60:63], v[96:99], v[152:155], v[60:63]
    ds_read_b128 v[96:99], v2 offset:13312
    buffer_load_dwordx4 v[140:143], v4, s[12:15], s46 offen offset:1024
    s_waitcnt lgkmcnt(8)
    v_mfma_f32_16x16x32_bf16 v[28:31], v[100:103], v[148:151], v[28:31]
    v_mfma_f32_16x16x32_bf16 v[64:67], v[100:103], v[152:155], v[64:67]
    ds_read_b128 v[100:103], v2 offset:14336
    s_waitcnt lgkmcnt(8)
    v_mfma_f32_16x16x32_bf16 v[32:35], v[104:107], v[148:151], v[32:35]
    v_mfma_f32_16x16x32_bf16 v[68:71], v[104:107], v[152:155], v[68:71]
    ds_read_b128 v[104:107], v2 offset:15360
    buffer_load_dwordx4 v[144:147], v5, s[12:15], s46 offen offset:1024
    s_waitcnt lgkmcnt(8)
    v_mfma_f32_16x16x32_bf16 v[36:39], v[108:111], v[148:151], v[36:39]
    v_mfma_f32_16x16x32_bf16 v[72:75], v[108:111], v[152:155], v[72:75]
    ds_read_b128 v[108:111], v2 offset:16384
    s_add_u32 s46, s46, 4096
    s_waitcnt lgkmcnt(8)
    v_mfma_f32_16x16x32_bf16 v[40:43], v[112:115], v[148:151], v[40:43]
    v_mfma_f32_16x16x32_bf16 v[76:79], v[112:115], v[152:155], v[76:79]
    ds_read_b128 v[112:115], v2 offset:17408
    s_waitcnt vmcnt(12)
    s_barrier
    s_waitcnt lgkmcnt(8)
    v_mfma_f32_16x16x32_bf16 v[8:11], v[80:83], v[156:159], v[8:11]
    v_mfma_f32_16x16x32_bf16 v[44:47], v[80:83], v[160:163], v[44:47]
    ds_read_b128 v[80:83], v2 offset:36864
    s_add_u32 m0, s41, 36864
    s_nop 0
    buffer_load_dwordx4 v3, s[8:11], s47 offen offset:0 lds
    s_waitcnt lgkmcnt(8)
    v_mfma_f32_16x16x32_bf16 v[12:15], v[84:87], v[156:159], v[12:15]
    v_mfma_f32_16x16x32_bf16 v[48:51], v[84:87], v[160:163], v[48:51]
    ds_read_b128 v[84:87], v2 offset:37888
    s_waitcnt lgkmcnt(8)
    v_mfma_f32_16x16x32_bf16 v[16:19], v[88:91], v[156:159], v[16:19]
    v_mfma_f32_16x16x32_bf16 v[52:55], v[88:91], v[160:163], v[52:55]
    ds_read_b128 v[88:91], v2 offset:38912
    buffer_load_dwordx4 v3, s[8:11], s47 offen offset:1024 lds
    s_waitcnt lgkmcnt(8)
    v_mfma_f32_16x16x32_bf16 v[20:23], v[92:95], v[156:159], v[20:23]
    v_mfma_f32_16x16x32_bf16 v[56:59], v[92:95], v[160:163], v[56:59]
    ds_read_b128 v[92:95], v2 offset:39936
    s_waitcnt lgkmcnt(8)
    v_mfma_f32_16x16x32_bf16 v[24:27], v[96:99], v[156:159], v[24:27]
    v_mfma_f32_16x16x32_bf16 v[60:63], v[96:99], v[160:163], v[60:63]
    ds_read_b128 v[96:99], v2 offset:40960
    buffer_load_dwordx4 v3, s[8:11], s47 offen offset:2048 lds
    s_waitcnt lgkmcnt(8)
    v_mfma_f32_16x16x32_bf16 v[28:31], v[100:103], v[156:159], v[28:31]
    v_mfma_f32_16x16x32_bf16 v[64:67], v[100:103], v[160:163], v[64:67]
    ds_read_b128 v[100:103], v2 offset:41984
    s_waitcnt lgkmcnt(8)
    v_mfma_f32_16x16x32_bf16 v[32:35], v[104:107], v[156:159], v[32:35]
    v_mfma_f32_16x16x32_bf16 v[68:71], v[104:107], v[160:163], v[68:71]
    ds_read_b128 v[104:107], v2 offset:43008
    buffer_load_dwordx4 v3, s[8:11], s47 offen offset:3072 lds
    s_waitcnt lgkmcnt(8)
    v_mfma_f32_16x16x32_bf16 v[36:39], v[108:111], v[156:159], v[36:39]
    v_mfma_f32_16x16x32_bf16 v[72:75], v[108:111], v[160:163], v[72:75]
    ds_read_b128 v[108:111], v2 offset:44032
    s_waitcnt lgkmcnt(8)
    v_mfma_f32_16x16x32_bf16 v[40:43], v[112:115], v[156:159], v[40:43]
    v_mfma_f32_16x16x32_bf16 v[76:79], v[112:115], v[160:163], v[76:79]
    ds_read_b128 v[112:115], v2 offset:45056
    s_cmp_lg_u32 s37, 0
    s_cbranch_scc1 k3_sk6
    s_add_u32 m0, m0, s42
    s_nop 0
    buffer_load_dwordx4 v252, s[8:11], s47 offen lds
k3_sk6:
    s_add_u32 s47, s47, 36864
    s_waitcnt lgkmcnt(8)
    v_mfma_f32_16x16x32_bf16 v[8:11], v[80:83], v[164:167], v[8:11]
    v_mfma_f32_16x16x32_bf16 v[44:47], v[80:83], v[168:171], v[44:47]
    ds_read_b128 v[80:83], v2 offset:46080
    buffer_load_dwordx4 v[148:151], v4, s[12:15], s46 offen offset:0
    s_waitcnt lgkmcnt(8)
    v_mfma_f32_16x16x32_bf16 v[12:15], v[84:87], v[164:167], v[12:15]
    v_mfma_f32_16x16x32_bf16 v[48:51], v[84:87], v[168:171], v[48:51]
    ds_read_b128 v[84:87], v2 offset:47104
    s_waitcnt lgkmcnt(8)
    v_mfma_f32_16x16x32_bf16 v[16:19], v[88:91], v[164:167], v[16:19]
    v_mfma_f32_16x16x32_bf16 v[52:55], v[88:91], v[168:171], v[52:55]
    ds_read_b128 v[88:91], v2 offset:48128
    buffer_load_dwordx4 v[152:155], v5, s[12:15], s46 offen offset:0
    s_waitcnt lgkmcnt(8)
    v_mfma_f32_16x16x32_bf16 v[20:23], v[92:95], v[164:167], v[20:23]
    v_mfma_f32_16x16x32_bf16 v[56:59], v[92:95], v[168:171], v[56:59]
    ds_read_b128 v[92:95], v2 offset:49152
    s_waitcnt lgkmcnt(8)
    v_mfma_f32_16x16x32_bf16 v[24:27], v[96:99], v[164:167], v[24:27]
    v_mfma_f32_16x16x32_bf16 v[60:63], v[96:99], v[168:171], v[60:63]
    ds_read_b128 v[96:99], v2 offset:50176
    buffer_load_dwordx4 v[156:159], v4, s[12:15], s46 offen offset:1024
    s_waitcnt lgkmcnt(8)
    v_mfma_f32_16x16x32_bf16 v[28:31], v[100:103], v[164:167], v[28:31]
    v_mfma_f32_16x16x32_bf16 v[64:67], v[100:103], v[168:171], v[64:67]
    ds_read_b128 v[100:103], v2 offset:51200
    s_waitcnt lgkmcnt(8)
    v_mfma_f32_16x16x32_bf16 v[32:35], v[104:107], v[164:167], v[32:35]
    v_mfma_f32_16x16x32_bf16 v[68:71], v[104:107], v[168:171], v[68:71]
    ds_read_b128 v[104:107], v2 offset:52224
    buffer_load_dwordx4 v[160:163], v5, s[12:15], s46 offen offset:1024
    s_waitcnt lgkmcnt(8)
    v_mfma_f32_16x16x32_bf16 v[36:39], v[108:111], v[164:167], v[36:39]
    v_mfma_f32_16x16x32_bf16 v[72:75], v[108:111], v[168:171], v[72:75]
    ds_read_b128 v[108:111], v2 offset:53248
    s_add_u32 s46, s46, 4096
    s_waitcnt lgkmcnt(8)
    v_mfma_f32_16x16x32_bf16 v[40:43], v[112:115], v[164:167], v[40:43]
    v_mfma_f32_16x16x32_bf16 v[76:79], v[112:115], v[168:171], v[76:79]
    ds_read_b128 v[112:115], v2 offset:54272
    s_waitcnt vmcnt(12)
    s_barrier
    s_waitcnt lgkmcnt(8)
    v_mfma_f32_16x16x32_bf16 v[8:11], v[80:83], v[172:175], v[8:11]
    v_mfma_f32_16x16x32_bf16 v[44:47], v[80:83], v[176:179], v[44:47]
    ds_read_b128 v[80:83], v1 offset:0
    s_add_u32 m0, s41, 73728
    s_nop 0
    buffer_load_dwordx4 v3, s[8:11], s47 offen offset:0 lds
    s_waitcnt lgkmcnt(8)
    v_mfma_f32_16x16x32_bf16 v[12:15], v[84:87], v[172:175], v[12:15]
    v_mfma_f32_16x16x32_bf16 v[48:51], v[84:87], v[176:179], v[48:51]
    ds_read_b128 v[84:87], v1 offset:1024
    s_waitcnt lgkmcnt(8)
    v_mfma_f32_16x16x32_bf16 v[16:19], v[88:91], v[172:175], v[16:19]
    v_mfma_f32_16x16x32_bf16 v[52:55], v[88:91], v[176:179], v[52:55]
    ds_read_b128 v[88:91], v1 offset:2048
    buffer_load_dwordx4 v3, s[8:11], s47 offen offset:1024 lds
    s_waitcnt lgkmcnt(8)
    v_mfma_f32_16x16x32_bf16 v[20:23], v[92:95], v[172:175], v[20:23]
    v_mfma_f32_16x16x32_bf16 v[56:59], v[92:95], v[176:179], v[56:59]
    ds_read_b128 v[92:95], v1 offset:3072
    s_waitcnt lgkmcnt(8)
    v_mfma_f32_16x16x32_bf16 v[24:27], v[96:99], v[172:175], v[24:27]
    v_mfma_f32_16x16x32_bf16 v[60:63], v[96:99], v[176:179], v[60:63]
    ds_read_b128 v[96:99], v1 offset:4096
    buffer_load_dwordx4 v3, s[8:11], s47 offen offset:2048 lds
    s_waitcnt lgkmcnt(8)
    v_mfma_f32_16x16x32_bf16 v[28:31], v[100:103], v[172:175], v[28:31]
    v_mfma_f32_16x16x32_bf16 v[64:67], v[100:103], v[176:179], v[64:67]
    ds_read_b128 v[100:103], v1 offset:5120
    s_waitcnt lgkmcnt(8)
    v_mfma_f32_16x16x32_bf16 v[32:35], v[104:107], v[172:175], v[32:35]
    v_mfma_f32_16x16x32_bf16 v[68:71], v[104:107], v[176:179], v[68:71]
    ds_read_b128 v[104:107], v1 offset:6144
    buffer_load_dwordx4 v3, s[8:11], s47 offen offset:3072 lds
    s_waitcnt lgkmcnt(8)
    v_mfma_f32_16x16x32_bf16 v[36:39], v[108:111], v[172:175], v[36:39]
    v_mfma_f32_16x16x32_bf16 v[72:75], v[108:111], v[176:179], v[72:75]
    ds_read_b128 v[108:111], v1 offset:7168
    s_waitcnt lgkmcnt(8)
    v_mfma_f32_16x16x32_bf16 v[40:43], v[112:115], v[172:175], v[40:43]
    v_mfma_f32_16x16x32_bf16 v[76:79], v[112:115], v[176:179], v[76:79]
    ds_read_b128 v[112:115], v1 offset:8192
    s_cmp_lg_u32 s37, 0
    s_cbranch_scc1 k3_sk7
    s_add_u32 m0, m0, s42
    s_nop 0
    buffer_load_dwordx4 v252, s[8:11], s47 offen lds
k3_sk7:
    s_add_u32 s47, s47, 36864
    s_add_u32 s48, s48, 1
    s_cmp_lt_u32 s48, 3
    s_cbranch_scc1 k3_loop
    s_waitcnt lgkmcnt(8)
    v_mfma_f32_16x16x32_bf16 v[8:11], v[80:83], v[116:119], v[8:11]
    v_mfma_f32_16x16x32_bf16 v[44:47], v[80:83], v[120:123], v[44:47]
    ds_read_b128 v[80:83], v1 offset:9216
    buffer_load_dwordx4 v[164:167], v4, s[12:15], s46 offen offset:0
    s_waitcnt lgkmcnt(8)
    v_mfma_f32_16x16x32_bf16 v[12:15], v[84:87], v[116:119], v[12:15]
    v_mfma_f32_16x16x32_bf16 v[48:51], v[84:87], v[120:123], v[48:51]
    ds_read_b128 v[84:87], v1 offset:10240
    s_waitcnt lgkmcnt(8)
    v_mfma_f32_16x16x32_bf16 v[16:19], v[88:91], v[116:119], v[16:19]
    v_mfma_f32_16x16x32_bf16 v[52:55], v[88:91], v[120:123], v[52:55]
    ds_read_b128 v[88:91], v1 offset:11264
    buffer_load_dwordx4 v[168:171], v5, s[12:15], s46 offen offset:0
    s_waitcnt lgkmcnt(8)
    v_mfma_f32_16x16x32_bf16 v[20:23], v[92:95], v[116:119], v[20:23]
    v_mfma_f32_16x16x32_bf16 v[56:59], v[92:95], v[120:123], v[56:59]
    ds_read_b128 v[92:95], v1 offset:12288
    s_waitcnt lgkmcnt(8)
    v_mfma_f32_16x16x32_bf16 v[24:27], v[96:99], v[116:119], v[24:27]
    v_mfma_f32_16x16x32_bf16 v[60:63], v[96:99], v[120:123], v[60:63]
    ds_read_b128 v[96:99], v1 offset:13312
    buffer_load_dwordx4 v[172:175], v4, s[12:15], s46 offen offset:1024
    s_waitcnt lgkmcnt(8)
    v_mfma_f32_16x16x32_bf16 v[28:31], v[100:103], v[116:119], v[28:31]
    v_mfma_f32_16x16x32_bf16 v[64:67], v[100:103], v[120:123], v[64:67]
    ds_read_b128 v[100:103], v1 offset:14336
    s_waitcnt lgkmcnt(8)
    v_mfma_f32_16x16x32_bf16 v[32:35], v[104:107], v[116:119], v[32:35]
    v_mfma_f32_16x16x32_bf16 v[68:71], v[104:107], v[120:123], v[68:71]
    ds_read_b128 v[104:107], v1 offset:15360
    buffer_load_dwordx4 v[176:179], v5, s[12:15], s46 offen offset:1024
    s_waitcnt lgkmcnt(8)
    v_mfma_f32_16x16x32_bf16 v[36:39], v[108:111], v[116:119], v[36:39]
    v_mfma_f32_16x16x32_bf16 v[72:75], v[108:111], v[120:123], v[72:75]
    ds_read_b128 v[108:111], v1 offset:16384
    s_add_u32 s46, s46, 4096
    s_waitcnt lgkmcnt(8)
    v_mfma_f32_16x16x32_bf16 v[40:43], v[112:115], v[116:119], v[40:43]
    v_mfma_f32_16x16x32_bf16 v[76:79], v[112:115], v[120:123], v[76:79]
    ds_read_b128 v[112:115], v1 offset:17408
    s_waitcnt vmcnt(12)
    s_barrier
    s_waitcnt lgkmcnt(8)
    v_mfma_f32_16x16x32_bf16 v[8:11], v[80:83], v[124:127], v[8:11]
    v_mfma_f32_16x16x32_bf16 v[44:47], v[80:83], v[128:131], v[44:47]
    ds_read_b128 v[80:83], v1 offset:36864
    s_add_u32 m0, s41, 110592
    s_nop 0
    buffer_load_dwordx4 v3, s[8:11], s47 offen offset:0 lds
    s_waitcnt lgkmcnt(8)
    v_mfma_f32_16x16x32_bf16 v[12:15], v[84:87], v[124:127], v[12:15]
    v_mfma_f32_16x16x32_bf16 v[48:51], v[84:87], v[128:131], v[48:51]
    ds_read_b128 v[84:87], v1 offset:37888
    s_waitcnt lgkmcnt(8)
    v_mfma_f32_16x16x32_bf16 v[16:19], v[88:91], v[124:127], v[16:19]
    v_mfma_f32_16x16x32_bf16 v[52:55], v[88:91], v[128:131], v[52:55]
    ds_read_b128 v[88:91], v1 offset:38912
    buffer_load_dwordx4 v3, s[8:11], s47 offen offset:1024 lds
    s_waitcnt lgkmcnt(8)
    v_mfma_f32_16x16x32_bf16 v[20:23], v[92:95], v[124:127], v[20:23]
    v_mfma_f32_16x16x32_bf16 v[56:59], v[92:95], v[128:131], v[56:59]
    ds_read_b128 v[92:95], v1 offset:39936
    s_waitcnt lgkmcnt(8)
    v_mfma_f32_16x16x32_bf16 v[24:27], v[96:99], v[124:127], v[24:27]
    v_mfma_f32_16x16x32_bf16 v[60:63], v[96:99], v[128:131], v[60:63]
    ds_read_b128 v[96:99], v1 offset:40960
    buffer_load_dwordx4 v3, s[8:11], s47 offen offset:2048 lds
    s_waitcnt lgkmcnt(8)
    v_mfma_f32_16x16x32_bf16 v[28:31], v[100:103], v[124:127], v[28:31]
    v_mfma_f32_16x16x32_bf16 v[64:67], v[100:103], v[128:131], v[64:67]
    ds_read_b128 v[100:103], v1 offset:41984
    s_waitcnt lgkmcnt(8)
    v_mfma_f32_16x16x32_bf16 v[32:35], v[104:107], v[124:127], v[32:35]
    v_mfma_f32_16x16x32_bf16 v[68:71], v[104:107], v[128:131], v[68:71]
    ds_read_b128 v[104:107], v1 offset:43008
    buffer_load_dwordx4 v3, s[8:11], s47 offen offset:3072 lds
    s_waitcnt lgkmcnt(8)
    v_mfma_f32_16x16x32_bf16 v[36:39], v[108:111], v[124:127], v[36:39]
    v_mfma_f32_16x16x32_bf16 v[72:75], v[108:111], v[128:131], v[72:75]
    ds_read_b128 v[108:111], v1 offset:44032
    s_waitcnt lgkmcnt(8)
    v_mfma_f32_16x16x32_bf16 v[40:43], v[112:115], v[124:127], v[40:43]
    v_mfma_f32_16x16x32_bf16 v[76:79], v[112:115], v[128:131], v[76:79]
    ds_read_b128 v[112:115], v1 offset:45056
    s_cmp_lg_u32 s37, 0
    s_cbranch_scc1 k3_sk8
    s_add_u32 m0, m0, s42
    s_nop 0
    buffer_load_dwordx4 v252, s[8:11], s47 offen lds
k3_sk8:
    s_add_u32 s47, s47, 36864
    s_waitcnt lgkmcnt(8)
    v_mfma_f32_16x16x32_bf16 v[8:11], v[80:83], v[132:135], v[8:11]
    v_mfma_f32_16x16x32_bf16 v[44:47], v[80:83], v[136:139], v[44:47]
    ds_read_b128 v[80:83], v1 offset:46080
    buffer_load_ushort v200, v199, s[24:27], 0 offen
    s_waitcnt lgkmcnt(8)
    v_mfma_f32_16x16x32_bf16 v[12:15], v[84:87], v[132:135], v[12:15]
    v_mfma_f32_16x16x32_bf16 v[48:51], v[84:87], v[136:139], v[48:51]
    ds_read_b128 v[84:87], v1 offset:47104
    s_waitcnt lgkmcnt(8)
    v_mfma_f32_16x16x32_bf16 v[16:19], v[88:91], v[132:135], v[16:19]
    v_mfma_f32_16x16x32_bf16 v[52:55], v[88:91], v[136:139], v[52:55]
    ds_read_b128 v[88:91], v1 offset:48128
    s_waitcnt lgkmcnt(8)
    v_mfma_f32_16x16x32_bf16 v[20:23], v[92:95], v[132:135], v[20:23]
    v_mfma_f32_16x16x32_bf16 v[56:59], v[92:95], v[136:139], v[56:59]
    ds_read_b128 v[92:95], v1 offset:49152
    s_waitcnt lgkmcnt(8)
    v_mfma_f32_16x16x32_bf16 v[24:27], v[96:99], v[132:135], v[24:27]
    v_mfma_f32_16x16x32_bf16 v[60:63], v[96:99], v[136:139], v[60:63]
    ds_read_b128 v[96:99], v1 offset:50176
    s_waitcnt lgkmcnt(8)
    v_mfma_f32_16x16x32_bf16 v[28:31], v[100:103], v[132:135], v[28:31]
    v_mfma_f32_16x16x32_bf16 v[64:67], v[100:103], v[136:139], v[64:67]
    ds_read_b128 v[100:103], v1 offset:51200
    s_waitcnt lgkmcnt(8)
    v_mfma_f32_16x16x32_bf16 v[32:35], v[104:107], v[132:135], v[32:35]
    v_mfma_f32_16x16x32_bf16 v[68:71], v[104:107], v[136:139], v[68:71]
    ds_read_b128 v[104:107], v1 offset:52224
    s_waitcnt lgkmcnt(8)
    v_mfma_f32_16x16x32_bf16 v[36:39], v[108:111], v[132:135], v[36:39]
    v_mfma_f32_16x16x32_bf16 v[72:75], v[108:111], v[136:139], v[72:75]
    ds_read_b128 v[108:111], v1 offset:53248
    s_waitcnt lgkmcnt(8)
    v_mfma_f32_16x16x32_bf16 v[40:43], v[112:115], v[132:135], v[40:43]
    v_mfma_f32_16x16x32_bf16 v[76:79], v[112:115], v[136:139], v[76:79]
    ds_read_b128 v[112:115], v1 offset:54272
    s_waitcnt vmcnt(9)
    s_barrier
    s_waitcnt lgkmcnt(8)
    v_mfma_f32_16x16x32_bf16 v[8:11], v[80:83], v[140:143], v[8:11]
    v_mfma_f32_16x16x32_bf16 v[44:47], v[80:83], v[144:147], v[44:47]
    ds_read_b128 v[80:83], v2 offset:0
    s_waitcnt lgkmcnt(8)
    v_mfma_f32_16x16x32_bf16 v[12:15], v[84:87], v[140:143], v[12:15]
    v_mfma_f32_16x16x32_bf16 v[48:51], v[84:87], v[144:147], v[48:51]
    ds_read_b128 v[84:87], v2 offset:1024
    s_waitcnt lgkmcnt(8)
    v_mfma_f32_16x16x32_bf16 v[16:19], v[88:91], v[140:143], v[16:19]
    v_mfma_f32_16x16x32_bf16 v[52:55], v[88:91], v[144:147], v[52:55]
    ds_read_b128 v[88:91], v2 offset:2048
    s_waitcnt lgkmcnt(8)
    v_mfma_f32_16x16x32_bf16 v[20:23], v[92:95], v[140:143], v[20:23]
    v_mfma_f32_16x16x32_bf16 v[56:59], v[92:95], v[144:147], v[56:59]
    ds_read_b128 v[92:95], v2 offset:3072
    s_waitcnt lgkmcnt(8)
    v_mfma_f32_16x16x32_bf16 v[24:27], v[96:99], v[140:143], v[24:27]
    v_mfma_f32_16x16x32_bf16 v[60:63], v[96:99], v[144:147], v[60:63]
    ds_read_b128 v[96:99], v2 offset:4096
    s_waitcnt lgkmcnt(8)
    v_mfma_f32_16x16x32_bf16 v[28:31], v[100:103], v[140:143], v[28:31]
    v_mfma_f32_16x16x32_bf16 v[64:67], v[100:103], v[144:147], v[64:67]
    ds_read_b128 v[100:103], v2 offset:5120
    s_waitcnt lgkmcnt(8)
    v_mfma_f32_16x16x32_bf16 v[32:35], v[104:107], v[140:143], v[32:35]
    v_mfma_f32_16x16x32_bf16 v[68:71], v[104:107], v[144:147], v[68:71]
    ds_read_b128 v[104:107], v2 offset:6144
    s_waitcnt lgkmcnt(8)
    v_mfma_f32_16x16x32_bf16 v[36:39], v[108:111], v[140:143], v[36:39]
    v_mfma_f32_16x16x32_bf16 v[72:75], v[108:111], v[144:147], v[72:75]
    ds_read_b128 v[108:111], v2 offset:7168
    s_waitcnt lgkmcnt(8)
    v_mfma_f32_16x16x32_bf16 v[40:43], v[112:115], v[140:143], v[40:43]
    v_mfma_f32_16x16x32_bf16 v[76:79], v[112:115], v[144:147], v[76:79]
    ds_read_b128 v[112:115], v2 offset:8192
    s_bitcmp1_b32 s35, 0
    s_cbranch_scc1 k3_z1odd
    buffer_load_dwordx4 v[180:183], v7, s[16:19], 0 offen offset:0
    buffer_load_dwordx4 v[184:187], v7, s[16:19], 0 offen offset:1024
    buffer_load_dwordx4 v[188:191], v7, s[16:19], 0 offen offset:2048
    buffer_load_dwordx4 v[192:195], v7, s[16:19], 0 offen offset:3072
    s_movk_i32 s49, 0x1000
    buffer_load_dwordx2 v[196:197], v7, s[16:19], s49 offen
    s_branch k3_noz1
k3_z1odd:
    buffer_load_dwordx2 v[180:181], v7, s[16:19], 0 offen offset:8
    s_movk_i32 s49, 0x400
    buffer_load_dwordx4 v[182:185], v7, s[16:19], s49 offen offset:0
    buffer_load_dwordx4 v[186:189], v7, s[16:19], s49 offen offset:1024
    buffer_load_dwordx4 v[190:193], v7, s[16:19], s49 offen offset:2048
    buffer_load_dwordx4 v[194:197], v7, s[16:19], s49 offen offset:3072
k3_noz1:
    s_waitcnt lgkmcnt(8)
    v_mfma_f32_16x16x32_bf16 v[8:11], v[80:83], v[148:151], v[8:11]
    v_mfma_f32_16x16x32_bf16 v[44:47], v[80:83], v[152:155], v[44:47]
    ds_read_b128 v[80:83], v2 offset:9216
    s_waitcnt lgkmcnt(8)
    v_mfma_f32_16x16x32_bf16 v[12:15], v[84:87], v[148:151], v[12:15]
    v_mfma_f32_16x16x32_bf16 v[48:51], v[84:87], v[152:155], v[48:51]
    ds_read_b128 v[84:87], v2 offset:10240
    s_waitcnt lgkmcnt(8)
    v_mfma_f32_16x16x32_bf16 v[16:19], v[88:91], v[148:151], v[16:19]
    v_mfma_f32_16x16x32_bf16 v[52:55], v[88:91], v[152:155], v[52:55]
    ds_read_b128 v[88:91], v2 offset:11264
    s_waitcnt lgkmcnt(8)
    v_mfma_f32_16x16x32_bf16 v[20:23], v[92:95], v[148:151], v[20:23]
    v_mfma_f32_16x16x32_bf16 v[56:59], v[92:95], v[152:155], v[56:59]
    ds_read_b128 v[92:95], v2 offset:12288
    s_waitcnt lgkmcnt(8)
    v_mfma_f32_16x16x32_bf16 v[24:27], v[96:99], v[148:151], v[24:27]
    v_mfma_f32_16x16x32_bf16 v[60:63], v[96:99], v[152:155], v[60:63]
    ds_read_b128 v[96:99], v2 offset:13312
    s_waitcnt lgkmcnt(8)
    v_mfma_f32_16x16x32_bf16 v[28:31], v[100:103], v[148:151], v[28:31]
    v_mfma_f32_16x16x32_bf16 v[64:67], v[100:103], v[152:155], v[64:67]
    ds_read_b128 v[100:103], v2 offset:14336
    s_waitcnt lgkmcnt(8)
    v_mfma_f32_16x16x32_bf16 v[32:35], v[104:107], v[148:151], v[32:35]
    v_mfma_f32_16x16x32_bf16 v[68:71], v[104:107], v[152:155], v[68:71]
    ds_read_b128 v[104:107], v2 offset:15360
    s_waitcnt lgkmcnt(8)
    v_mfma_f32_16x16x32_bf16 v[36:39], v[108:111], v[148:151], v[36:39]
    v_mfma_f32_16x16x32_bf16 v[72:75], v[108:111], v[152:155], v[72:75]
    ds_read_b128 v[108:111], v2 offset:16384
    s_waitcnt lgkmcnt(8)
    v_mfma_f32_16x16x32_bf16 v[40:43], v[112:115], v[148:151], v[40:43]
    v_mfma_f32_16x16x32_bf16 v[76:79], v[112:115], v[152:155], v[76:79]
    ds_read_b128 v[112:115], v2 offset:17408
    s_waitcnt vmcnt(6)
    s_barrier
    s_waitcnt lgkmcnt(8)
    v_mfma_f32_16x16x32_bf16 v[8:11], v[80:83], v[156:159], v[8:11]
    v_mfma_f32_16x16x32_bf16 v[44:47], v[80:83], v[160:163], v[44:47]
    ds_read_b128 v[80:83], v2 offset:36864
    s_waitcnt lgkmcnt(8)
    v_mfma_f32_16x16x32_bf16 v[12:15], v[84:87], v[156:159], v[12:15]
    v_mfma_f32_16x16x32_bf16 v[48:51], v[84:87], v[160:163], v[48:51]
    ds_read_b128 v[84:87], v2 offset:37888
    s_waitcnt lgkmcnt(8)
    v_mfma_f32_16x16x32_bf16 v[16:19], v[88:91], v[156:159], v[16:19]
    v_mfma_f32_16x16x32_bf16 v[52:55], v[88:91], v[160:163], v[52:55]
    ds_read_b128 v[88:91], v2 offset:38912
    s_waitcnt lgkmcnt(8)
    v_mfma_f32_16x16x32_bf16 v[20:23], v[92:95], v[156:159], v[20:23]
    v_mfma_f32_16x16x32_bf16 v[56:59], v[92:95], v[160:163], v[56:59]
    ds_read_b128 v[92:95], v2 offset:39936
    s_waitcnt lgkmcnt(8)
    v_mfma_f32_16x16x32_bf16 v[24:27], v[96:99], v[156:159], v[24:27]
    v_mfma_f32_16x16x32_bf16 v[60:63], v[96:99], v[160:163], v[60:63]
    ds_read_b128 v[96:99], v2 offset:40960
    s_waitcnt lgkmcnt(8)
    v_mfma_f32_16x16x32_bf16 v[28:31], v[100:103], v[156:159], v[28:31]
    v_mfma_f32_16x16x32_bf16 v[64:67], v[100:103], v[160:163], v[64:67]
    ds_read_b128 v[100:103], v2 offset:41984
    s_waitcnt lgkmcnt(8)
    v_mfma_f32_16x16x32_bf16 v[32:35], v[104:107], v[156:159], v[32:35]
    v_mfma_f32_16x16x32_bf16 v[68:71], v[104:107], v[160:163], v[68:71]
    ds_read_b128 v[104:107], v2 offset:43008
    s_waitcnt lgkmcnt(8)
    v_mfma_f32_16x16x32_bf16 v[36:39], v[108:111], v[156:159], v[36:39]
    v_mfma_f32_16x16x32_bf16 v[72:75], v[108:111], v[160:163], v[72:75]
    ds_read_b128 v[108:111], v2 offset:44032
    s_waitcnt lgkmcnt(8)
    v_mfma_f32_16x16x32_bf16 v[40:43], v[112:115], v[156:159], v[40:43]
    v_mfma_f32_16x16x32_bf16 v[76:79], v[112:115], v[160:163], v[76:79]
    ds_read_b128 v[112:115], v2 offset:45056
    s_waitcnt lgkmcnt(8)
    v_mfma_f32_16x16x32_bf16 v[8:11], v[80:83], v[164:167], v[8:11]
    v_mfma_f32_16x16x32_bf16 v[44:47], v[80:83], v[168:171], v[44:47]
    ds_read_b128 v[80:83], v2 offset:46080
    s_waitcnt lgkmcnt(8)
    v_mfma_f32_16x16x32_bf16 v[12:15], v[84:87], v[164:167], v[12:15]
    v_mfma_f32_16x16x32_bf16 v[48:51], v[84:87], v[168:171], v[48:51]
    ds_read_b128 v[84:87], v2 offset:47104
    s_waitcnt lgkmcnt(8)
    v_mfma_f32_16x16x32_bf16 v[16:19], v[88:91], v[164:167], v[16:19]
    v_mfma_f32_16x16x32_bf16 v[52:55], v[88:91], v[168:171], v[52:55]
    ds_read_b128 v[88:91], v2 offset:48128
    s_waitcnt lgkmcnt(8)
    v_mfma_f32_16x16x32_bf16 v[20:23], v[92:95], v[164:167], v[20:23]
    v_mfma_f32_16x16x32_bf16 v[56:59], v[92:95], v[168:171], v[56:59]
    ds_read_b128 v[92:95], v2 offset:49152
    s_waitcnt lgkmcnt(8)
    v_mfma_f32_16x16x32_bf16 v[24:27], v[96:99], v[164:167], v[24:27]
    v_mfma_f32_16x16x32_bf16 v[60:63], v[96:99], v[168:171], v[60:63]
    ds_read_b128 v[96:99], v2 offset:50176
    s_waitcnt lgkmcnt(8)
    v_mfma_f32_16x16x32_bf16 v[28:31], v[100:103], v[164:167], v[28:31]
    v_mfma_f32_16x16x32_bf16 v[64:67], v[100:103], v[168:171], v[64:67]
    ds_read_b128 v[100:103], v2 offset:51200
    s_waitcnt lgkmcnt(8)
    v_mfma_f32_16x16x32_bf16 v[32:35], v[104:107], v[164:167], v[32:35]
    v_mfma_f32_16x16x32_bf16 v[68:71], v[104:107], v[168:171], v[68:71]
    ds_read_b128 v[104:107], v2 offset:52224
    s_waitcnt lgkmcnt(8)
    v_mfma_f32_16x16x32_bf16 v[36:39], v[108:111], v[164:167], v[36:39]
    v_mfma_f32_16x16x32_bf16 v[72:75], v[108:111], v[168:171], v[72:75]
    ds_read_b128 v[108:111], v2 offset:53248
    s_waitcnt lgkmcnt(8)
    v_mfma_f32_16x16x32_bf16 v[40:43], v[112:115], v[164:167], v[40:43]
    v_mfma_f32_16x16x32_bf16 v[76:79], v[112:115], v[168:171], v[76:79]
    ds_read_b128 v[112:115], v2 offset:54272
    s_waitcnt lgkmcnt(8)
    v_mfma_f32_16x16x32_bf16 v[8:11], v[80:83], v[172:175], v[8:11]
    v_mfma_f32_16x16x32_bf16 v[44:47], v[80:83], v[176:179], v[44:47]
    s_waitcnt lgkmcnt(7)
    v_mfma_f32_16x16x32_bf16 v[12:15], v[84:87], v[172:175], v[12:15]
    v_mfma_f32_16x16x32_bf16 v[48:51], v[84:87], v[176:179], v[48:51]
    s_waitcnt lgkmcnt(6)
    v_mfma_f32_16x16x32_bf16 v[16:19], v[88:91], v[172:175], v[16:19]
    v_mfma_f32_16x16x32_bf16 v[52:55], v[88:91], v[176:179], v[52:55]
    s_waitcnt lgkmcnt(5)
    v_mfma_f32_16x16x32_bf16 v[20:23], v[92:95], v[172:175], v[20:23]
    v_mfma_f32_16x16x32_bf16 v[56:59], v[92:95], v[176:179], v[56:59]
    s_waitcnt lgkmcnt(4)
    v_mfma_f32_16x16x32_bf16 v[24:27], v[96:99], v[172:175], v[24:27]
    v_mfma_f32_16x16x32_bf16 v[60:63], v[96:99], v[176:179], v[60:63]
    s_waitcnt lgkmcnt(3)
    v_mfma_f32_16x16x32_bf16 v[28:31], v[100:103], v[172:175], v[28:31]
    v_mfma_f32_16x16x32_bf16 v[64:67], v[100:103], v[176:179], v[64:67]
    s_waitcnt lgkmcnt(2)
    v_mfma_f32_16x16x32_bf16 v[32:35], v[104:107], v[172:175], v[32:35]
    v_mfma_f32_16x16x32_bf16 v[68:71], v[104:107], v[176:179], v[68:71]
    s_waitcnt lgkmcnt(1)
    v_mfma_f32_16x16x32_bf16 v[36:39], v[108:111], v[172:175], v[36:39]
    v_mfma_f32_16x16x32_bf16 v[72:75], v[108:111], v[176:179], v[72:75]
    s_waitcnt lgkmcnt(0)
    v_mfma_f32_16x16x32_bf16 v[40:43], v[112:115], v[172:175], v[40:43]
    v_mfma_f32_16x16x32_bf16 v[76:79], v[112:115], v[176:179], v[76:79]
    s_waitcnt vmcnt(0) lgkmcnt(0)
    s_barrier
    s_mul_i32 s43, s36, 9216
    v_add_u32 v1, s43, v7
    s_xor_b32 s44, s36, 4
    s_mul_i32 s44, s44, 9216
    v_add_u32 v2, s44, v7
    s_cmp_lg_u32 s37, 0
    s_cbranch_scc1 k3_ysend
    ds_write_b128 v1, v[44:47] offset:0
    ds_write_b128 v1, v[48:51] offset:1024
    ds_write_b128 v1, v[52:55] offset:2048
    ds_write_b128 v1, v[56:59] offset:3072
    ds_write_b128 v1, v[60:63] offset:4096
    ds_write_b128 v1, v[64:67] offset:5120
    ds_write_b128 v1, v[68:71] offset:6144
    ds_write_b128 v1, v[72:75] offset:7168
    ds_write_b128 v1, v[76:79] offset:8192
    s_waitcnt lgkmcnt(0)
    s_barrier
    ds_read_b128 v[44:47], v2 offset:0
    ds_read_b128 v[48:51], v2 offset:1024
    ds_read_b128 v[52:55], v2 offset:2048
    ds_read_b128 v[56:59], v2 offset:3072
    ds_read_b128 v[60:63], v2 offset:4096
    ds_read_b128 v[64:67], v2 offset:5120
    ds_read_b128 v[68:71], v2 offset:6144
    ds_read_b128 v[72:75], v2 offset:7168
    ds_read_b128 v[76:79], v2 offset:8192
    s_branch k3_sent
k3_ysend:
    ds_write_b128 v1, v[8:11] offset:0
    ds_write_b128 v1, v[12:15] offset:1024
    ds_write_b128 v1, v[16:19] offset:2048
    ds_write_b128 v1, v[20:23] offset:3072
    ds_write_b128 v1, v[24:27] offset:4096
    ds_write_b128 v1, v[28:31] offset:5120
    ds_write_b128 v1, v[32:35] offset:6144
    ds_write_b128 v1, v[36:39] offset:7168
    ds_write_b128 v1, v[40:43] offset:8192
    s_waitcnt lgkmcnt(0)
    s_barrier
    ds_read_b128 v[8:11], v2 offset:0
    ds_read_b128 v[12:15], v2 offset:1024
    ds_read_b128 v[16:19], v2 offset:2048
    ds_read_b128 v[20:23], v2 offset:3072
    ds_read_b128 v[24:27], v2 offset:4096
    ds_read_b128 v[28:31], v2 offset:5120
    ds_read_b128 v[32:35], v2 offset:6144
    ds_read_b128 v[36:39], v2 offset:7168
    ds_read_b128 v[40:43], v2 offset:8192
k3_sent:
    v_lshlrev_b32 v200, 16, v200
    s_waitcnt lgkmcnt(8)
    v_add_f32 v8, v8, v44
    v_add_f32 v9, v9, v45
    v_add_f32 v10, v10, v46
    v_add_f32 v11, v11, v47
    v_add_f32 v8, v8, v200
    v_add_f32 v9, v9, v200
    v_add_f32 v10, v10, v200
    v_add_f32 v11, v11, v200
    v_lshlrev_b32 v116, 16, v180
    v_and_b32 v117, 0xffff0000, v180
    v_mul_f32 v116, v116, v8
    v_mul_f32 v117, v117, v9
    v_cvt_pk_bf16_f32 v180, v116, v117
    v_lshlrev_b32 v116, 16, v181
    v_and_b32 v117, 0xffff0000, v181
    v_mul_f32 v116, v116, v10
    v_mul_f32 v117, v117, v11
    v_cvt_pk_bf16_f32 v181, v116, v117
    s_waitcnt lgkmcnt(7)
    v_add_f32 v12, v12, v48
    v_add_f32 v13, v13, v49
    v_add_f32 v14, v14, v50
    v_add_f32 v15, v15, v51
    v_add_f32 v12, v12, v200
    v_add_f32 v13, v13, v200
    v_add_f32 v14, v14, v200
    v_add_f32 v15, v15, v200
    v_lshlrev_b32 v116, 16, v182
    v_and_b32 v117, 0xffff0000, v182
    v_mul_f32 v116, v116, v12
    v_mul_f32 v117, v117, v13
    v_cvt_pk_bf16_f32 v182, v116, v117
    v_lshlrev_b32 v116, 16, v183
    v_and_b32 v117, 0xffff0000, v183
    v_mul_f32 v116, v116, v14
    v_mul_f32 v117, v117, v15
    v_cvt_pk_bf16_f32 v183, v116, v117
    s_waitcnt lgkmcnt(6)
    v_add_f32 v16, v16, v52
    v_add_f32 v17, v17, v53
    v_add_f32 v18, v18, v54
    v_add_f32 v19, v19, v55
    v_add_f32 v16, v16, v200
    v_add_f32 v17, v17, v200
    v_add_f32 v18, v18, v200
    v_add_f32 v19, v19, v200
    v_lshlrev_b32 v116, 16, v184
    v_and_b32 v117, 0xffff0000, v184
    v_mul_f32 v116, v116, v16
    v_mul_f32 v117, v117, v17
    v_cvt_pk_bf16_f32 v184, v116, v117
    v_lshlrev_b32 v116, 16, v185
    v_and_b32 v117, 0xffff0000, v185
    v_mul_f32 v116, v116, v18
    v_mul_f32 v117, v117, v19
    v_cvt_pk_bf16_f32 v185, v116, v117
    s_waitcnt lgkmcnt(5)
    v_add_f32 v20, v20, v56
    v_add_f32 v21, v21, v57
    v_add_f32 v22, v22, v58
    v_add_f32 v23, v23, v59
    v_add_f32 v20, v20, v200
    v_add_f32 v21, v21, v200
    v_add_f32 v22, v22, v200
    v_add_f32 v23, v23, v200
    v_lshlrev_b32 v116, 16, v186
    v_and_b32 v117, 0xffff0000, v186
    v_mul_f32 v116, v116, v20
    v_mul_f32 v117, v117, v21
    v_cvt_pk_bf16_f32 v186, v116, v117
    v_lshlrev_b32 v116, 16, v187
    v_and_b32 v117, 0xffff0000, v187
    v_mul_f32 v116, v116, v22
    v_mul_f32 v117, v117, v23
    v_cvt_pk_bf16_f32 v187, v116, v117
    s_waitcnt lgkmcnt(4)
    v_add_f32 v24, v24, v60
    v_add_f32 v25, v25, v61
    v_add_f32 v26, v26, v62
    v_add_f32 v27, v27, v63
    v_add_f32 v24, v24, v200
    v_add_f32 v25, v25, v200
    v_add_f32 v26, v26, v200
    v_add_f32 v27, v27, v200
    v_lshlrev_b32 v116, 16, v188
    v_and_b32 v117, 0xffff0000, v188
    v_mul_f32 v116, v116, v24
    v_mul_f32 v117, v117, v25
    v_cvt_pk_bf16_f32 v188, v116, v117
    v_lshlrev_b32 v116, 16, v189
    v_and_b32 v117, 0xffff0000, v189
    v_mul_f32 v116, v116, v26
    v_mul_f32 v117, v117, v27
    v_cvt_pk_bf16_f32 v189, v116, v117
    s_waitcnt lgkmcnt(3)
    v_add_f32 v28, v28, v64
    v_add_f32 v29, v29, v65
    v_add_f32 v30, v30, v66
    v_add_f32 v31, v31, v67
    v_add_f32 v28, v28, v200
    v_add_f32 v29, v29, v200
    v_add_f32 v30, v30, v200
    v_add_f32 v31, v31, v200
    v_lshlrev_b32 v116, 16, v190
    v_and_b32 v117, 0xffff0000, v190
    v_mul_f32 v116, v116, v28
    v_mul_f32 v117, v117, v29
    v_cvt_pk_bf16_f32 v190, v116, v117
    v_lshlrev_b32 v116, 16, v191
    v_and_b32 v117, 0xffff0000, v191
    v_mul_f32 v116, v116, v30
    v_mul_f32 v117, v117, v31
    v_cvt_pk_bf16_f32 v191, v116, v117
    s_waitcnt lgkmcnt(2)
    v_add_f32 v32, v32, v68
    v_add_f32 v33, v33, v69
    v_add_f32 v34, v34, v70
    v_add_f32 v35, v35, v71
    v_add_f32 v32, v32, v200
    v_add_f32 v33, v33, v200
    v_add_f32 v34, v34, v200
    v_add_f32 v35, v35, v200
    v_lshlrev_b32 v116, 16, v192
    v_and_b32 v117, 0xffff0000, v192
    v_mul_f32 v116, v116, v32
    v_mul_f32 v117, v117, v33
    v_cvt_pk_bf16_f32 v192, v116, v117
    v_lshlrev_b32 v116, 16, v193
    v_and_b32 v117, 0xffff0000, v193
    v_mul_f32 v116, v116, v34
    v_mul_f32 v117, v117, v35
    v_cvt_pk_bf16_f32 v193, v116, v117
    s_waitcnt lgkmcnt(1)
    v_add_f32 v36, v36, v72
    v_add_f32 v37, v37, v73
    v_add_f32 v38, v38, v74
    v_add_f32 v39, v39, v75
    v_add_f32 v36, v36, v200
    v_add_f32 v37, v37, v200
    v_add_f32 v38, v38, v200
    v_add_f32 v39, v39, v200
    v_lshlrev_b32 v116, 16, v194
    v_and_b32 v117, 0xffff0000, v194
    v_mul_f32 v116, v116, v36
    v_mul_f32 v117, v117, v37
    v_cvt_pk_bf16_f32 v194, v116, v117
    v_lshlrev_b32 v116, 16, v195
    v_and_b32 v117, 0xffff0000, v195
    v_mul_f32 v116, v116, v38
    v_mul_f32 v117, v117, v39
    v_cvt_pk_bf16_f32 v195, v116, v117
    s_waitcnt lgkmcnt(0)
    v_add_f32 v40, v40, v76
    v_add_f32 v41, v41, v77
    v_add_f32 v42, v42, v78
    v_add_f32 v43, v43, v79
    v_add_f32 v40, v40, v200
    v_add_f32 v41, v41, v200
    v_add_f32 v42, v42, v200
    v_add_f32 v43, v43, v200
    v_lshlrev_b32 v116, 16, v196
    v_and_b32 v117, 0xffff0000, v196
    v_mul_f32 v116, v116, v40
    v_mul_f32 v117, v117, v41
    v_cvt_pk_bf16_f32 v196, v116, v117
    v_lshlrev_b32 v116, 16, v197
    v_and_b32 v117, 0xffff0000, v197
    v_mul_f32 v116, v116, v42
    v_mul_f32 v117, v117, v43
    v_cvt_pk_bf16_f32 v197, v116, v117
    s_bitcmp1_b32 s35, 0
    s_cbranch_scc1 k3_stodd
    buffer_store_dwordx4 v[180:183], v7, s[20:23], 0 offen offset:0
    buffer_store_dwordx4 v[184:187], v7, s[20:23], 0 offen offset:1024
    buffer_store_dwordx4 v[188:191], v7, s[20:23], 0 offen offset:2048
    buffer_store_dwordx4 v[192:195], v7, s[20:23], 0 offen offset:3072
    buffer_store_dwordx2 v[196:197], v7, s[20:23], s49 offen
    s_endpgm
k3_stodd:
    buffer_store_dwordx2 v[180:181], v7, s[20:23], 0 offen offset:8
    buffer_store_dwordx4 v[182:185], v7, s[20:23], s49 offen offset:0
    buffer_store_dwordx4 v[186:189], v7, s[20:23], s49 offen offset:1024
    buffer_store_dwordx4 v[190:193], v7, s[20:23], s49 offen offset:2048
    buffer_store_dwordx4 v[194:197], v7, s[20:23], s49 offen offset:3072
k3_end:
    s_endpgm
.globl k4_kernel
.p2align 8
.type k4_kernel,@function
k4_kernel:
    s_cmp_ge_u32 s2, 256
    s_cbranch_scc1 k4_end
    s_load_dwordx2 s[4:5], s[0:1], 80
    s_load_dwordx2 s[6:7], s[0:1], 0
    s_load_dwordx2 s[28:29], s[0:1], 64
    v_lshrrev_b32 v1, 6, v0
    v_and_b32 v0, 63, v0
    s_and_b32 s32, s2, 3
    v_readfirstlane_b32 s36, v1
    s_lshl_b32 s32, s32, 3
    s_bfe_u32 s33, s2, 0x30003
    s_add_u32 s32, s32, s33
    s_bfe_u32 s33, s2, 0x10002
    s_lshl_b32 s33, s33, 2
    s_lshr_b32 s34, s2, 6
    s_add_u32 s33, s33, s34
    v_lshlrev_b32 v1, 4, v0
    v_lshrrev_b32 v2, 4, v0
    v_and_b32 v3, 15, v0
    s_lshl_b32 s37, s36, 10
    s_add_u32 s38, s36, 0
    s_and_b32 s38, s38, 3
    s_mul_i32 s38, s38, 92160
    s_add_u32 s38, s38, s37
    v_add_u32 v4, s38, v1
    s_add_u32 s38, s36, 1
    s_and_b32 s38, s38, 3
    s_mul_i32 s38, s38, 92160
    s_add_u32 s38, s38, s37
    v_add_u32 v5, s38, v1
    s_add_u32 s38, s36, 2
    s_and_b32 s38, s38, 3
    s_mul_i32 s38, s38, 92160
    s_add_u32 s38, s38, s37
    v_add_u32 v6, s38, v1
    s_add_u32 s38, s36, 3
    s_and_b32 s38, s38, 3
    s_mul_i32 s38, s38, 92160
    s_add_u32 s38, s38, s37
    v_add_u32 v7, s38, v1
    v_mul_u32_u24 v8, 9216, v2
    v_lshl_add_u32 v8, v3, 4, v8
    s_mul_i32 s38, s36, 36864
    s_mul_i32 s39, s33, 1152
    s_add_u32 s38, s38, s39
    v_add_u32 v8, s38, v8
    v_mov_b32 v10, 0x10000000
    v_cmp_gt_u32 vcc, 8, v3
    s_mul_i32 s38, s32, 368640
    s_add_u32 s38, s38, 0x1c00000
    v_cndmask_b32 v9, v10, v8, vcc
    s_waitcnt lgkmcnt(0)
    s_add_u32 s8, s4, s38
    s_addc_u32 s9, s5, 0
    s_mov_b32 s10, 0x5a000
    s_mov_b32 s11, 0x00020000
    s_add_u32 s12, s4, 0x3100000
    s_addc_u32 s13, s5, 0
    s_mov_b32 s14, 0x32a000
    s_mov_b32 s15, 0x00020000
    s_mov_b32 s40, 0
    s_mov_b32 s41, 0
    buffer_load_dwordx4 v[56:59], v8, s[12:15], s41 offen offset:0
    buffer_load_dwordx4 v[60:63], v8, s[12:15], s41 offen offset:256
    buffer_load_dwordx4 v[64:67], v8, s[12:15], s41 offen offset:512
    buffer_load_dwordx4 v[68:71], v8, s[12:15], s41 offen offset:768
    buffer_load_dwordx4 v[72:75], v9, s[12:15], s41 offen offset:1024
    buffer_load_dwordx4 v[40:43], v4, s[8:11], s40 offen
    buffer_load_dwordx4 v[44:47], v5, s[8:11], s40 offen
    buffer_load_dwordx4 v[48:51], v6, s[8:11], s40 offen
    buffer_load_dwordx4 v[52:55], v7, s[8:11], s40 offen
    s_add_u32 s40, s40, 4096
    s_add_u32 s41, s41, 147456
    buffer_load_dwordx4 v[92:95], v8, s[12:15], s41 offen offset:0
    buffer_load_dwordx4 v[96:99], v8, s[12:15], s41 offen offset:256
    buffer_load_dwordx4 v[100:103], v8, s[12:15], s41 offen offset:512
    buffer_load_dwordx4 v[104:107], v8, s[12:15], s41 offen offset:768
    buffer_load_dwordx4 v[108:111], v9, s[12:15], s41 offen offset:1024
    buffer_load_dwordx4 v[76:79], v4, s[8:11], s40 offen
    buffer_load_dwordx4 v[80:83], v5, s[8:11], s40 offen
    buffer_load_dwordx4 v[84:87], v6, s[8:11], s40 offen
    buffer_load_dwordx4 v[88:91], v7, s[8:11], s40 offen
    s_add_u32 s40, s40, 4096
    s_add_u32 s41, s41, 147456
    buffer_load_dwordx4 v[128:131], v8, s[12:15], s41 offen offset:0
    buffer_load_dwordx4 v[132:135], v8, s[12:15], s41 offen offset:256
    buffer_load_dwordx4 v[136:139], v8, s[12:15], s41 offen offset:512
    buffer_load_dwordx4 v[140:143], v8, s[12:15], s41 offen offset:768
    buffer_load_dwordx4 v[144:147], v9, s[12:15], s41 offen offset:1024
    buffer_load_dwordx4 v[112:115], v4, s[8:11], s40 offen
    buffer_load_dwordx4 v[116:119], v5, s[8:11], s40 offen
    buffer_load_dwordx4 v[120:123], v6, s[8:11], s40 offen
    buffer_load_dwordx4 v[124:127], v7, s[8:11], s40 offen
    s_add_u32 s40, s40, 4096
    s_add_u32 s41, s41, 147456
    buffer_load_dwordx4 v[164:167], v8, s[12:15], s41 offen offset:0
    buffer_load_dwordx4 v[168:171], v8, s[12:15], s41 offen offset:256
    buffer_load_dwordx4 v[172:175], v8, s[12:15], s41 offen offset:512
    buffer_load_dwordx4 v[176:179], v8, s[12:15], s41 offen offset:768
    buffer_load_dwordx4 v[180:183], v9, s[12:15], s41 offen offset:1024
    buffer_load_dwordx4 v[148:151], v4, s[8:11], s40 offen
    buffer_load_dwordx4 v[152:155], v5, s[8:11], s40 offen
    buffer_load_dwordx4 v[156:159], v6, s[8:11], s40 offen
    buffer_load_dwordx4 v[160:163], v7, s[8:11], s40 offen
    s_add_u32 s40, s40, 4096
    s_add_u32 s41, s41, 147456
    buffer_load_dwordx4 v[200:203], v8, s[12:15], s41 offen offset:0
    buffer_load_dwordx4 v[204:207], v8, s[12:15], s41 offen offset:256
    buffer_load_dwordx4 v[208:211], v8, s[12:15], s41 offen offset:512
    buffer_load_dwordx4 v[212:215], v8, s[12:15], s41 offen offset:768
    buffer_load_dwordx4 v[216:219], v9, s[12:15], s41 offen offset:1024
    buffer_load_dwordx4 v[184:187], v4, s[8:11], s40 offen
    buffer_load_dwordx4 v[188:191], v5, s[8:11], s40 offen
    buffer_load_dwordx4 v[192:195], v6, s[8:11], s40 offen
    buffer_load_dwordx4 v[196:199], v7, s[8:11], s40 offen
    s_add_u32 s40, s40, 4096
    s_add_u32 s41, s41, 147456
    buffer_load_dwordx4 v[236:239], v8, s[12:15], s41 offen offset:0
    buffer_load_dwordx4 v[240:243], v8, s[12:15], s41 offen offset:256
    buffer_load_dwordx4 v[244:247], v8, s[12:15], s41 offen offset:512
    buffer_load_dwordx4 v[248:251], v8, s[12:15], s41 offen offset:768
    buffer_load_dwordx4 v[252:255], v9, s[12:15], s41 offen offset:1024
    buffer_load_dwordx4 v[220:223], v4, s[8:11], s40 offen
    buffer_load_dwordx4 v[224:227], v5, s[8:11], s40 offen
    buffer_load_dwordx4 v[228:231], v6, s[8:11], s40 offen
    buffer_load_dwordx4 v[232:235], v7, s[8:11], s40 offen
    s_add_u32 s40, s40, 4096
    s_add_u32 s41, s41, 147456
    s_mov_b32 s16, s6
    s_mov_b32 s17, s7
    s_mov_b32 s18, 0x240000
    s_mov_b32 s19, 0x00020000
    s_mov_b32 s20, s28
    s_mov_b32 s21, s29
    s_mov_b32 s22, 0x240000
    s_mov_b32 s23, 0x00020000
    v_lshrrev_b32 v11, 2, v3
    v_lshlrev_b32 v11, 3, v11
    v_and_b32 v12, 3, v3
    v_add_u32 v11, v11, v12
    s_lshr_b32 s38, s36, 1
    s_lshl_b32 s38, s38, 5
    s_and_b32 s39, s36, 1
    s_lshl_b32 s39, s39, 2
    s_add_u32 s38, s38, s39
    s_lshl_b32 s39, s32, 6
    s_add_u32 s38, s38, s39
    s_mul_i32 s38, s38, 1152
    s_mul_i32 s39, s33, 144
    s_add_u32 s38, s38, s39
    v_mul_u32_u24 v11, 1152, v11
    v_lshl_add_u32 v11, v2, 3, v11
    v_add_u32 v11, s38, v11
    v_cmp_gt_u32 vcc, 2, v2
    s_add_u32 s38, s36, 1
    s_and_b32 s38, s38, 3
    s_mul_i32 s38, s38, 15360
    v_cndmask_b32 v12, v10, v11, vcc
    v_add_u32 v13, s38, v1
    s_add_u32 s38, s36, 2
    s_and_b32 s38, s38, 3
    s_mul_i32 s38, s38, 15360
    v_add_u32 v14, s38, v1
    s_add_u32 s38, s36, 3
    s_and_b32 s38, s38, 3
    s_mul_i32 s38, s38, 15360
    v_add_u32 v15, s38, v1
    s_mul_i32 s38, s36, 15360
    v_add_u32 v1, s38, v1
    s_waitcnt vmcnt(45)
    v_mfma_f32_16x16x32_bf16 a[0:3], v[56:59], v[40:43], 0
    v_mfma_f32_16x16x32_bf16 a[20:23], v[56:59], v[44:47], 0
    v_mfma_f32_16x16x32_bf16 a[40:43], v[56:59], v[48:51], 0
    v_mfma_f32_16x16x32_bf16 a[60:63], v[56:59], v[52:55], 0
    buffer_load_dwordx4 v[56:59], v8, s[12:15], s41 offen offset:0
    v_mfma_f32_16x16x32_bf16 a[4:7], v[60:63], v[40:43], 0
    v_mfma_f32_16x16x32_bf16 a[24:27], v[60:63], v[44:47], 0
    v_mfma_f32_16x16x32_bf16 a[44:47], v[60:63], v[48:51], 0
    v_mfma_f32_16x16x32_bf16 a[64:67], v[60:63], v[52:55], 0
    buffer_load_dwordx4 v[60:63], v8, s[12:15], s41 offen offset:256
    v_mfma_f32_16x16x32_bf16 a[8:11], v[64:67], v[40:43], 0
    v_mfma_f32_16x16x32_bf16 a[28:31], v[64:67], v[44:47], 0
    v_mfma_f32_16x16x32_bf16 a[48:51], v[64:67], v[48:51], 0
    v_mfma_f32_16x16x32_bf16 a[68:71], v[64:67], v[52:55], 0
    buffer_load_dwordx4 v[64:67], v8, s[12:15], s41 offen offset:512
    v_mfma_f32_16x16x32_bf16 a[12:15], v[68:71], v[40:43], 0
    v_mfma_f32_16x16x32_bf16 a[32:35], v[68:71], v[44:47], 0
    v_mfma_f32_16x16x32_bf16 a[52:55], v[68:71], v[48:51], 0
    v_mfma_f32_16x16x32_bf16 a[72:75], v[68:71], v[52:55], 0
    buffer_load_dwordx4 v[68:71], v8, s[12:15], s41 offen offset:768
    v_mfma_f32_16x16x32_bf16 a[16:19], v[72:75], v[40:43], 0
    v_mfma_f32_16x16x32_bf16 a[36:39], v[72:75], v[44:47], 0
    v_mfma_f32_16x16x32_bf16 a[56:59], v[72:75], v[48:51], 0
    v_mfma_f32_16x16x32_bf16 a[76:79], v[72:75], v[52:55], 0
    buffer_load_dwordx4 v[72:75], v9, s[12:15], s41 offen offset:1024
    buffer_load_dwordx4 v[40:43], v4, s[8:11], s40 offen
    buffer_load_dwordx4 v[44:47], v5, s[8:11], s40 offen
    buffer_load_dwordx4 v[48:51], v6, s[8:11], s40 offen
    buffer_load_dwordx4 v[52:55], v7, s[8:11], s40 offen
    s_add_u32 s40, s40, 4096
    s_add_u32 s41, s41, 147456
    s_waitcnt vmcnt(45)
    v_mfma_f32_16x16x32_bf16 a[0:3], v[92:95], v[76:79], a[0:3]
    v_mfma_f32_16x16x32_bf16 a[20:23], v[92:95], v[80:83], a[20:23]
    v_mfma_f32_16x16x32_bf16 a[40:43], v[92:95], v[84:87], a[40:43]
    v_mfma_f32_16x16x32_bf16 a[60:63], v[92:95], v[88:91], a[60:63]
    buffer_load_dwordx4 v[92:95], v8, s[12:15], s41 offen offset:0
    v_mfma_f32_16x16x32_bf16 a[4:7], v[96:99], v[76:79], a[4:7]
    v_mfma_f32_16x16x32_bf16 a[24:27], v[96:99], v[80:83], a[24:27]
    v_mfma_f32_16x16x32_bf16 a[44:47], v[96:99], v[84:87], a[44:47]
    v_mfma_f32_16x16x32_bf16 a[64:67], v[96:99], v[88:91], a[64:67]
    buffer_load_dwordx4 v[96:99], v8, s[12:15], s41 offen offset:256
    v_mfma_f32_16x16x32_bf16 a[8:11], v[100:103], v[76:79], a[8:11]
    v_mfma_f32_16x16x32_bf16 a[28:31], v[100:103], v[80:83], a[28:31]
    v_mfma_f32_16x16x32_bf16 a[48:51], v[100:103], v[84:87], a[48:51]
    v_mfma_f32_16x16x32_bf16 a[68:71], v[100:103], v[88:91], a[68:71]
    buffer_load_dwordx4 v[100:103], v8, s[12:15], s41 offen offset:512
    v_mfma_f32_16x16x32_bf16 a[12:15], v[104:107], v[76:79], a[12:15]
    v_mfma_f32_16x16x32_bf16 a[32:35], v[104:107], v[80:83], a[32:35]
    v_mfma_f32_16x16x32_bf16 a[52:55], v[104:107], v[84:87], a[52:55]
    v_mfma_f32_16x16x32_bf16 a[72:75], v[104:107], v[88:91], a[72:75]
    buffer_load_dwordx4 v[104:107], v8, s[12:15], s41 offen offset:768
    v_mfma_f32_16x16x32_bf16 a[16:19], v[108:111], v[76:79], a[16:19]
    v_mfma_f32_16x16x32_bf16 a[36:39], v[108:111], v[80:83], a[36:39]
    v_mfma_f32_16x16x32_bf16 a[56:59], v[108:111], v[84:87], a[56:59]
    v_mfma_f32_16x16x32_bf16 a[76:79], v[108:111], v[88:91], a[76:79]
    buffer_load_dwordx4 v[108:111], v9, s[12:15], s41 offen offset:1024
    buffer_load_dwordx4 v[76:79], v4, s[8:11], s40 offen
    buffer_load_dwordx4 v[80:83], v5, s[8:11], s40 offen
    buffer_load_dwordx4 v[84:87], v6, s[8:11], s40 offen
    buffer_load_dwordx4 v[88:91], v7, s[8:11], s40 offen
    s_add_u32 s40, s40, 4096
    s_add_u32 s41, s41, 147456
    s_waitcnt vmcnt(45)
    v_mfma_f32_16x16x32_bf16 a[0:3], v[128:131], v[112:115], a[0:3]
    v_mfma_f32_16x16x32_bf16 a[20:23], v[128:131], v[116:119], a[20:23]
    v_mfma_f32_16x16x32_bf16 a[40:43], v[128:131], v[120:123], a[40:43]
    v_mfma_f32_16x16x32_bf16 a[60:63], v[128:131], v[124:127], a[60:63]
    buffer_load_dwordx4 v[128:131], v8, s[12:15], s41 offen offset:0
    v_mfma_f32_16x16x32_bf16 a[4:7], v[132:135], v[112:115], a[4:7]
    v_mfma_f32_16x16x32_bf16 a[24:27], v[132:135], v[116:119], a[24:27]
    v_mfma_f32_16x16x32_bf16 a[44:47], v[132:135], v[120:123], a[44:47]
    v_mfma_f32_16x16x32_bf16 a[64:67], v[132:135], v[124:127], a[64:67]
    buffer_load_dwordx4 v[132:135], v8, s[12:15], s41 offen offset:256
    v_mfma_f32_16x16x32_bf16 a[8:11], v[136:139], v[112:115], a[8:11]
    v_mfma_f32_16x16x32_bf16 a[28:31], v[136:139], v[116:119], a[28:31]
    v_mfma_f32_16x16x32_bf16 a[48:51], v[136:139], v[120:123], a[48:51]
    v_mfma_f32_16x16x32_bf16 a[68:71], v[136:139], v[124:127], a[68:71]
    buffer_load_dwordx4 v[136:139], v8, s[12:15], s41 offen offset:512
    v_mfma_f32_16x16x32_bf16 a[12:15], v[140:143], v[112:115], a[12:15]
    v_mfma_f32_16x16x32_bf16 a[32:35], v[140:143], v[116:119], a[32:35]
    v_mfma_f32_16x16x32_bf16 a[52:55], v[140:143], v[120:123], a[52:55]
    v_mfma_f32_16x16x32_bf16 a[72:75], v[140:143], v[124:127], a[72:75]
    buffer_load_dwordx4 v[140:143], v8, s[12:15], s41 offen offset:768
    v_mfma_f32_16x16x32_bf16 a[16:19], v[144:147], v[112:115], a[16:19]
    v_mfma_f32_16x16x32_bf16 a[36:39], v[144:147], v[116:119], a[36:39]
    v_mfma_f32_16x16x32_bf16 a[56:59], v[144:147], v[120:123], a[56:59]
    v_mfma_f32_16x16x32_bf16 a[76:79], v[144:147], v[124:127], a[76:79]
    buffer_load_dwordx4 v[144:147], v9, s[12:15], s41 offen offset:1024
    buffer_load_dwordx4 v[112:115], v4, s[8:11], s40 offen
    buffer_load_dwordx4 v[116:119], v5, s[8:11], s40 offen
    buffer_load_dwordx4 v[120:123], v6, s[8:11], s40 offen
    buffer_load_dwordx4 v[124:127], v7, s[8:11], s40 offen
    s_add_u32 s40, s40, 4096
    s_add_u32 s41, s41, 147456
    s_waitcnt vmcnt(45)
    v_mfma_f32_16x16x32_bf16 a[0:3], v[164:167], v[148:151], a[0:3]
    v_mfma_f32_16x16x32_bf16 a[20:23], v[164:167], v[152:155], a[20:23]
    v_mfma_f32_16x16x32_bf16 a[40:43], v[164:167], v[156:159], a[40:43]
    v_mfma_f32_16x16x32_bf16 a[60:63], v[164:167], v[160:163], a[60:63]
    buffer_load_dwordx4 v[164:167], v8, s[12:15], s41 offen offset:0
    v_mfma_f32_16x16x32_bf16 a[4:7], v[168:171], v[148:151], a[4:7]
    v_mfma_f32_16x16x32_bf16 a[24:27], v[168:171], v[152:155], a[24:27]
    v_mfma_f32_16x16x32_bf16 a[44:47], v[168:171], v[156:159], a[44:47]
    v_mfma_f32_16x16x32_bf16 a[64:67], v[168:171], v[160:163], a[64:67]
    buffer_load_dwordx4 v[168:171], v8, s[12:15], s41 offen offset:256
    v_mfma_f32_16x16x32_bf16 a[8:11], v[172:175], v[148:151], a[8:11]
    v_mfma_f32_16x16x32_bf16 a[28:31], v[172:175], v[152:155], a[28:31]
    v_mfma_f32_16x16x32_bf16 a[48:51], v[172:175], v[156:159], a[48:51]
    v_mfma_f32_16x16x32_bf16 a[68:71], v[172:175], v[160:163], a[68:71]
    buffer_load_dwordx4 v[172:175], v8, s[12:15], s41 offen offset:512
    v_mfma_f32_16x16x32_bf16 a[12:15], v[176:179], v[148:151], a[12:15]
    v_mfma_f32_16x16x32_bf16 a[32:35], v[176:179], v[152:155], a[32:35]
    v_mfma_f32_16x16x32_bf16 a[52:55], v[176:179], v[156:159], a[52:55]
    v_mfma_f32_16x16x32_bf16 a[72:75], v[176:179], v[160:163], a[72:75]
    buffer_load_dwordx4 v[176:179], v8, s[12:15], s41 offen offset:768
    v_mfma_f32_16x16x32_bf16 a[16:19], v[180:183], v[148:151], a[16:19]
    v_mfma_f32_16x16x32_bf16 a[36:39], v[180:183], v[152:155], a[36:39]
    v_mfma_f32_16x16x32_bf16 a[56:59], v[180:183], v[156:159], a[56:59]
    v_mfma_f32_16x16x32_bf16 a[76:79], v[180:183], v[160:163], a[76:79]
    buffer_load_dwordx4 v[180:183], v9, s[12:15], s41 offen offset:1024
    buffer_load_dwordx4 v[148:151], v4, s[8:11], s40 offen
    buffer_load_dwordx4 v[152:155], v5, s[8:11], s40 offen
    buffer_load_dwordx4 v[156:159], v6, s[8:11], s40 offen
    buffer_load_dwordx4 v[160:163], v7, s[8:11], s40 offen
    s_add_u32 s40, s40, 4096
    s_add_u32 s41, s41, 147456
    s_waitcnt vmcnt(45)
    v_mfma_f32_16x16x32_bf16 a[0:3], v[200:203], v[184:187], a[0:3]
    v_mfma_f32_16x16x32_bf16 a[20:23], v[200:203], v[188:191], a[20:23]
    v_mfma_f32_16x16x32_bf16 a[40:43], v[200:203], v[192:195], a[40:43]
    v_mfma_f32_16x16x32_bf16 a[60:63], v[200:203], v[196:199], a[60:63]
    buffer_load_dwordx4 v[200:203], v8, s[12:15], s41 offen offset:0
    v_mfma_f32_16x16x32_bf16 a[4:7], v[204:207], v[184:187], a[4:7]
    v_mfma_f32_16x16x32_bf16 a[24:27], v[204:207], v[188:191], a[24:27]
    v_mfma_f32_16x16x32_bf16 a[44:47], v[204:207], v[192:195], a[44:47]
    v_mfma_f32_16x16x32_bf16 a[64:67], v[204:207], v[196:199], a[64:67]
    buffer_load_dwordx4 v[204:207], v8, s[12:15], s41 offen offset:256
    v_mfma_f32_16x16x32_bf16 a[8:11], v[208:211], v[184:187], a[8:11]
    v_mfma_f32_16x16x32_bf16 a[28:31], v[208:211], v[188:191], a[28:31]
    v_mfma_f32_16x16x32_bf16 a[48:51], v[208:211], v[192:195], a[48:51]
    v_mfma_f32_16x16x32_bf16 a[68:71], v[208:211], v[196:199], a[68:71]
    buffer_load_dwordx4 v[208:211], v8, s[12:15], s41 offen offset:512
    v_mfma_f32_16x16x32_bf16 a[12:15], v[212:215], v[184:187], a[12:15]
    v_mfma_f32_16x16x32_bf16 a[32:35], v[212:215], v[188:191], a[32:35]
    v_mfma_f32_16x16x32_bf16 a[52:55], v[212:215], v[192:195], a[52:55]
    v_mfma_f32_16x16x32_bf16 a[72:75], v[212:215], v[196:199], a[72:75]
    buffer_load_dwordx4 v[212:215], v8, s[12:15], s41 offen offset:768
    v_mfma_f32_16x16x32_bf16 a[16:19], v[216:219], v[184:187], a[16:19]
    v_mfma_f32_16x16x32_bf16 a[36:39], v[216:219], v[188:191], a[36:39]
    v_mfma_f32_16x16x32_bf16 a[56:59], v[216:219], v[192:195], a[56:59]
    v_mfma_f32_16x16x32_bf16 a[76:79], v[216:219], v[196:199], a[76:79]
    buffer_load_dwordx4 v[216:219], v9, s[12:15], s41 offen offset:1024
    buffer_load_dwordx4 v[184:187], v4, s[8:11], s40 offen
    buffer_load_dwordx4 v[188:191], v5, s[8:11], s40 offen
    buffer_load_dwordx4 v[192:195], v6, s[8:11], s40 offen
    buffer_load_dwordx4 v[196:199], v7, s[8:11], s40 offen
    s_add_u32 s40, s40, 4096
    s_add_u32 s41, s41, 147456
    s_waitcnt vmcnt(45)
    v_mfma_f32_16x16x32_bf16 a[0:3], v[236:239], v[220:223], a[0:3]
    v_mfma_f32_16x16x32_bf16 a[20:23], v[236:239], v[224:227], a[20:23]
    v_mfma_f32_16x16x32_bf16 a[40:43], v[236:239], v[228:231], a[40:43]
    v_mfma_f32_16x16x32_bf16 a[60:63], v[236:239], v[232:235], a[60:63]
    buffer_load_dwordx4 v[236:239], v8, s[12:15], s41 offen offset:0
    v_mfma_f32_16x16x32_bf16 a[4:7], v[240:243], v[220:223], a[4:7]
    v_mfma_f32_16x16x32_bf16 a[24:27], v[240:243], v[224:227], a[24:27]
    v_mfma_f32_16x16x32_bf16 a[44:47], v[240:243], v[228:231], a[44:47]
    v_mfma_f32_16x16x32_bf16 a[64:67], v[240:243], v[232:235], a[64:67]
    buffer_load_dwordx4 v[240:243], v8, s[12:15], s41 offen offset:256
    v_mfma_f32_16x16x32_bf16 a[8:11], v[244:247], v[220:223], a[8:11]
    v_mfma_f32_16x16x32_bf16 a[28:31], v[244:247], v[224:227], a[28:31]
    v_mfma_f32_16x16x32_bf16 a[48:51], v[244:247], v[228:231], a[48:51]
    v_mfma_f32_16x16x32_bf16 a[68:71], v[244:247], v[232:235], a[68:71]
    buffer_load_dwordx4 v[244:247], v8, s[12:15], s41 offen offset:512
    v_mfma_f32_16x16x32_bf16 a[12:15], v[248:251], v[220:223], a[12:15]
    v_mfma_f32_16x16x32_bf16 a[32:35], v[248:251], v[224:227], a[32:35]
    v_mfma_f32_16x16x32_bf16 a[52:55], v[248:251], v[228:231], a[52:55]
    v_mfma_f32_16x16x32_bf16 a[72:75], v[248:251], v[232:235], a[72:75]
    buffer_load_dwordx4 v[248:251], v8, s[12:15], s41 offen offset:768
    v_mfma_f32_16x16x32_bf16 a[16:19], v[252:255], v[220:223], a[16:19]
    v_mfma_f32_16x16x32_bf16 a[36:39], v[252:255], v[224:227], a[36:39]
    v_mfma_f32_16x16x32_bf16 a[56:59], v[252:255], v[228:231], a[56:59]
    v_mfma_f32_16x16x32_bf16 a[76:79], v[252:255], v[232:235], a[76:79]
    buffer_load_dwordx4 v[252:255], v9, s[12:15], s41 offen offset:1024
    buffer_load_dwordx4 v[220:223], v4, s[8:11], s40 offen
    buffer_load_dwordx4 v[224:227], v5, s[8:11], s40 offen
    buffer_load_dwordx4 v[228:231], v6, s[8:11], s40 offen
    buffer_load_dwordx4 v[232:235], v7, s[8:11], s40 offen
    s_add_u32 s40, s40, 4096
    s_add_u32 s41, s41, 147456
    s_waitcnt vmcnt(45)
    v_mfma_f32_16x16x32_bf16 a[0:3], v[56:59], v[40:43], a[0:3]
    v_mfma_f32_16x16x32_bf16 a[20:23], v[56:59], v[44:47], a[20:23]
    v_mfma_f32_16x16x32_bf16 a[40:43], v[56:59], v[48:51], a[40:43]
    v_mfma_f32_16x16x32_bf16 a[60:63], v[56:59], v[52:55], a[60:63]
    buffer_load_dwordx4 v[56:59], v8, s[12:15], s41 offen offset:0
    v_mfma_f32_16x16x32_bf16 a[4:7], v[60:63], v[40:43], a[4:7]
    v_mfma_f32_16x16x32_bf16 a[24:27], v[60:63], v[44:47], a[24:27]
    v_mfma_f32_16x16x32_bf16 a[44:47], v[60:63], v[48:51], a[44:47]
    v_mfma_f32_16x16x32_bf16 a[64:67], v[60:63], v[52:55], a[64:67]
    buffer_load_dwordx4 v[60:63], v8, s[12:15], s41 offen offset:256
    v_mfma_f32_16x16x32_bf16 a[8:11], v[64:67], v[40:43], a[8:11]
    v_mfma_f32_16x16x32_bf16 a[28:31], v[64:67], v[44:47], a[28:31]
    v_mfma_f32_16x16x32_bf16 a[48:51], v[64:67], v[48:51], a[48:51]
    v_mfma_f32_16x16x32_bf16 a[68:71], v[64:67], v[52:55], a[68:71]
    buffer_load_dwordx4 v[64:67], v8, s[12:15], s41 offen offset:512
    v_mfma_f32_16x16x32_bf16 a[12:15], v[68:71], v[40:43], a[12:15]
    v_mfma_f32_16x16x32_bf16 a[32:35], v[68:71], v[44:47], a[32:35]
    v_mfma_f32_16x16x32_bf16 a[52:55], v[68:71], v[48:51], a[52:55]
    v_mfma_f32_16x16x32_bf16 a[72:75], v[68:71], v[52:55], a[72:75]
    buffer_load_dwordx4 v[68:71], v8, s[12:15], s41 offen offset:768
    v_mfma_f32_16x16x32_bf16 a[16:19], v[72:75], v[40:43], a[16:19]
    v_mfma_f32_16x16x32_bf16 a[36:39], v[72:75], v[44:47], a[36:39]
    v_mfma_f32_16x16x32_bf16 a[56:59], v[72:75], v[48:51], a[56:59]
    v_mfma_f32_16x16x32_bf16 a[76:79], v[72:75], v[52:55], a[76:79]
    buffer_load_dwordx4 v[72:75], v9, s[12:15], s41 offen offset:1024
    buffer_load_dwordx4 v[40:43], v4, s[8:11], s40 offen
    buffer_load_dwordx4 v[44:47], v5, s[8:11], s40 offen
    buffer_load_dwordx4 v[48:51], v6, s[8:11], s40 offen
    buffer_load_dwordx4 v[52:55], v7, s[8:11], s40 offen
    s_add_u32 s40, s40, 4096
    s_add_u32 s41, s41, 147456
    s_waitcnt vmcnt(45)
    v_mfma_f32_16x16x32_bf16 a[0:3], v[92:95], v[76:79], a[0:3]
    v_mfma_f32_16x16x32_bf16 a[20:23], v[92:95], v[80:83], a[20:23]
    v_mfma_f32_16x16x32_bf16 a[40:43], v[92:95], v[84:87], a[40:43]
    v_mfma_f32_16x16x32_bf16 a[60:63], v[92:95], v[88:91], a[60:63]
    buffer_load_dwordx4 v[92:95], v8, s[12:15], s41 offen offset:0
    v_mfma_f32_16x16x32_bf16 a[4:7], v[96:99], v[76:79], a[4:7]
    v_mfma_f32_16x16x32_bf16 a[24:27], v[96:99], v[80:83], a[24:27]
    v_mfma_f32_16x16x32_bf16 a[44:47], v[96:99], v[84:87], a[44:47]
    v_mfma_f32_16x16x32_bf16 a[64:67], v[96:99], v[88:91], a[64:67]
    buffer_load_dwordx4 v[96:99], v8, s[12:15], s41 offen offset:256
    v_mfma_f32_16x16x32_bf16 a[8:11], v[100:103], v[76:79], a[8:11]
    v_mfma_f32_16x16x32_bf16 a[28:31], v[100:103], v[80:83], a[28:31]
    v_mfma_f32_16x16x32_bf16 a[48:51], v[100:103], v[84:87], a[48:51]
    v_mfma_f32_16x16x32_bf16 a[68:71], v[100:103], v[88:91], a[68:71]
    buffer_load_dwordx4 v[100:103], v8, s[12:15], s41 offen offset:512
    v_mfma_f32_16x16x32_bf16 a[12:15], v[104:107], v[76:79], a[12:15]
    v_mfma_f32_16x16x32_bf16 a[32:35], v[104:107], v[80:83], a[32:35]
    v_mfma_f32_16x16x32_bf16 a[52:55], v[104:107], v[84:87], a[52:55]
    v_mfma_f32_16x16x32_bf16 a[72:75], v[104:107], v[88:91], a[72:75]
    buffer_load_dwordx4 v[104:107], v8, s[12:15], s41 offen offset:768
    v_mfma_f32_16x16x32_bf16 a[16:19], v[108:111], v[76:79], a[16:19]
    v_mfma_f32_16x16x32_bf16 a[36:39], v[108:111], v[80:83], a[36:39]
    v_mfma_f32_16x16x32_bf16 a[56:59], v[108:111], v[84:87], a[56:59]
    v_mfma_f32_16x16x32_bf16 a[76:79], v[108:111], v[88:91], a[76:79]
    buffer_load_dwordx4 v[108:111], v9, s[12:15], s41 offen offset:1024
    buffer_load_dwordx4 v[76:79], v4, s[8:11], s40 offen
    buffer_load_dwordx4 v[80:83], v5, s[8:11], s40 offen
    buffer_load_dwordx4 v[84:87], v6, s[8:11], s40 offen
    buffer_load_dwordx4 v[88:91], v7, s[8:11], s40 offen
    s_add_u32 s40, s40, 4096
    s_add_u32 s41, s41, 147456
    s_waitcnt vmcnt(45)
    v_mfma_f32_16x16x32_bf16 a[0:3], v[128:131], v[112:115], a[0:3]
    v_mfma_f32_16x16x32_bf16 a[20:23], v[128:131], v[116:119], a[20:23]
    v_mfma_f32_16x16x32_bf16 a[40:43], v[128:131], v[120:123], a[40:43]
    v_mfma_f32_16x16x32_bf16 a[60:63], v[128:131], v[124:127], a[60:63]
    buffer_load_dwordx4 v[128:131], v8, s[12:15], s41 offen offset:0
    v_mfma_f32_16x16x32_bf16 a[4:7], v[132:135], v[112:115], a[4:7]
    v_mfma_f32_16x16x32_bf16 a[24:27], v[132:135], v[116:119], a[24:27]
    v_mfma_f32_16x16x32_bf16 a[44:47], v[132:135], v[120:123], a[44:47]
    v_mfma_f32_16x16x32_bf16 a[64:67], v[132:135], v[124:127], a[64:67]
    buffer_load_dwordx4 v[132:135], v8, s[12:15], s41 offen offset:256
    v_mfma_f32_16x16x32_bf16 a[8:11], v[136:139], v[112:115], a[8:11]
    v_mfma_f32_16x16x32_bf16 a[28:31], v[136:139], v[116:119], a[28:31]
    v_mfma_f32_16x16x32_bf16 a[48:51], v[136:139], v[120:123], a[48:51]
    v_mfma_f32_16x16x32_bf16 a[68:71], v[136:139], v[124:127], a[68:71]
    buffer_load_dwordx4 v[136:139], v8, s[12:15], s41 offen offset:512
    v_mfma_f32_16x16x32_bf16 a[12:15], v[140:143], v[112:115], a[12:15]
    v_mfma_f32_16x16x32_bf16 a[32:35], v[140:143], v[116:119], a[32:35]
    v_mfma_f32_16x16x32_bf16 a[52:55], v[140:143], v[120:123], a[52:55]
    v_mfma_f32_16x16x32_bf16 a[72:75], v[140:143], v[124:127], a[72:75]
    buffer_load_dwordx4 v[140:143], v8, s[12:15], s41 offen offset:768
    v_mfma_f32_16x16x32_bf16 a[16:19], v[144:147], v[112:115], a[16:19]
    v_mfma_f32_16x16x32_bf16 a[36:39], v[144:147], v[116:119], a[36:39]
    v_mfma_f32_16x16x32_bf16 a[56:59], v[144:147], v[120:123], a[56:59]
    v_mfma_f32_16x16x32_bf16 a[76:79], v[144:147], v[124:127], a[76:79]
    buffer_load_dwordx4 v[144:147], v9, s[12:15], s41 offen offset:1024
    buffer_load_dwordx4 v[112:115], v4, s[8:11], s40 offen
    buffer_load_dwordx4 v[116:119], v5, s[8:11], s40 offen
    buffer_load_dwordx4 v[120:123], v6, s[8:11], s40 offen
    buffer_load_dwordx4 v[124:127], v7, s[8:11], s40 offen
    s_add_u32 s40, s40, 4096
    s_add_u32 s41, s41, 147456
    s_waitcnt vmcnt(45)
    v_mfma_f32_16x16x32_bf16 a[0:3], v[164:167], v[148:151], a[0:3]
    v_mfma_f32_16x16x32_bf16 a[20:23], v[164:167], v[152:155], a[20:23]
    v_mfma_f32_16x16x32_bf16 a[40:43], v[164:167], v[156:159], a[40:43]
    v_mfma_f32_16x16x32_bf16 a[60:63], v[164:167], v[160:163], a[60:63]
    buffer_load_dwordx4 v[164:167], v8, s[12:15], s41 offen offset:0
    v_mfma_f32_16x16x32_bf16 a[4:7], v[168:171], v[148:151], a[4:7]
    v_mfma_f32_16x16x32_bf16 a[24:27], v[168:171], v[152:155], a[24:27]
    v_mfma_f32_16x16x32_bf16 a[44:47], v[168:171], v[156:159], a[44:47]
    v_mfma_f32_16x16x32_bf16 a[64:67], v[168:171], v[160:163], a[64:67]
    buffer_load_dwordx4 v[168:171], v8, s[12:15], s41 offen offset:256
    v_mfma_f32_16x16x32_bf16 a[8:11], v[172:175], v[148:151], a[8:11]
    v_mfma_f32_16x16x32_bf16 a[28:31], v[172:175], v[152:155], a[28:31]
    v_mfma_f32_16x16x32_bf16 a[48:51], v[172:175], v[156:159], a[48:51]
    v_mfma_f32_16x16x32_bf16 a[68:71], v[172:175], v[160:163], a[68:71]
    buffer_load_dwordx4 v[172:175], v8, s[12:15], s41 offen offset:512
    v_mfma_f32_16x16x32_bf16 a[12:15], v[176:179], v[148:151], a[12:15]
    v_mfma_f32_16x16x32_bf16 a[32:35], v[176:179], v[152:155], a[32:35]
    v_mfma_f32_16x16x32_bf16 a[52:55], v[176:179], v[156:159], a[52:55]
    v_mfma_f32_16x16x32_bf16 a[72:75], v[176:179], v[160:163], a[72:75]
    buffer_load_dwordx4 v[176:179], v8, s[12:15], s41 offen offset:768
    v_mfma_f32_16x16x32_bf16 a[16:19], v[180:183], v[148:151], a[16:19]
    v_mfma_f32_16x16x32_bf16 a[36:39], v[180:183], v[152:155], a[36:39]
    v_mfma_f32_16x16x32_bf16 a[56:59], v[180:183], v[156:159], a[56:59]
    v_mfma_f32_16x16x32_bf16 a[76:79], v[180:183], v[160:163], a[76:79]
    buffer_load_dwordx4 v[180:183], v9, s[12:15], s41 offen offset:1024
    buffer_load_dwordx4 v[148:151], v4, s[8:11], s40 offen
    buffer_load_dwordx4 v[152:155], v5, s[8:11], s40 offen
    buffer_load_dwordx4 v[156:159], v6, s[8:11], s40 offen
    buffer_load_dwordx4 v[160:163], v7, s[8:11], s40 offen
    s_add_u32 s40, s40, 4096
    s_add_u32 s41, s41, 147456
    s_waitcnt vmcnt(45)
    v_mfma_f32_16x16x32_bf16 a[0:3], v[200:203], v[184:187], a[0:3]
    v_mfma_f32_16x16x32_bf16 a[20:23], v[200:203], v[188:191], a[20:23]
    v_mfma_f32_16x16x32_bf16 a[40:43], v[200:203], v[192:195], a[40:43]
    v_mfma_f32_16x16x32_bf16 a[60:63], v[200:203], v[196:199], a[60:63]
    buffer_load_dwordx4 v[200:203], v8, s[12:15], s41 offen offset:0
    v_mfma_f32_16x16x32_bf16 a[4:7], v[204:207], v[184:187], a[4:7]
    v_mfma_f32_16x16x32_bf16 a[24:27], v[204:207], v[188:191], a[24:27]
    v_mfma_f32_16x16x32_bf16 a[44:47], v[204:207], v[192:195], a[44:47]
    v_mfma_f32_16x16x32_bf16 a[64:67], v[204:207], v[196:199], a[64:67]
    buffer_load_dwordx4 v[204:207], v8, s[12:15], s41 offen offset:256
    v_mfma_f32_16x16x32_bf16 a[8:11], v[208:211], v[184:187], a[8:11]
    v_mfma_f32_16x16x32_bf16 a[28:31], v[208:211], v[188:191], a[28:31]
    v_mfma_f32_16x16x32_bf16 a[48:51], v[208:211], v[192:195], a[48:51]
    v_mfma_f32_16x16x32_bf16 a[68:71], v[208:211], v[196:199], a[68:71]
    buffer_load_dwordx4 v[208:211], v8, s[12:15], s41 offen offset:512
    v_mfma_f32_16x16x32_bf16 a[12:15], v[212:215], v[184:187], a[12:15]
    v_mfma_f32_16x16x32_bf16 a[32:35], v[212:215], v[188:191], a[32:35]
    v_mfma_f32_16x16x32_bf16 a[52:55], v[212:215], v[192:195], a[52:55]
    v_mfma_f32_16x16x32_bf16 a[72:75], v[212:215], v[196:199], a[72:75]
    buffer_load_dwordx4 v[212:215], v8, s[12:15], s41 offen offset:768
    v_mfma_f32_16x16x32_bf16 a[16:19], v[216:219], v[184:187], a[16:19]
    v_mfma_f32_16x16x32_bf16 a[36:39], v[216:219], v[188:191], a[36:39]
    v_mfma_f32_16x16x32_bf16 a[56:59], v[216:219], v[192:195], a[56:59]
    v_mfma_f32_16x16x32_bf16 a[76:79], v[216:219], v[196:199], a[76:79]
    buffer_load_dwordx4 v[216:219], v9, s[12:15], s41 offen offset:1024
    buffer_load_dwordx4 v[184:187], v4, s[8:11], s40 offen
    buffer_load_dwordx4 v[188:191], v5, s[8:11], s40 offen
    buffer_load_dwordx4 v[192:195], v6, s[8:11], s40 offen
    buffer_load_dwordx4 v[196:199], v7, s[8:11], s40 offen
    s_add_u32 s40, s40, 4096
    s_add_u32 s41, s41, 147456
    s_waitcnt vmcnt(45)
    v_mfma_f32_16x16x32_bf16 a[0:3], v[236:239], v[220:223], a[0:3]
    v_mfma_f32_16x16x32_bf16 a[20:23], v[236:239], v[224:227], a[20:23]
    v_mfma_f32_16x16x32_bf16 a[40:43], v[236:239], v[228:231], a[40:43]
    v_mfma_f32_16x16x32_bf16 a[60:63], v[236:239], v[232:235], a[60:63]
    buffer_load_dwordx4 v[236:239], v8, s[12:15], s41 offen offset:0
    v_mfma_f32_16x16x32_bf16 a[4:7], v[240:243], v[220:223], a[4:7]
    v_mfma_f32_16x16x32_bf16 a[24:27], v[240:243], v[224:227], a[24:27]
    v_mfma_f32_16x16x32_bf16 a[44:47], v[240:243], v[228:231], a[44:47]
    v_mfma_f32_16x16x32_bf16 a[64:67], v[240:243], v[232:235], a[64:67]
    buffer_load_dwordx4 v[240:243], v8, s[12:15], s41 offen offset:256
    v_mfma_f32_16x16x32_bf16 a[8:11], v[244:247], v[220:223], a[8:11]
    v_mfma_f32_16x16x32_bf16 a[28:31], v[244:247], v[224:227], a[28:31]
    v_mfma_f32_16x16x32_bf16 a[48:51], v[244:247], v[228:231], a[48:51]
    v_mfma_f32_16x16x32_bf16 a[68:71], v[244:247], v[232:235], a[68:71]
    buffer_load_dwordx4 v[244:247], v8, s[12:15], s41 offen offset:512
    v_mfma_f32_16x16x32_bf16 a[12:15], v[248:251], v[220:223], a[12:15]
    v_mfma_f32_16x16x32_bf16 a[32:35], v[248:251], v[224:227], a[32:35]
    v_mfma_f32_16x16x32_bf16 a[52:55], v[248:251], v[228:231], a[52:55]
    v_mfma_f32_16x16x32_bf16 a[72:75], v[248:251], v[232:235], a[72:75]
    buffer_load_dwordx4 v[248:251], v8, s[12:15], s41 offen offset:768
    v_mfma_f32_16x16x32_bf16 a[16:19], v[252:255], v[220:223], a[16:19]
    v_mfma_f32_16x16x32_bf16 a[36:39], v[252:255], v[224:227], a[36:39]
    v_mfma_f32_16x16x32_bf16 a[56:59], v[252:255], v[228:231], a[56:59]
    v_mfma_f32_16x16x32_bf16 a[76:79], v[252:255], v[232:235], a[76:79]
    buffer_load_dwordx4 v[252:255], v9, s[12:15], s41 offen offset:1024
    buffer_load_dwordx4 v[220:223], v4, s[8:11], s40 offen
    buffer_load_dwordx4 v[224:227], v5, s[8:11], s40 offen
    buffer_load_dwordx4 v[228:231], v6, s[8:11], s40 offen
    buffer_load_dwordx4 v[232:235], v7, s[8:11], s40 offen
    s_add_u32 s40, s40, 4096
    s_add_u32 s41, s41, 147456
    s_waitcnt vmcnt(45)
    v_mfma_f32_16x16x32_bf16 a[0:3], v[56:59], v[40:43], a[0:3]
    v_mfma_f32_16x16x32_bf16 a[20:23], v[56:59], v[44:47], a[20:23]
    v_mfma_f32_16x16x32_bf16 a[40:43], v[56:59], v[48:51], a[40:43]
    v_mfma_f32_16x16x32_bf16 a[60:63], v[56:59], v[52:55], a[60:63]
    buffer_load_dwordx4 v[56:59], v8, s[12:15], s41 offen offset:0
    v_mfma_f32_16x16x32_bf16 a[4:7], v[60:63], v[40:43], a[4:7]
    v_mfma_f32_16x16x32_bf16 a[24:27], v[60:63], v[44:47], a[24:27]
    v_mfma_f32_16x16x32_bf16 a[44:47], v[60:63], v[48:51], a[44:47]
    v_mfma_f32_16x16x32_bf16 a[64:67], v[60:63], v[52:55], a[64:67]
    buffer_load_dwordx4 v[60:63], v8, s[12:15], s41 offen offset:256
    v_mfma_f32_16x16x32_bf16 a[8:11], v[64:67], v[40:43], a[8:11]
    v_mfma_f32_16x16x32_bf16 a[28:31], v[64:67], v[44:47], a[28:31]
    v_mfma_f32_16x16x32_bf16 a[48:51], v[64:67], v[48:51], a[48:51]
    v_mfma_f32_16x16x32_bf16 a[68:71], v[64:67], v[52:55], a[68:71]
    buffer_load_dwordx4 v[64:67], v8, s[12:15], s41 offen offset:512
    v_mfma_f32_16x16x32_bf16 a[12:15], v[68:71], v[40:43], a[12:15]
    v_mfma_f32_16x16x32_bf16 a[32:35], v[68:71], v[44:47], a[32:35]
    v_mfma_f32_16x16x32_bf16 a[52:55], v[68:71], v[48:51], a[52:55]
    v_mfma_f32_16x16x32_bf16 a[72:75], v[68:71], v[52:55], a[72:75]
    buffer_load_dwordx4 v[68:71], v8, s[12:15], s41 offen offset:768
    v_mfma_f32_16x16x32_bf16 a[16:19], v[72:75], v[40:43], a[16:19]
    v_mfma_f32_16x16x32_bf16 a[36:39], v[72:75], v[44:47], a[36:39]
    v_mfma_f32_16x16x32_bf16 a[56:59], v[72:75], v[48:51], a[56:59]
    v_mfma_f32_16x16x32_bf16 a[76:79], v[72:75], v[52:55], a[76:79]
    buffer_load_dwordx4 v[72:75], v9, s[12:15], s41 offen offset:1024
    buffer_load_dwordx4 v[40:43], v4, s[8:11], s40 offen
    buffer_load_dwordx4 v[44:47], v5, s[8:11], s40 offen
    buffer_load_dwordx4 v[48:51], v6, s[8:11], s40 offen
    buffer_load_dwordx4 v[52:55], v7, s[8:11], s40 offen
    s_add_u32 s40, s40, 4096
    s_add_u32 s41, s41, 147456
    s_waitcnt vmcnt(45)
    v_mfma_f32_16x16x32_bf16 a[0:3], v[92:95], v[76:79], a[0:3]
    v_mfma_f32_16x16x32_bf16 a[20:23], v[92:95], v[80:83], a[20:23]
    v_mfma_f32_16x16x32_bf16 a[40:43], v[92:95], v[84:87], a[40:43]
    v_mfma_f32_16x16x32_bf16 a[60:63], v[92:95], v[88:91], a[60:63]
    buffer_load_dwordx4 v[92:95], v8, s[12:15], s41 offen offset:0
    v_mfma_f32_16x16x32_bf16 a[4:7], v[96:99], v[76:79], a[4:7]
    v_mfma_f32_16x16x32_bf16 a[24:27], v[96:99], v[80:83], a[24:27]
    v_mfma_f32_16x16x32_bf16 a[44:47], v[96:99], v[84:87], a[44:47]
    v_mfma_f32_16x16x32_bf16 a[64:67], v[96:99], v[88:91], a[64:67]
    buffer_load_dwordx4 v[96:99], v8, s[12:15], s41 offen offset:256
    v_mfma_f32_16x16x32_bf16 a[8:11], v[100:103], v[76:79], a[8:11]
    v_mfma_f32_16x16x32_bf16 a[28:31], v[100:103], v[80:83], a[28:31]
    v_mfma_f32_16x16x32_bf16 a[48:51], v[100:103], v[84:87], a[48:51]
    v_mfma_f32_16x16x32_bf16 a[68:71], v[100:103], v[88:91], a[68:71]
    buffer_load_dwordx4 v[100:103], v8, s[12:15], s41 offen offset:512
    v_mfma_f32_16x16x32_bf16 a[12:15], v[104:107], v[76:79], a[12:15]
    v_mfma_f32_16x16x32_bf16 a[32:35], v[104:107], v[80:83], a[32:35]
    v_mfma_f32_16x16x32_bf16 a[52:55], v[104:107], v[84:87], a[52:55]
    v_mfma_f32_16x16x32_bf16 a[72:75], v[104:107], v[88:91], a[72:75]
    buffer_load_dwordx4 v[104:107], v8, s[12:15], s41 offen offset:768
    v_mfma_f32_16x16x32_bf16 a[16:19], v[108:111], v[76:79], a[16:19]
    v_mfma_f32_16x16x32_bf16 a[36:39], v[108:111], v[80:83], a[36:39]
    v_mfma_f32_16x16x32_bf16 a[56:59], v[108:111], v[84:87], a[56:59]
    v_mfma_f32_16x16x32_bf16 a[76:79], v[108:111], v[88:91], a[76:79]
    buffer_load_dwordx4 v[108:111], v9, s[12:15], s41 offen offset:1024
    buffer_load_dwordx4 v[76:79], v4, s[8:11], s40 offen
    buffer_load_dwordx4 v[80:83], v5, s[8:11], s40 offen
    buffer_load_dwordx4 v[84:87], v6, s[8:11], s40 offen
    buffer_load_dwordx4 v[88:91], v7, s[8:11], s40 offen
    s_add_u32 s40, s40, 4096
    s_add_u32 s41, s41, 147456
    s_waitcnt vmcnt(45)
    v_mfma_f32_16x16x32_bf16 a[0:3], v[128:131], v[112:115], a[0:3]
    v_mfma_f32_16x16x32_bf16 a[20:23], v[128:131], v[116:119], a[20:23]
    v_mfma_f32_16x16x32_bf16 a[40:43], v[128:131], v[120:123], a[40:43]
    v_mfma_f32_16x16x32_bf16 a[60:63], v[128:131], v[124:127], a[60:63]
    buffer_load_dwordx4 v[128:131], v8, s[12:15], s41 offen offset:0
    v_mfma_f32_16x16x32_bf16 a[4:7], v[132:135], v[112:115], a[4:7]
    v_mfma_f32_16x16x32_bf16 a[24:27], v[132:135], v[116:119], a[24:27]
    v_mfma_f32_16x16x32_bf16 a[44:47], v[132:135], v[120:123], a[44:47]
    v_mfma_f32_16x16x32_bf16 a[64:67], v[132:135], v[124:127], a[64:67]
    buffer_load_dwordx4 v[132:135], v8, s[12:15], s41 offen offset:256
    v_mfma_f32_16x16x32_bf16 a[8:11], v[136:139], v[112:115], a[8:11]
    v_mfma_f32_16x16x32_bf16 a[28:31], v[136:139], v[116:119], a[28:31]
    v_mfma_f32_16x16x32_bf16 a[48:51], v[136:139], v[120:123], a[48:51]
    v_mfma_f32_16x16x32_bf16 a[68:71], v[136:139], v[124:127], a[68:71]
    buffer_load_dwordx4 v[136:139], v8, s[12:15], s41 offen offset:512
    v_mfma_f32_16x16x32_bf16 a[12:15], v[140:143], v[112:115], a[12:15]
    v_mfma_f32_16x16x32_bf16 a[32:35], v[140:143], v[116:119], a[32:35]
    v_mfma_f32_16x16x32_bf16 a[52:55], v[140:143], v[120:123], a[52:55]
    v_mfma_f32_16x16x32_bf16 a[72:75], v[140:143], v[124:127], a[72:75]
    buffer_load_dwordx4 v[140:143], v8, s[12:15], s41 offen offset:768
    v_mfma_f32_16x16x32_bf16 a[16:19], v[144:147], v[112:115], a[16:19]
    v_mfma_f32_16x16x32_bf16 a[36:39], v[144:147], v[116:119], a[36:39]
    v_mfma_f32_16x16x32_bf16 a[56:59], v[144:147], v[120:123], a[56:59]
    v_mfma_f32_16x16x32_bf16 a[76:79], v[144:147], v[124:127], a[76:79]
    buffer_load_dwordx4 v[144:147], v9, s[12:15], s41 offen offset:1024
    buffer_load_dwordx4 v[112:115], v4, s[8:11], s40 offen
    buffer_load_dwordx4 v[116:119], v5, s[8:11], s40 offen
    buffer_load_dwordx4 v[120:123], v6, s[8:11], s40 offen
    buffer_load_dwordx4 v[124:127], v7, s[8:11], s40 offen
    s_add_u32 s40, s40, 4096
    s_add_u32 s41, s41, 147456
    s_waitcnt vmcnt(45)
    v_mfma_f32_16x16x32_bf16 a[0:3], v[164:167], v[148:151], a[0:3]
    v_mfma_f32_16x16x32_bf16 a[20:23], v[164:167], v[152:155], a[20:23]
    v_mfma_f32_16x16x32_bf16 a[40:43], v[164:167], v[156:159], a[40:43]
    v_mfma_f32_16x16x32_bf16 a[60:63], v[164:167], v[160:163], a[60:63]
    buffer_load_dwordx4 v[164:167], v8, s[12:15], s41 offen offset:0
    v_mfma_f32_16x16x32_bf16 a[4:7], v[168:171], v[148:151], a[4:7]
    v_mfma_f32_16x16x32_bf16 a[24:27], v[168:171], v[152:155], a[24:27]
    v_mfma_f32_16x16x32_bf16 a[44:47], v[168:171], v[156:159], a[44:47]
    v_mfma_f32_16x16x32_bf16 a[64:67], v[168:171], v[160:163], a[64:67]
    buffer_load_dwordx4 v[168:171], v8, s[12:15], s41 offen offset:256
    v_mfma_f32_16x16x32_bf16 a[8:11], v[172:175], v[148:151], a[8:11]
    v_mfma_f32_16x16x32_bf16 a[28:31], v[172:175], v[152:155], a[28:31]
    v_mfma_f32_16x16x32_bf16 a[48:51], v[172:175], v[156:159], a[48:51]
    v_mfma_f32_16x16x32_bf16 a[68:71], v[172:175], v[160:163], a[68:71]
    buffer_load_dwordx4 v[172:175], v8, s[12:15], s41 offen offset:512
    v_mfma_f32_16x16x32_bf16 a[12:15], v[176:179], v[148:151], a[12:15]
    v_mfma_f32_16x16x32_bf16 a[32:35], v[176:179], v[152:155], a[32:35]
    v_mfma_f32_16x16x32_bf16 a[52:55], v[176:179], v[156:159], a[52:55]
    v_mfma_f32_16x16x32_bf16 a[72:75], v[176:179], v[160:163], a[72:75]
    buffer_load_dwordx4 v[176:179], v8, s[12:15], s41 offen offset:768
    v_mfma_f32_16x16x32_bf16 a[16:19], v[180:183], v[148:151], a[16:19]
    v_mfma_f32_16x16x32_bf16 a[36:39], v[180:183], v[152:155], a[36:39]
    v_mfma_f32_16x16x32_bf16 a[56:59], v[180:183], v[156:159], a[56:59]
    v_mfma_f32_16x16x32_bf16 a[76:79], v[180:183], v[160:163], a[76:79]
    buffer_load_dwordx4 v[180:183], v9, s[12:15], s41 offen offset:1024
    buffer_load_dwordx4 v[148:151], v4, s[8:11], s40 offen
    buffer_load_dwordx4 v[152:155], v5, s[8:11], s40 offen
    buffer_load_dwordx4 v[156:159], v6, s[8:11], s40 offen
    buffer_load_dwordx4 v[160:163], v7, s[8:11], s40 offen
    s_add_u32 s40, s40, 4096
    s_add_u32 s41, s41, 147456
    s_cmp_ge_u32 s36, 2
    s_cselect_b32 s40, 0x10000000, s40
    s_cselect_b32 s41, 0x10000000, s41
    s_waitcnt vmcnt(45)
    v_mfma_f32_16x16x32_bf16 a[0:3], v[200:203], v[184:187], a[0:3]
    v_mfma_f32_16x16x32_bf16 a[20:23], v[200:203], v[188:191], a[20:23]
    v_mfma_f32_16x16x32_bf16 a[40:43], v[200:203], v[192:195], a[40:43]
    v_mfma_f32_16x16x32_bf16 a[60:63], v[200:203], v[196:199], a[60:63]
    buffer_load_dwordx4 v[200:203], v8, s[12:15], s41 offen offset:0
    v_mfma_f32_16x16x32_bf16 a[4:7], v[204:207], v[184:187], a[4:7]
    v_mfma_f32_16x16x32_bf16 a[24:27], v[204:207], v[188:191], a[24:27]
    v_mfma_f32_16x16x32_bf16 a[44:47], v[204:207], v[192:195], a[44:47]
    v_mfma_f32_16x16x32_bf16 a[64:67], v[204:207], v[196:199], a[64:67]
    buffer_load_dwordx4 v[204:207], v8, s[12:15], s41 offen offset:256
    v_mfma_f32_16x16x32_bf16 a[8:11], v[208:211], v[184:187], a[8:11]
    v_mfma_f32_16x16x32_bf16 a[28:31], v[208:211], v[188:191], a[28:31]
    v_mfma_f32_16x16x32_bf16 a[48:51], v[208:211], v[192:195], a[48:51]
    v_mfma_f32_16x16x32_bf16 a[68:71], v[208:211], v[196:199], a[68:71]
    buffer_load_dwordx4 v[208:211], v8, s[12:15], s41 offen offset:512
    v_mfma_f32_16x16x32_bf16 a[12:15], v[212:215], v[184:187], a[12:15]
    v_mfma_f32_16x16x32_bf16 a[32:35], v[212:215], v[188:191], a[32:35]
    v_mfma_f32_16x16x32_bf16 a[52:55], v[212:215], v[192:195], a[52:55]
    v_mfma_f32_16x16x32_bf16 a[72:75], v[212:215], v[196:199], a[72:75]
    buffer_load_dwordx4 v[212:215], v8, s[12:15], s41 offen offset:768
    v_mfma_f32_16x16x32_bf16 a[16:19], v[216:219], v[184:187], a[16:19]
    v_mfma_f32_16x16x32_bf16 a[36:39], v[216:219], v[188:191], a[36:39]
    v_mfma_f32_16x16x32_bf16 a[56:59], v[216:219], v[192:195], a[56:59]
    v_mfma_f32_16x16x32_bf16 a[76:79], v[216:219], v[196:199], a[76:79]
    buffer_load_dwordx4 v[216:219], v9, s[12:15], s41 offen offset:1024
    buffer_load_dwordx4 v[184:187], v4, s[8:11], s40 offen
    buffer_load_dwordx4 v[188:191], v5, s[8:11], s40 offen
    buffer_load_dwordx4 v[192:195], v6, s[8:11], s40 offen
    buffer_load_dwordx4 v[196:199], v7, s[8:11], s40 offen
    s_add_u32 s40, s40, 4096
    s_add_u32 s41, s41, 147456
    s_waitcnt vmcnt(45)
    v_mfma_f32_16x16x32_bf16 a[0:3], v[236:239], v[220:223], a[0:3]
    v_mfma_f32_16x16x32_bf16 a[20:23], v[236:239], v[224:227], a[20:23]
    v_mfma_f32_16x16x32_bf16 a[40:43], v[236:239], v[228:231], a[40:43]
    v_mfma_f32_16x16x32_bf16 a[60:63], v[236:239], v[232:235], a[60:63]
    v_mfma_f32_16x16x32_bf16 a[4:7], v[240:243], v[220:223], a[4:7]
    v_mfma_f32_16x16x32_bf16 a[24:27], v[240:243], v[224:227], a[24:27]
    v_mfma_f32_16x16x32_bf16 a[44:47], v[240:243], v[228:231], a[44:47]
    v_mfma_f32_16x16x32_bf16 a[64:67], v[240:243], v[232:235], a[64:67]
    v_mfma_f32_16x16x32_bf16 a[8:11], v[244:247], v[220:223], a[8:11]
    v_mfma_f32_16x16x32_bf16 a[28:31], v[244:247], v[224:227], a[28:31]
    v_mfma_f32_16x16x32_bf16 a[48:51], v[244:247], v[228:231], a[48:51]
    v_mfma_f32_16x16x32_bf16 a[68:71], v[244:247], v[232:235], a[68:71]
    v_mfma_f32_16x16x32_bf16 a[12:15], v[248:251], v[220:223], a[12:15]
    v_mfma_f32_16x16x32_bf16 a[32:35], v[248:251], v[224:227], a[32:35]
    v_mfma_f32_16x16x32_bf16 a[52:55], v[248:251], v[228:231], a[52:55]
    v_mfma_f32_16x16x32_bf16 a[72:75], v[248:251], v[232:235], a[72:75]
    v_mfma_f32_16x16x32_bf16 a[16:19], v[252:255], v[220:223], a[16:19]
    v_mfma_f32_16x16x32_bf16 a[36:39], v[252:255], v[224:227], a[36:39]
    v_mfma_f32_16x16x32_bf16 a[56:59], v[252:255], v[228:231], a[56:59]
    v_mfma_f32_16x16x32_bf16 a[76:79], v[252:255], v[232:235], a[76:79]
    buffer_load_dwordx2 v[16:17], v11, s[16:19], 0 offen offset:0
    buffer_load_dwordx2 v[18:19], v11, s[16:19], 0 offen offset:32
    buffer_load_dwordx2 v[20:21], v11, s[16:19], 0 offen offset:64
    buffer_load_dwordx2 v[22:23], v11, s[16:19], 0 offen offset:96
    buffer_load_dwordx2 v[24:25], v12, s[16:19], 0 offen offset:128
    s_waitcnt vmcnt(41)
    v_mfma_f32_16x16x32_bf16 a[0:3], v[56:59], v[40:43], a[0:3]
    v_mfma_f32_16x16x32_bf16 a[20:23], v[56:59], v[44:47], a[20:23]
    v_mfma_f32_16x16x32_bf16 a[40:43], v[56:59], v[48:51], a[40:43]
    v_mfma_f32_16x16x32_bf16 a[60:63], v[56:59], v[52:55], a[60:63]
    v_mfma_f32_16x16x32_bf16 a[4:7], v[60:63], v[40:43], a[4:7]
    v_mfma_f32_16x16x32_bf16 a[24:27], v[60:63], v[44:47], a[24:27]
    v_mfma_f32_16x16x32_bf16 a[44:47], v[60:63], v[48:51], a[44:47]
    v_mfma_f32_16x16x32_bf16 a[64:67], v[60:63], v[52:55], a[64:67]
    v_mfma_f32_16x16x32_bf16 a[8:11], v[64:67], v[40:43], a[8:11]
    v_mfma_f32_16x16x32_bf16 a[28:31], v[64:67], v[44:47], a[28:31]
    v_mfma_f32_16x16x32_bf16 a[48:51], v[64:67], v[48:51], a[48:51]
    v_mfma_f32_16x16x32_bf16 a[68:71], v[64:67], v[52:55], a[68:71]
    v_mfma_f32_16x16x32_bf16 a[12:15], v[68:71], v[40:43], a[12:15]
    v_mfma_f32_16x16x32_bf16 a[32:35], v[68:71], v[44:47], a[32:35]
    v_mfma_f32_16x16x32_bf16 a[52:55], v[68:71], v[48:51], a[52:55]
    v_mfma_f32_16x16x32_bf16 a[72:75], v[68:71], v[52:55], a[72:75]
    v_mfma_f32_16x16x32_bf16 a[16:19], v[72:75], v[40:43], a[16:19]
    v_mfma_f32_16x16x32_bf16 a[36:39], v[72:75], v[44:47], a[36:39]
    v_mfma_f32_16x16x32_bf16 a[56:59], v[72:75], v[48:51], a[56:59]
    v_mfma_f32_16x16x32_bf16 a[76:79], v[72:75], v[52:55], a[76:79]
    s_waitcnt vmcnt(32)
    v_mfma_f32_16x16x32_bf16 a[0:3], v[92:95], v[76:79], a[0:3]
    v_mfma_f32_16x16x32_bf16 a[20:23], v[92:95], v[80:83], a[20:23]
    v_mfma_f32_16x16x32_bf16 a[40:43], v[92:95], v[84:87], a[40:43]
    v_mfma_f32_16x16x32_bf16 a[60:63], v[92:95], v[88:91], a[60:63]
    v_mfma_f32_16x16x32_bf16 a[4:7], v[96:99], v[76:79], a[4:7]
    v_mfma_f32_16x16x32_bf16 a[24:27], v[96:99], v[80:83], a[24:27]
    v_mfma_f32_16x16x32_bf16 a[44:47], v[96:99], v[84:87], a[44:47]
    v_mfma_f32_16x16x32_bf16 a[64:67], v[96:99], v[88:91], a[64:67]
    v_mfma_f32_16x16x32_bf16 a[8:11], v[100:103], v[76:79], a[8:11]
    v_mfma_f32_16x16x32_bf16 a[28:31], v[100:103], v[80:83], a[28:31]
    v_mfma_f32_16x16x32_bf16 a[48:51], v[100:103], v[84:87], a[48:51]
    v_mfma_f32_16x16x32_bf16 a[68:71], v[100:103], v[88:91], a[68:71]
    v_mfma_f32_16x16x32_bf16 a[12:15], v[104:107], v[76:79], a[12:15]
    v_mfma_f32_16x16x32_bf16 a[32:35], v[104:107], v[80:83], a[32:35]
    v_mfma_f32_16x16x32_bf16 a[52:55], v[104:107], v[84:87], a[52:55]
    v_mfma_f32_16x16x32_bf16 a[72:75], v[104:107], v[88:91], a[72:75]
    v_mfma_f32_16x16x32_bf16 a[16:19], v[108:111], v[76:79], a[16:19]
    v_mfma_f32_16x16x32_bf16 a[36:39], v[108:111], v[80:83], a[36:39]
    v_mfma_f32_16x16x32_bf16 a[56:59], v[108:111], v[84:87], a[56:59]
    v_mfma_f32_16x16x32_bf16 a[76:79], v[108:111], v[88:91], a[76:79]
    s_waitcnt vmcnt(23)
    v_mfma_f32_16x16x32_bf16 a[0:3], v[128:131], v[112:115], a[0:3]
    v_mfma_f32_16x16x32_bf16 a[20:23], v[128:131], v[116:119], a[20:23]
    v_mfma_f32_16x16x32_bf16 a[40:43], v[128:131], v[120:123], a[40:43]
    v_mfma_f32_16x16x32_bf16 a[60:63], v[128:131], v[124:127], a[60:63]
    v_mfma_f32_16x16x32_bf16 a[4:7], v[132:135], v[112:115], a[4:7]
    v_mfma_f32_16x16x32_bf16 a[24:27], v[132:135], v[116:119], a[24:27]
    v_mfma_f32_16x16x32_bf16 a[44:47], v[132:135], v[120:123], a[44:47]
    v_mfma_f32_16x16x32_bf16 a[64:67], v[132:135], v[124:127], a[64:67]
    v_mfma_f32_16x16x32_bf16 a[8:11], v[136:139], v[112:115], a[8:11]
    v_mfma_f32_16x16x32_bf16 a[28:31], v[136:139], v[116:119], a[28:31]
    v_mfma_f32_16x16x32_bf16 a[48:51], v[136:139], v[120:123], a[48:51]
    v_mfma_f32_16x16x32_bf16 a[68:71], v[136:139], v[124:127], a[68:71]
    v_mfma_f32_16x16x32_bf16 a[12:15], v[140:143], v[112:115], a[12:15]
    v_mfma_f32_16x16x32_bf16 a[32:35], v[140:143], v[116:119], a[32:35]
    v_mfma_f32_16x16x32_bf16 a[52:55], v[140:143], v[120:123], a[52:55]
    v_mfma_f32_16x16x32_bf16 a[72:75], v[140:143], v[124:127], a[72:75]
    v_mfma_f32_16x16x32_bf16 a[16:19], v[144:147], v[112:115], a[16:19]
    v_mfma_f32_16x16x32_bf16 a[36:39], v[144:147], v[116:119], a[36:39]
    v_mfma_f32_16x16x32_bf16 a[56:59], v[144:147], v[120:123], a[56:59]
    v_mfma_f32_16x16x32_bf16 a[76:79], v[144:147], v[124:127], a[76:79]
    s_waitcnt vmcnt(14)
    v_mfma_f32_16x16x32_bf16 a[0:3], v[164:167], v[148:151], a[0:3]
    v_mfma_f32_16x16x32_bf16 a[20:23], v[164:167], v[152:155], a[20:23]
    v_mfma_f32_16x16x32_bf16 a[40:43], v[164:167], v[156:159], a[40:43]
    v_mfma_f32_16x16x32_bf16 a[60:63], v[164:167], v[160:163], a[60:63]
    v_mfma_f32_16x16x32_bf16 a[4:7], v[168:171], v[148:151], a[4:7]
    v_mfma_f32_16x16x32_bf16 a[24:27], v[168:171], v[152:155], a[24:27]
    v_mfma_f32_16x16x32_bf16 a[44:47], v[168:171], v[156:159], a[44:47]
    v_mfma_f32_16x16x32_bf16 a[64:67], v[168:171], v[160:163], a[64:67]
    v_mfma_f32_16x16x32_bf16 a[8:11], v[172:175], v[148:151], a[8:11]
    v_mfma_f32_16x16x32_bf16 a[28:31], v[172:175], v[152:155], a[28:31]
    v_mfma_f32_16x16x32_bf16 a[48:51], v[172:175], v[156:159], a[48:51]
    v_mfma_f32_16x16x32_bf16 a[68:71], v[172:175], v[160:163], a[68:71]
    v_mfma_f32_16x16x32_bf16 a[12:15], v[176:179], v[148:151], a[12:15]
    v_mfma_f32_16x16x32_bf16 a[32:35], v[176:179], v[152:155], a[32:35]
    v_mfma_f32_16x16x32_bf16 a[52:55], v[176:179], v[156:159], a[52:55]
    v_mfma_f32_16x16x32_bf16 a[72:75], v[176:179], v[160:163], a[72:75]
    v_mfma_f32_16x16x32_bf16 a[16:19], v[180:183], v[148:151], a[16:19]
    v_mfma_f32_16x16x32_bf16 a[36:39], v[180:183], v[152:155], a[36:39]
    v_mfma_f32_16x16x32_bf16 a[56:59], v[180:183], v[156:159], a[56:59]
    v_mfma_f32_16x16x32_bf16 a[76:79], v[180:183], v[160:163], a[76:79]
    s_waitcnt vmcnt(5)
    v_mfma_f32_16x16x32_bf16 a[0:3], v[200:203], v[184:187], a[0:3]
    v_mfma_f32_16x16x32_bf16 a[20:23], v[200:203], v[188:191], a[20:23]
    v_mfma_f32_16x16x32_bf16 a[40:43], v[200:203], v[192:195], a[40:43]
    v_mfma_f32_16x16x32_bf16 a[60:63], v[200:203], v[196:199], a[60:63]
    v_mfma_f32_16x16x32_bf16 a[4:7], v[204:207], v[184:187], a[4:7]
    v_mfma_f32_16x16x32_bf16 a[24:27], v[204:207], v[188:191], a[24:27]
    v_mfma_f32_16x16x32_bf16 a[44:47], v[204:207], v[192:195], a[44:47]
    v_mfma_f32_16x16x32_bf16 a[64:67], v[204:207], v[196:199], a[64:67]
    v_mfma_f32_16x16x32_bf16 a[8:11], v[208:211], v[184:187], a[8:11]
    v_mfma_f32_16x16x32_bf16 a[28:31], v[208:211], v[188:191], a[28:31]
    v_mfma_f32_16x16x32_bf16 a[48:51], v[208:211], v[192:195], a[48:51]
    v_mfma_f32_16x16x32_bf16 a[68:71], v[208:211], v[196:199], a[68:71]
    v_mfma_f32_16x16x32_bf16 a[12:15], v[212:215], v[184:187], a[12:15]
    v_mfma_f32_16x16x32_bf16 a[32:35], v[212:215], v[188:191], a[32:35]
    v_mfma_f32_16x16x32_bf16 a[52:55], v[212:215], v[192:195], a[52:55]
    v_mfma_f32_16x16x32_bf16 a[72:75], v[212:215], v[196:199], a[72:75]
    v_mfma_f32_16x16x32_bf16 a[16:19], v[216:219], v[184:187], a[16:19]
    v_mfma_f32_16x16x32_bf16 a[36:39], v[216:219], v[188:191], a[36:39]
    v_mfma_f32_16x16x32_bf16 a[56:59], v[216:219], v[192:195], a[56:59]
    v_mfma_f32_16x16x32_bf16 a[76:79], v[216:219], v[196:199], a[76:79]
    s_nop 7
    ds_write_b128 v13, a[20:23] offset:0
    ds_write_b128 v14, a[40:43] offset:5120
    ds_write_b128 v15, a[60:63] offset:10240
    ds_write_b128 v13, a[24:27] offset:1024
    ds_write_b128 v14, a[44:47] offset:6144
    ds_write_b128 v15, a[64:67] offset:11264
    ds_write_b128 v13, a[28:31] offset:2048
    ds_write_b128 v14, a[48:51] offset:7168
    ds_write_b128 v15, a[68:71] offset:12288
    ds_write_b128 v13, a[32:35] offset:3072
    ds_write_b128 v14, a[52:55] offset:8192
    ds_write_b128 v15, a[72:75] offset:13312
    ds_write_b128 v13, a[36:39] offset:4096
    ds_write_b128 v14, a[56:59] offset:9216
    ds_write_b128 v15, a[76:79] offset:14336
    v_accvgpr_read_b32 v100, a0
    v_accvgpr_read_b32 v101, a1
    v_accvgpr_read_b32 v102, a2
    v_accvgpr_read_b32 v103, a3
    v_accvgpr_read_b32 v104, a4
    v_accvgpr_read_b32 v105, a5
    v_accvgpr_read_b32 v106, a6
    v_accvgpr_read_b32 v107, a7
    v_accvgpr_read_b32 v108, a8
    v_accvgpr_read_b32 v109, a9
    v_accvgpr_read_b32 v110, a10
    v_accvgpr_read_b32 v111, a11
    v_accvgpr_read_b32 v112, a12
    v_accvgpr_read_b32 v113, a13
    v_accvgpr_read_b32 v114, a14
    v_accvgpr_read_b32 v115, a15
    v_accvgpr_read_b32 v116, a16
    v_accvgpr_read_b32 v117, a17
    v_accvgpr_read_b32 v118, a18
    v_accvgpr_read_b32 v119, a19
    s_waitcnt lgkmcnt(0)
    s_barrier
    ds_read_b128 v[40:43], v1 offset:0
    ds_read_b128 v[44:47], v1 offset:5120
    ds_read_b128 v[48:51], v1 offset:10240
    ds_read_b128 v[52:55], v1 offset:1024
    ds_read_b128 v[56:59], v1 offset:6144
    ds_read_b128 v[60:63], v1 offset:11264
    ds_read_b128 v[64:67], v1 offset:2048
    ds_read_b128 v[68:71], v1 offset:7168
    ds_read_b128 v[72:75], v1 offset:12288
    ds_read_b128 v[76:79], v1 offset:3072
    ds_read_b128 v[80:83], v1 offset:8192
    ds_read_b128 v[84:87], v1 offset:13312
    ds_read_b128 v[88:91], v1 offset:4096
    ds_read_b128 v[92:95], v1 offset:9216
    ds_read_b128 v[96:99], v1 offset:14336
    s_waitcnt vmcnt(0)
    v_lshlrev_b32 v30, 16, v16
    v_and_b32 v31, 0xffff0000, v16
    v_add_f32 v100, v100, v30
    v_add_f32 v101, v101, v31
    v_lshlrev_b32 v30, 16, v17
    v_and_b32 v31, 0xffff0000, v17
    v_add_f32 v102, v102, v30
    v_add_f32 v103, v103, v31
    v_lshlrev_b32 v30, 16, v18
    v_and_b32 v31, 0xffff0000, v18
    v_add_f32 v104, v104, v30
    v_add_f32 v105, v105, v31
    v_lshlrev_b32 v30, 16, v19
    v_and_b32 v31, 0xffff0000, v19
    v_add_f32 v106, v106, v30
    v_add_f32 v107, v107, v31
    v_lshlrev_b32 v30, 16, v20
    v_and_b32 v31, 0xffff0000, v20
    v_add_f32 v108, v108, v30
    v_add_f32 v109, v109, v31
    v_lshlrev_b32 v30, 16, v21
    v_and_b32 v31, 0xffff0000, v21
    v_add_f32 v110, v110, v30
    v_add_f32 v111, v111, v31
    v_lshlrev_b32 v30, 16, v22
    v_and_b32 v31, 0xffff0000, v22
    v_add_f32 v112, v112, v30
    v_add_f32 v113, v113, v31
    v_lshlrev_b32 v30, 16, v23
    v_and_b32 v31, 0xffff0000, v23
    v_add_f32 v114, v114, v30
    v_add_f32 v115, v115, v31
    v_lshlrev_b32 v30, 16, v24
    v_and_b32 v31, 0xffff0000, v24
    v_add_f32 v116, v116, v30
    v_add_f32 v117, v117, v31
    v_lshlrev_b32 v30, 16, v25
    v_and_b32 v31, 0xffff0000, v25
    v_add_f32 v118, v118, v30
    v_add_f32 v119, v119, v31
    s_waitcnt lgkmcnt(12)
    v_add_f32 v40, v40, v44
    v_add_f32 v100, v100, v48
    v_add_f32 v41, v41, v45
    v_add_f32 v101, v101, v49
    v_add_f32 v42, v42, v46
    v_add_f32 v102, v102, v50
    v_add_f32 v43, v43, v47
    v_add_f32 v103, v103, v51
    v_add_f32 v100, v100, v40
    v_add_f32 v101, v101, v41
    v_add_f32 v102, v102, v42
    v_add_f32 v103, v103, v43
    v_cvt_pk_bf16_f32 v16, v100, v101
    v_cvt_pk_bf16_f32 v17, v102, v103
    buffer_store_dwordx2 v[16:17], v11, s[20:23], 0 offen offset:0
    s_waitcnt lgkmcnt(9)
    v_add_f32 v52, v52, v56
    v_add_f32 v104, v104, v60
    v_add_f32 v53, v53, v57
    v_add_f32 v105, v105, v61
    v_add_f32 v54, v54, v58
    v_add_f32 v106, v106, v62
    v_add_f32 v55, v55, v59
    v_add_f32 v107, v107, v63
    v_add_f32 v104, v104, v52
    v_add_f32 v105, v105, v53
    v_add_f32 v106, v106, v54
    v_add_f32 v107, v107, v55
    v_cvt_pk_bf16_f32 v18, v104, v105
    v_cvt_pk_bf16_f32 v19, v106, v107
    buffer_store_dwordx2 v[18:19], v11, s[20:23], 0 offen offset:32
    s_waitcnt lgkmcnt(6)
    v_add_f32 v64, v64, v68
    v_add_f32 v108, v108, v72
    v_add_f32 v65, v65, v69
    v_add_f32 v109, v109, v73
    v_add_f32 v66, v66, v70
    v_add_f32 v110, v110, v74
    v_add_f32 v67, v67, v71
    v_add_f32 v111, v111, v75
    v_add_f32 v108, v108, v64
    v_add_f32 v109, v109, v65
    v_add_f32 v110, v110, v66
    v_add_f32 v111, v111, v67
    v_cvt_pk_bf16_f32 v20, v108, v109
    v_cvt_pk_bf16_f32 v21, v110, v111
    buffer_store_dwordx2 v[20:21], v11, s[20:23], 0 offen offset:64
    s_waitcnt lgkmcnt(3)
    v_add_f32 v76, v76, v80
    v_add_f32 v112, v112, v84
    v_add_f32 v77, v77, v81
    v_add_f32 v113, v113, v85
    v_add_f32 v78, v78, v82
    v_add_f32 v114, v114, v86
    v_add_f32 v79, v79, v83
    v_add_f32 v115, v115, v87
    v_add_f32 v112, v112, v76
    v_add_f32 v113, v113, v77
    v_add_f32 v114, v114, v78
    v_add_f32 v115, v115, v79
    v_cvt_pk_bf16_f32 v22, v112, v113
    v_cvt_pk_bf16_f32 v23, v114, v115
    buffer_store_dwordx2 v[22:23], v11, s[20:23], 0 offen offset:96
    s_waitcnt lgkmcnt(0)
    v_add_f32 v88, v88, v92
    v_add_f32 v116, v116, v96
    v_add_f32 v89, v89, v93
    v_add_f32 v117, v117, v97
    v_add_f32 v90, v90, v94
    v_add_f32 v118, v118, v98
    v_add_f32 v91, v91, v95
    v_add_f32 v119, v119, v99
    v_add_f32 v116, v116, v88
    v_add_f32 v117, v117, v89
    v_add_f32 v118, v118, v90
    v_add_f32 v119, v119, v91
    v_cvt_pk_bf16_f32 v24, v116, v117
    v_cvt_pk_bf16_f32 v25, v118, v119
    buffer_store_dwordx2 v[24:25], v12, s[20:23], 0 offen offset:128
k4_end:
    s_endpgm
.section .rodata,"a"
.p2align 6
.amdhsa_kernel k0_kernel
  .amdhsa_next_free_vgpr 72
  .amdhsa_next_free_sgpr 96
  .amdhsa_accum_offset 72
  .amdhsa_group_segment_fixed_size 0
  .amdhsa_kernarg_size 88
  .amdhsa_user_sgpr_count 2
  .amdhsa_user_sgpr_kernarg_segment_ptr 1
  .amdhsa_system_sgpr_workgroup_id_x 1
.end_amdhsa_kernel
.p2align 6
.amdhsa_kernel k1_kernel
  .amdhsa_next_free_vgpr 256
  .amdhsa_next_free_sgpr 96
  .amdhsa_accum_offset 256
  .amdhsa_group_segment_fixed_size 0
  .amdhsa_kernarg_size 88
  .amdhsa_user_sgpr_count 2
  .amdhsa_user_sgpr_kernarg_segment_ptr 1
  .amdhsa_system_sgpr_workgroup_id_x 1
.end_amdhsa_kernel
.p2align 6
.amdhsa_kernel k3_kernel
  .amdhsa_next_free_vgpr 256
  .amdhsa_next_free_sgpr 96
  .amdhsa_accum_offset 256
  .amdhsa_group_segment_fixed_size 0
  .amdhsa_kernarg_size 88
  .amdhsa_user_sgpr_count 2
  .amdhsa_user_sgpr_kernarg_segment_ptr 1
  .amdhsa_system_sgpr_workgroup_id_x 1
.end_amdhsa_kernel
.p2align 6
.amdhsa_kernel k4_kernel
  .amdhsa_next_free_vgpr 336
  .amdhsa_next_free_sgpr 96
  .amdhsa_accum_offset 256
  .amdhsa_group_segment_fixed_size 0
  .amdhsa_kernarg_size 88
  .amdhsa_user_sgpr_count 2
  .amdhsa_user_sgpr_kernarg_segment_ptr 1
  .amdhsa_system_sgpr_workgroup_id_x 1
.end_amdhsa_kernel
```
